```python
import torch

def _softmax(x, axis=-1):
    return torch.softmax(x, dim=axis)
def _gelu(x):
    return torch.nn.functional.gelu(x, approximate="tanh")
def _silu(x):
    return torch.nn.functional.silu(x)
def _sigmoid(x):
    return torch.sigmoid(x)
def _layernorm(x, axis=-1, eps=1e-5):
    m = x.mean(dim=axis, keepdim=True)
    v = x.var(dim=axis, keepdim=True, unbiased=False)
    return (x - m) / torch.sqrt(v + eps)
def _scatter_add(tgt, idx, src, axis=0):
    return tgt.clone().index_add_(axis, idx, src)
def _segment_sum(src, seg, n):
    out = torch.zeros((n,) + src.shape[1:], dtype=src.dtype)
    return out.index_add_(0, seg, src)
def _pad(x, pw):
    flat = tuple(v for pair in reversed(pw) for v in pair)
    return torch.nn.functional.pad(x, flat)

kernel_name = 'recurrent_scan__softmax_full_mha__glu_gated_glu__prompt'

def setup_inputs():

    _w = (lambda a: (lambda t: t.to(torch.bfloat16) if t.is_floating_point() else t)(torch.as_tensor(a)))
    def _A_setup():
        B, S, D = 1, 2048, 640
        return {
            "x": _w((lambda *s: torch.randn(*s, dtype=torch.bfloat16) * 0.05)(B, S, D)),
            "wqkv": _w((lambda *s: torch.randn(*s, dtype=torch.bfloat16) * 0.05)(D, 3 * D)),
            "wo": _w((lambda *s: torch.randn(*s, dtype=torch.bfloat16) * 0.05)(D, D)),
        }
    _A_in = _A_setup()

    def _B_setup():
        B, S, D, F = 1, 2048, 640, 1728
        return {
            "x": _w((lambda *s: torch.randn(*s, dtype=torch.bfloat16) * 0.05)(B, S, D)),
            "w_gate": _w((lambda *s: torch.randn(*s, dtype=torch.bfloat16) * 0.05)(D, F)),
            "w_up": _w((lambda *s: torch.randn(*s, dtype=torch.bfloat16) * 0.05)(D, F)),
            "w_down": _w((lambda *s: torch.randn(*s, dtype=torch.bfloat16) * 0.05)(F, D)),
        }
    _B_in = _B_setup()

    return {
        "A_x": _A_in["x"],
        "A_wqkv": _A_in["wqkv"],
        "A_wo": _A_in["wo"],
        "B_x": _B_in["x"],
        "B_w_gate": _B_in["w_gate"],
        "B_w_up": _B_in["w_up"],
        "B_w_down": _B_in["w_down"],
    }

def reference(A_x, A_wqkv, A_wo, B_x, B_w_gate, B_w_up, B_w_down):
    def _A_ref(x, wqkv, wo):
        B, S, D = x.shape
        H = 32; Dh = D // H
        qkv = (lambda x, *d: x.permute(*d))((x @ wqkv).reshape(B, S, 3, H, Dh), 2, 0, 3, 1, 4)
        q, k, v = qkv[0], qkv[1], qkv[2]
        scale = Dh ** -0.5
        scores = torch.einsum("bhqd,bhkd->bhqk", q, k) * scale
        p = _softmax(scores, axis=-1)
        o = torch.einsum("bhqk,bhkd->bhqd", p, v)
        return (lambda x, *d: x.permute(*d))(o, 0, 2, 1, 3).reshape(B, S, D) @ wo

    def _B_ref(x, w_gate, w_up, w_down):
        g = torch.einsum("bsd,df->bsf", x, w_gate)
        u = torch.einsum("bsd,df->bsf", x, w_up)
        h = _sigmoid(g) * u
        return torch.einsum("bsf,fd->bsd", h, w_down)

    x = A_x
    xn = _layernorm(x, axis=-1)
    s = _A_ref(xn, A_wqkv, A_wo)
    g = _silu(_B_ref(xn, B_w_gate, B_w_up, B_w_down))
    return x + s * g
```

```asm
; @launch grid=(256,1,1) block=(512,1,1) lds=163840
.amdgcn_target "amdgcn-amd-amdhsa--gfx950"
.text
.macro M32 a:vararg
v_mfma_f32_32x32x16_bf16 \a
.endm
.macro M2B a:vararg
v_mfma_f32_32x32x4_2b_bf16 \a
.endm
.macro TR a:vararg
ds_read_b64_tr_b16 \a
.endm
.macro EX a:vararg
v_exp_f32 \a
.endm
.macro CV a:vararg
v_cvt_pk_bf16_f32 \a
.endm
.macro BL4 a:vararg
buffer_load_dwordx4 \a
.endm
.macro BS4 a:vararg
buffer_store_dwordx4 \a
.endm
.macro R128 a:vararg
ds_read_b128 \a
.endm
.macro AR a:vararg
v_accvgpr_read_b32 \a
.endm
.macro WT a:vararg
s_waitcnt \a
.endm
.macro FMA a:vararg
v_fma_f32 \a
.endm
.macro SHL a:vararg
v_lshlrev_b32 \a
.endm
.macro AND a:vararg
v_and_b32 \a
.endm
.macro MUL a:vararg
v_mul_f32 \a
.endm
.macro ADD a:vararg
v_add_f32 \a
.endm
.macro SADD a:vararg
s_add_u32 \a
.endm
.macro DOT a:vararg
v_dot2_f32_bf16 \a
.endm
.macro RCP a:vararg
v_rcp_f32 \a
.endm
.globl recurrent_scan__softmax_full_mha__glu_gated_glu__prompt_kernel
.p2align 8
.type recurrent_scan__softmax_full_mha__glu_gated_glu__prompt_kernel,@function
recurrent_scan__softmax_full_mha__glu_gated_glu__prompt_kernel:
KSTART:
s_cmp_ge_u32 s2,256
s_cbranch_scc1 K1_exit
s_getpc_b64 s[90:91]
PF_pc:
s_sub_u32 s90,s90,PF_pc-KSTART
s_subb_u32 s91,s91,0
s_lshr_b32 s89,s2,3
s_mul_i32 s89,s89,2176
v_subrev_u32 v200,448,v0
v_cmp_gt_u32 vcc,17,v200
SHL v200,7,v200
v_add_u32 v200,s89,v200
s_nop 1
s_and_saveexec_b64 s[92:93],vcc
s_cbranch_execz PF_done
global_load_dword v201,v200,s[90:91]
PF_done:
s_mov_b64 exec,s[92:93]
s_load_dwordx2 s[4:5],s[0:1],0
s_load_dwordx2 s[24:25],s[0:1],72
s_load_dwordx2 s[64:65],s[0:1],8
s_load_dwordx4 s[68:71],s[0:1],32
s_and_b32 s50,s2,7
s_lshr_b32 s51,s2,3
v_lshrrev_b32 v240,6,v0
AND v241,63,v0
v_readfirstlane_b32 s30,v240
SHL v234,4,v241
s_nop 2
s_and_b32 s49,s30,3
s_lshr_b32 s48,s30,2
s_lshr_b32 s52,s50,1
s_lshl_b32 s29,s52,2
s_lshr_b32 s55,s51,3
SADD s29,s29,s55
s_and_b32 s53,s50,1
s_lshl_b32 s28,s53,3
s_and_b32 s53,s51,7
SADD s28,s28,s53
s_cmp_eq_u32 s29,15
s_cbranch_scc1 K1_retile
SADD s31,s53,s55
s_cmp_ge_u32 s31,5
s_cselect_b32 s53,5,0
s_sub_u32 s31,s31,s53
s_cmp_ge_u32 s31,5
s_cselect_b32 s53,5,0
s_sub_u32 s31,s31,s53
s_lshl_b32 s57,s28,2
SADD s57,s57,s49
v_lshrrev_b32 v242,4,v241
AND v243,15,v241
v_add_u32 v244,0,v242
v_xor_b32 v245,v243,v244
v_mul_u32_u24 v244,1280,v244
v_lshl_add_u32 v248,v245,4,v244
v_add_u32 v244,4,v242
v_xor_b32 v245,v243,v244
v_mul_u32_u24 v244,1280,v244
v_lshl_add_u32 v249,v245,4,v244
v_add_u32 v244,8,v242
v_xor_b32 v245,v243,v244
v_mul_u32_u24 v244,1280,v244
v_lshl_add_u32 v250,v245,4,v244
v_add_u32 v244,12,v242
v_xor_b32 v245,v243,v244
v_mul_u32_u24 v244,1280,v244
v_lshl_add_u32 v251,v245,4,v244
s_mul_i32 s50,s57,40960
s_mul_i32 s53,s48,20480
SADD s50,s50,s53
SADD s84,s31,0
s_cmp_ge_u32 s84,5
s_cselect_b32 s53,5,0
s_sub_u32 s84,s84,s53
s_lshl_b32 s84,s84,8
SADD s84,s84,s50
SADD s85,s31,1
s_cmp_ge_u32 s85,5
s_cselect_b32 s53,5,0
s_sub_u32 s85,s85,s53
s_lshl_b32 s85,s85,8
SADD s85,s85,s50
SADD s86,s31,2
s_cmp_ge_u32 s86,5
s_cselect_b32 s53,5,0
s_sub_u32 s86,s86,s53
s_lshl_b32 s86,s86,8
SADD s86,s86,s50
SADD s87,s31,3
s_cmp_ge_u32 s87,5
s_cselect_b32 s53,5,0
s_sub_u32 s87,s87,s53
s_lshl_b32 s87,s87,8
SADD s87,s87,s50
SADD s88,s31,4
s_cmp_ge_u32 s88,5
s_cselect_b32 s53,5,0
s_sub_u32 s88,s88,s53
s_lshl_b32 s88,s88,8
SADD s88,s88,s50
s_lshl_b32 s51,s49,13
s_lshl_b32 s53,s48,12
SADD s51,s51,s53
WT lgkmcnt(0)
s_mov_b32 s6,2621440
s_mov_b32 s7,131072
SADD m0,s51,0
s_nop 0
BL4 v248,s[4:7],s84 offen lds
SADD m0,s51,1024
s_nop 0
BL4 v249,s[4:7],s84 offen lds
SADD m0,s51,2048
s_nop 0
BL4 v250,s[4:7],s84 offen lds
SADD m0,s51,3072
s_nop 0
BL4 v251,s[4:7],s84 offen lds
SADD m0,s51,32768
s_nop 0
BL4 v248,s[4:7],s85 offen lds
SADD m0,s51,33792
s_nop 0
BL4 v249,s[4:7],s85 offen lds
SADD m0,s51,34816
s_nop 0
BL4 v250,s[4:7],s85 offen lds
SADD m0,s51,35840
s_nop 0
BL4 v251,s[4:7],s85 offen lds
SADD m0,s51,65536
s_nop 0
BL4 v248,s[4:7],s86 offen lds
s_mov_b32 s26,23527424
s_mov_b32 s27,131072
s_sub_u32 s8,s64,4096
s_subb_u32 s9,s65,0
s_sub_u32 s12,s64,3968
s_subb_u32 s13,s65,0
s_mov_b32 s10,2461696
s_mov_b32 s14,2461568
s_sub_u32 s16,s68,4096
s_subb_u32 s17,s69,0
s_sub_u32 s20,s70,4096
s_subb_u32 s21,s71,0
s_mov_b32 s18,2215936
s_mov_b32 s22,2215936
s_mov_b32 s11,131072
s_mov_b32 s15,131072
s_mov_b32 s19,131072
s_mov_b32 s23,131072
s_cmp_ge_u32 s29,5
s_cselect_b32 s62,1,0
s_cmp_ge_u32 s29,10
s_cselect_b32 s62,2,s62
s_mul_i32 s53,s62,5
s_sub_u32 s63,s29,s53
s_mov_b32 s60,s29
SADD s61,s29,15
s_mul_i32 s55,s62,1280
s_lshl_b32 s53,s63,8
SADD s55,s55,s53
s_lshl_b32 s56,s60,7
s_lshl_b32 s58,s61,7
SADD s53,s31,0
s_cmp_ge_u32 s53,5
s_cselect_b32 s59,5,0
s_sub_u32 s53,s53,s59
s_lshl_b32 s53,s53,7
s_lshl_b32 s59,s30,4
SADD s59,s59,s53
s_mul_i32 s32,s59,3840
SADD s32,s32,s55
s_mul_i32 s53,s59,3456
SADD s37,s53,s56
SADD s42,s53,s58
SADD s53,s31,1
SADD m0,s51,66560
s_nop 0
BL4 v249,s[4:7],s86 offen lds
s_cmp_ge_u32 s53,5
s_cselect_b32 s59,5,0
s_sub_u32 s53,s53,s59
s_lshl_b32 s53,s53,7
s_lshl_b32 s59,s30,4
SADD s59,s59,s53
s_mul_i32 s33,s59,3840
SADD s33,s33,s55
s_mul_i32 s53,s59,3456
SADD s38,s53,s56
SADD s43,s53,s58
SADD s53,s31,2
s_cmp_ge_u32 s53,5
s_cselect_b32 s59,5,0
s_sub_u32 s53,s53,s59
s_lshl_b32 s53,s53,7
s_lshl_b32 s59,s30,4
SADD s59,s59,s53
s_mul_i32 s34,s59,3840
SADD s34,s34,s55
s_mul_i32 s53,s59,3456
SADD s39,s53,s56
SADD s44,s53,s58
SADD s53,s31,3
s_cmp_ge_u32 s53,5
s_cselect_b32 s59,5,0
s_sub_u32 s53,s53,s59
s_lshl_b32 s53,s53,7
s_lshl_b32 s59,s30,4
SADD s59,s59,s53
s_mul_i32 s35,s59,3840
SADD s35,s35,s55
s_mul_i32 s53,s59,3456
SADD s40,s53,s56
SADD s45,s53,s58
SADD s53,s31,4
s_cmp_ge_u32 s53,5
s_cselect_b32 s59,5,0
s_sub_u32 s53,s53,s59
s_lshl_b32 s53,s53,7
s_lshl_b32 s59,s30,4
SADD s59,s59,s53
s_mul_i32 s36,s59,3840
SADD s36,s36,s55
s_mul_i32 s53,s59,3456
SADD m0,s51,67584
s_nop 0
BL4 v250,s[4:7],s86 offen lds
SADD s41,s53,s56
SADD s46,s53,s58
s_lshl_b32 s47,s30,12
v_lshrrev_b32 v242,3,v241
v_lshrrev_b32 v243,4,v241
AND v243,1,v243
SHL v243,2,v243
AND v244,7,v241
v_xor_b32 v243,v243,v244
SHL v243,4,v243
v_mul_u32_u24 v244,3840,v242
v_add_u32 v244,v244,v243
v_add_u32 v228,4096,v244
v_add_u32 v229,33792,v244
v_add_u32 v230,2048,v244
v_add_u32 v231,31744,v244
v_lshrrev_b32 v242,5,v241
SHL v242,3,v242
v_bfe_u32 v243,v241,2,2
v_add_u32 v242,v242,v243
SHL v242,7,v242
v_bfe_u32 v244,v241,4,1
v_lshl_add_u32 v242,v244,5,v242
AND v244,3,v241
v_lshl_add_u32 v242,v244,3,v242
s_lshl_b32 s53,s48,12
v_add_u32 v242,s53,v242
v_lshrrev_b32 v243,1,v243
v_xor_b32 v243,s48,v243
v_lshl_add_u32 v226,v243,6,v242
v_xor_b32 v243,1,v243
v_lshl_add_u32 v227,v243,6,v242
AND v242,31,v241
v_lshrrev_b32 v243,2,v242
SHL v243,10,v243
AND v244,3,v242
v_lshl_add_u32 v243,v244,8,v243
AND v244,15,v242
v_lshrrev_b32 v245,5,v241
v_xor_b32 v244,v244,v245
v_lshl_add_u32 v243,v244,4,v243
s_lshl_b32 s53,s49,13
v_add_u32 v243,s53,v243
s_lshl_b32 s53,s48,5
v_xor_b32 v243,s53,v243
SADD m0,s51,68608
s_nop 0
BL4 v251,s[4:7],s86 offen lds
v_xor_b32 v208,0,v243
v_xor_b32 v209,64,v243
v_xor_b32 v210,128,v243
v_xor_b32 v211,192,v243
v_mov_b32 v212,0
v_mov_b32 v213,0
v_mov_b32 v214,0
v_mov_b32 v215,0
v_mov_b32 v216,0
v_mov_b32 v217,0
v_mov_b32 v218,0
v_mov_b32 v219,0
v_cmp_eq_u32 vcc,63,v241
v_mov_b32 v235,0x80000000
v_mov_b32 v246,0
v_cndmask_b32 v235,v235,v246,vcc
v_lshrrev_b32 v237,5,v241
v_mul_u32_u24 v237,10368,v237
AND v236,31,v241
v_lshl_add_u32 v236,v236,4,v237
v_add_u32 v237,20736,v236
s_cmp_eq_u32 s62,0
s_cselect_b32 s59,0x3ea52b5c,1.0
s_cselect_b32 s58,5120,0
s_lshl_b32 s53,s63,10
SADD s58,s58,s53
s_lshl_b32 s53,s48,8
SADD s58,s58,s53
s_lshl_b32 s53,s57,2
SADD s58,s58,s53
SADD s58,s58,20856832
s_lshl_b32 s53,s30,12
SADD s53,s53,131072
v_add_u32 v238,s53,v234
s_xor_b32 s53,s30,4
s_lshl_b32 s53,s53,12
SADD s53,s53,131072
v_add_u32 v239,s53,v234
s_mov_b32 s50,0x3f803f80
s_cmp_ge_u32 s29,12
s_cselect_b32 s42,0x7ff00000,s42
s_cselect_b32 s43,0x7ff00000,s43
s_cselect_b32 s44,0x7ff00000,s44
s_cselect_b32 s45,0x7ff00000,s45
s_cselect_b32 s46,0x7ff00000,s46
WT vmcnt(8)
s_barrier
R128 v[0:3],v208 offset:0
R128 v[4:7],v209 offset:0
R128 v[8:11],v210 offset:0
R128 v[12:15],v211 offset:0
WT lgkmcnt(0)
SADD m0,s51,98304
s_nop 0
BL4 v248,s[4:7],s87 offen lds
DOT v212,v0,s50,v212
DOT v216,v0,v0,v216
DOT v213,v1,s50,v213
DOT v217,v1,v1,v217
DOT v214,v2,s50,v214
DOT v218,v2,v2,v218
DOT v215,v3,s50,v215
DOT v219,v3,v3,v219
SADD m0,s51,99328
s_nop 0
BL4 v249,s[4:7],s87 offen lds
DOT v212,v4,s50,v212
DOT v216,v4,v4,v216
DOT v213,v5,s50,v213
DOT v217,v5,v5,v217
DOT v214,v6,s50,v214
DOT v218,v6,v6,v218
DOT v215,v7,s50,v215
DOT v219,v7,v7,v219
SADD m0,s51,100352
s_nop 0
BL4 v250,s[4:7],s87 offen lds
DOT v212,v8,s50,v212
DOT v216,v8,v8,v216
DOT v213,v9,s50,v213
DOT v217,v9,v9,v217
DOT v214,v10,s50,v214
DOT v218,v10,v10,v218
DOT v215,v11,s50,v215
DOT v219,v11,v11,v219
SADD m0,s51,101376
s_nop 0
BL4 v251,s[4:7],s87 offen lds
DOT v212,v12,s50,v212
DOT v216,v12,v12,v216
DOT v213,v13,s50,v213
DOT v217,v13,v13,v217
DOT v214,v14,s50,v214
DOT v218,v14,v14,v218
DOT v215,v15,s50,v215
DOT v219,v15,v15,v219
WT vmcnt(8)
s_barrier
R128 v[16:19],v208 offset:32768
R128 v[20:23],v209 offset:32768
R128 v[24:27],v210 offset:32768
R128 v[28:31],v211 offset:32768
WT lgkmcnt(0)
SADD m0,s51,131072
s_nop 0
BL4 v248,s[4:7],s88 offen lds
DOT v212,v16,s50,v212
DOT v216,v16,v16,v216
DOT v213,v17,s50,v213
DOT v217,v17,v17,v217
DOT v214,v18,s50,v214
DOT v218,v18,v18,v218
DOT v215,v19,s50,v215
DOT v219,v19,v19,v219
SADD m0,s51,132096
s_nop 0
BL4 v249,s[4:7],s88 offen lds
DOT v212,v20,s50,v212
DOT v216,v20,v20,v216
DOT v213,v21,s50,v213
DOT v217,v21,v21,v217
DOT v214,v22,s50,v214
DOT v218,v22,v22,v218
DOT v215,v23,s50,v215
DOT v219,v23,v23,v219
SADD m0,s51,133120
s_nop 0
BL4 v250,s[4:7],s88 offen lds
DOT v212,v24,s50,v212
DOT v216,v24,v24,v216
DOT v213,v25,s50,v213
DOT v217,v25,v25,v217
DOT v214,v26,s50,v214
DOT v218,v26,v26,v218
DOT v215,v27,s50,v215
DOT v219,v27,v27,v219
SADD m0,s51,134144
s_nop 0
BL4 v251,s[4:7],s88 offen lds
DOT v212,v28,s50,v212
DOT v216,v28,v28,v216
DOT v213,v29,s50,v213
DOT v217,v29,v29,v217
DOT v214,v30,s50,v214
DOT v218,v30,v30,v218
DOT v215,v31,s50,v215
DOT v219,v31,v31,v219
WT vmcnt(8)
s_barrier
v_add_u32 v208,65536,v208
v_add_u32 v209,65536,v209
v_add_u32 v210,65536,v210
v_add_u32 v211,65536,v211
R128 v[32:35],v208 offset:0
R128 v[36:39],v209 offset:0
R128 v[40:43],v210 offset:0
R128 v[44:47],v211 offset:0
WT lgkmcnt(0)
SADD m0,s47,0
s_nop 0
BL4 v228,s[8:11],s32 offen lds
DOT v212,v32,s50,v212
DOT v216,v32,v32,v216
DOT v213,v33,s50,v213
DOT v217,v33,v33,v217
DOT v214,v34,s50,v214
DOT v218,v34,v34,v218
DOT v215,v35,s50,v215
DOT v219,v35,v35,v219
BL4 v229,s[8:11],s32 offen offset:1024 lds
DOT v212,v36,s50,v212
DOT v216,v36,v36,v216
DOT v213,v37,s50,v213
DOT v217,v37,v37,v217
DOT v214,v38,s50,v214
DOT v218,v38,v38,v218
DOT v215,v39,s50,v215
DOT v219,v39,v39,v219
BL4 v230,s[12:15],s32 offen offset:2048 lds
DOT v212,v40,s50,v212
DOT v216,v40,v40,v216
DOT v213,v41,s50,v213
DOT v217,v41,v41,v217
DOT v214,v42,s50,v214
DOT v218,v42,v42,v218
DOT v215,v43,s50,v215
DOT v219,v43,v43,v219
BL4 v231,s[12:15],s32 offen offset:3072 lds
DOT v212,v44,s50,v212
DOT v216,v44,v44,v216
DOT v213,v45,s50,v213
DOT v217,v45,v45,v217
DOT v214,v46,s50,v214
DOT v218,v46,v46,v218
DOT v215,v47,s50,v215
DOT v219,v47,v47,v219
WT vmcnt(8)
s_barrier
R128 v[48:51],v208 offset:32768
R128 v[52:55],v209 offset:32768
R128 v[56:59],v210 offset:32768
R128 v[60:63],v211 offset:32768
WT lgkmcnt(0)
SADD m0,s47,32768
s_nop 0
BL4 v228,s[8:11],s33 offen lds
DOT v212,v48,s50,v212
DOT v216,v48,v48,v216
DOT v213,v49,s50,v213
DOT v217,v49,v49,v217
DOT v214,v50,s50,v214
DOT v218,v50,v50,v218
DOT v215,v51,s50,v215
DOT v219,v51,v51,v219
BL4 v229,s[8:11],s33 offen offset:1024 lds
DOT v212,v52,s50,v212
DOT v216,v52,v52,v216
DOT v213,v53,s50,v213
DOT v217,v53,v53,v217
DOT v214,v54,s50,v214
DOT v218,v54,v54,v218
DOT v215,v55,s50,v215
DOT v219,v55,v55,v219
BL4 v230,s[12:15],s33 offen offset:2048 lds
DOT v212,v56,s50,v212
DOT v216,v56,v56,v216
DOT v213,v57,s50,v213
DOT v217,v57,v57,v217
DOT v214,v58,s50,v214
DOT v218,v58,v58,v218
DOT v215,v59,s50,v215
DOT v219,v59,v59,v219
BL4 v231,s[12:15],s33 offen offset:3072 lds
DOT v212,v60,s50,v212
DOT v216,v60,v60,v216
DOT v213,v61,s50,v213
DOT v217,v61,v61,v217
DOT v214,v62,s50,v214
DOT v218,v62,v62,v218
DOT v215,v63,s50,v215
DOT v219,v63,v63,v219
WT vmcnt(8)
s_barrier
v_add_u32 v208,65536,v208
v_add_u32 v209,65536,v209
v_add_u32 v210,65536,v210
v_add_u32 v211,65536,v211
R128 v[64:67],v208 offset:0
R128 v[68:71],v209 offset:0
R128 v[72:75],v210 offset:0
R128 v[76:79],v211 offset:0
WT lgkmcnt(0)
DOT v212,v64,s50,v212
DOT v216,v64,v64,v216
DOT v213,v65,s50,v213
DOT v217,v65,v65,v217
DOT v214,v66,s50,v214
DOT v218,v66,v66,v218
DOT v215,v67,s50,v215
DOT v219,v67,v67,v219
DOT v212,v68,s50,v212
DOT v216,v68,v68,v216
DOT v213,v69,s50,v213
DOT v217,v69,v69,v217
DOT v214,v70,s50,v214
DOT v218,v70,v70,v218
DOT v215,v71,s50,v215
DOT v219,v71,v71,v219
DOT v212,v72,s50,v212
DOT v216,v72,v72,v216
DOT v213,v73,s50,v213
DOT v217,v73,v73,v217
DOT v214,v74,s50,v214
DOT v218,v74,v74,v218
DOT v215,v75,s50,v215
DOT v219,v75,v75,v219
DOT v212,v76,s50,v212
DOT v216,v76,v76,v216
DOT v213,v77,s50,v213
DOT v217,v77,v77,v217
DOT v214,v78,s50,v214
DOT v218,v78,v78,v218
DOT v215,v79,s50,v215
DOT v219,v79,v79,v219
ADD v212,v212,v213
s_nop 0
ADD v214,v214,v215
ADD v216,v216,v217
ADD v218,v218,v219
ADD v212,v212,v214
ADD v213,v216,v218
v_mov_b32 v216,v212
v_mov_b32 v217,v213
s_nop 0
v_permlane32_swap_b32 v216,v212
v_permlane32_swap_b32 v217,v213
ADD v212,v212,v216
ADD v213,v213,v217
s_barrier
v_lshrrev_b32 v240,1,v234
s_lshl_b32 s53,s30,9
SADD s53,s53,131072
v_add_u32 v242,s53,v240
ds_write_b64 v242,v[212:213]
s_xor_b32 s53,s30,4
s_lshl_b32 s53,s53,9
SADD s53,s53,131072
v_add_u32 v242,s53,v240
WT lgkmcnt(0)
s_barrier
ds_read_b64 v[216:217],v242
WT lgkmcnt(0)
ADD v212,v212,v216
ADD v216,v213,v217
MUL v212,0x3acccccd,v212
MUL v216,0x3acccccd,v216
FMA v216,-v212,v212,v216
v_max_f32 v216,0,v216
ADD v216,0x3727c5ac,v216
v_rsq_f32 v232,v216
s_nop 0
MUL v233,v212,v232
v_sub_f32 v233,0,v233
s_load_dwordx2 s[64:65],s[0:1],64
WT lgkmcnt(0)
s_mov_b32 s66,256
s_mov_b32 s67,131072
SHL v248,16,v0
SHL v250,16,v1
SHL v252,16,v2
SHL v254,16,v3
AND v249,0xffff0000,v0
AND v251,0xffff0000,v1
AND v253,0xffff0000,v2
AND v255,0xffff0000,v3
FMA v248,v248,v232,v233
FMA v250,v250,v232,v233
FMA v252,v252,v232,v233
FMA v254,v254,v232,v233
FMA v249,v249,v232,v233
FMA v251,v251,v232,v233
FMA v253,v253,v232,v233
FMA v255,v255,v232,v233
CV v0,v248,v249
CV v1,v250,v251
CV v2,v252,v253
CV v3,v254,v255
SHL v248,16,v4
SHL v250,16,v5
SHL v252,16,v6
SHL v254,16,v7
AND v249,0xffff0000,v4
AND v251,0xffff0000,v5
AND v253,0xffff0000,v6
AND v255,0xffff0000,v7
FMA v248,v248,v232,v233
FMA v250,v250,v232,v233
FMA v252,v252,v232,v233
FMA v254,v254,v232,v233
FMA v249,v249,v232,v233
FMA v251,v251,v232,v233
FMA v253,v253,v232,v233
FMA v255,v255,v232,v233
CV v4,v248,v249
CV v5,v250,v251
CV v6,v252,v253
CV v7,v254,v255
SHL v248,16,v8
SHL v250,16,v9
SHL v252,16,v10
SHL v254,16,v11
AND v249,0xffff0000,v8
AND v251,0xffff0000,v9
AND v253,0xffff0000,v10
AND v255,0xffff0000,v11
FMA v248,v248,v232,v233
FMA v250,v250,v232,v233
FMA v252,v252,v232,v233
FMA v254,v254,v232,v233
FMA v249,v249,v232,v233
FMA v251,v251,v232,v233
FMA v253,v253,v232,v233
FMA v255,v255,v232,v233
CV v8,v248,v249
CV v9,v250,v251
CV v10,v252,v253
CV v11,v254,v255
SHL v248,16,v12
SHL v250,16,v13
SHL v252,16,v14
SHL v254,16,v15
AND v249,0xffff0000,v12
AND v251,0xffff0000,v13
AND v253,0xffff0000,v14
AND v255,0xffff0000,v15
FMA v248,v248,v232,v233
FMA v250,v250,v232,v233
FMA v252,v252,v232,v233
FMA v254,v254,v232,v233
FMA v249,v249,v232,v233
FMA v251,v251,v232,v233
FMA v253,v253,v232,v233
FMA v255,v255,v232,v233
CV v12,v248,v249
CV v13,v250,v251
CV v14,v252,v253
CV v15,v254,v255
WT vmcnt(4)
s_barrier
v_mov_b32 v224,v226
v_mov_b32 v225,v227
TR v[208:209],v224 offset:0
TR v[210:211],v224 offset:512
TR v[212:213],v224 offset:2048
TR v[214:215],v224 offset:2560
TR v[216:217],v225 offset:0
TR v[218:219],v225 offset:512
TR v[220:221],v225 offset:2048
TR v[222:223],v225 offset:2560
s_cmp_eq_u32 s62,2
s_cbranch_scc1 K1_v
WT lgkmcnt(4)
M32 v[80:95],v[208:211],v[0:3],0
TR v[208:209],v224 offset:8192
TR v[210:211],v224 offset:8704
SHL v248,16,v16
SHL v250,16,v17
SHL v252,16,v18
SHL v254,16,v19
AND v249,0xffff0000,v16
M32 v[96:111],v[212:215],v[0:3],0
TR v[212:213],v224 offset:10240
TR v[214:215],v224 offset:10752
SADD m0,s47,65536
AND v251,0xffff0000,v17
AND v253,0xffff0000,v18
AND v255,0xffff0000,v19
FMA v248,v248,v232,v233
FMA v250,v250,v232,v233
WT lgkmcnt(4)
M32 v[112:127],v[216:219],v[0:3],0
TR v[216:217],v225 offset:8192
TR v[218:219],v225 offset:8704
FMA v252,v252,v232,v233
FMA v254,v254,v232,v233
FMA v249,v249,v232,v233
FMA v251,v251,v232,v233
FMA v253,v253,v232,v233
M32 v[128:143],v[220:223],v[0:3],0
TR v[220:221],v225 offset:10240
TR v[222:223],v225 offset:10752
BL4 v228,s[8:11],s34 offen lds
FMA v255,v255,v232,v233
CV v16,v248,v249
CV v17,v250,v251
CV v18,v252,v253
CV v19,v254,v255
WT lgkmcnt(4)
M32 v[80:95],v[208:211],v[4:7],v[80:95]
TR v[208:209],v224 offset:16384
TR v[210:211],v224 offset:16896
SHL v248,16,v20
SHL v250,16,v21
SHL v252,16,v22
SHL v254,16,v23
AND v249,0xffff0000,v20
M32 v[96:111],v[212:215],v[4:7],v[96:111]
TR v[212:213],v224 offset:18432
TR v[214:215],v224 offset:18944
BL4 v229,s[8:11],s34 offen offset:1024 lds
AND v251,0xffff0000,v21
AND v253,0xffff0000,v22
AND v255,0xffff0000,v23
FMA v248,v248,v232,v233
FMA v250,v250,v232,v233
WT lgkmcnt(4)
M32 v[112:127],v[216:219],v[4:7],v[112:127]
TR v[216:217],v225 offset:16384
TR v[218:219],v225 offset:16896
FMA v252,v252,v232,v233
FMA v254,v254,v232,v233
FMA v249,v249,v232,v233
FMA v251,v251,v232,v233
FMA v253,v253,v232,v233
M32 v[128:143],v[220:223],v[4:7],v[128:143]
TR v[220:221],v225 offset:18432
TR v[222:223],v225 offset:18944
BL4 v230,s[12:15],s34 offen offset:2048 lds
FMA v255,v255,v232,v233
CV v20,v248,v249
CV v21,v250,v251
CV v22,v252,v253
CV v23,v254,v255
WT lgkmcnt(4)
M32 v[80:95],v[208:211],v[8:11],v[80:95]
TR v[208:209],v224 offset:24576
TR v[210:211],v224 offset:25088
SHL v248,16,v24
SHL v250,16,v25
SHL v252,16,v26
SHL v254,16,v27
AND v249,0xffff0000,v24
M32 v[96:111],v[212:215],v[8:11],v[96:111]
TR v[212:213],v224 offset:26624
TR v[214:215],v224 offset:27136
BL4 v231,s[12:15],s34 offen offset:3072 lds
AND v251,0xffff0000,v25
AND v253,0xffff0000,v26
AND v255,0xffff0000,v27
FMA v248,v248,v232,v233
FMA v250,v250,v232,v233
WT lgkmcnt(4)
M32 v[112:127],v[216:219],v[8:11],v[112:127]
TR v[216:217],v225 offset:24576
TR v[218:219],v225 offset:25088
FMA v252,v252,v232,v233
FMA v254,v254,v232,v233
FMA v249,v249,v232,v233
FMA v251,v251,v232,v233
FMA v253,v253,v232,v233
M32 v[128:143],v[220:223],v[8:11],v[128:143]
TR v[220:221],v225 offset:26624
TR v[222:223],v225 offset:27136
FMA v255,v255,v232,v233
CV v24,v248,v249
CV v25,v250,v251
CV v26,v252,v253
CV v27,v254,v255
WT lgkmcnt(4)
M32 v[80:95],v[208:211],v[12:15],v[80:95]
WT vmcnt(4)
s_barrier
v_add_u32 v224,32768,v226
v_add_u32 v225,32768,v227
TR v[208:209],v224 offset:0
TR v[210:211],v224 offset:512
SHL v248,16,v28
SHL v250,16,v29
SHL v252,16,v30
SHL v254,16,v31
AND v249,0xffff0000,v28
M32 v[96:111],v[212:215],v[12:15],v[96:111]
TR v[212:213],v224 offset:2048
TR v[214:215],v224 offset:2560
AND v251,0xffff0000,v29
AND v253,0xffff0000,v30
AND v255,0xffff0000,v31
FMA v248,v248,v232,v233
FMA v250,v250,v232,v233
WT lgkmcnt(4)
M32 v[112:127],v[216:219],v[12:15],v[112:127]
TR v[216:217],v225 offset:0
TR v[218:219],v225 offset:512
FMA v252,v252,v232,v233
FMA v254,v254,v232,v233
FMA v249,v249,v232,v233
FMA v251,v251,v232,v233
FMA v253,v253,v232,v233
M32 v[128:143],v[220:223],v[12:15],v[128:143]
TR v[220:221],v225 offset:2048
TR v[222:223],v225 offset:2560
FMA v255,v255,v232,v233
CV v28,v248,v249
CV v29,v250,v251
CV v30,v252,v253
CV v31,v254,v255
WT lgkmcnt(4)
M32 v[80:95],v[208:211],v[16:19],v[80:95]
TR v[208:209],v224 offset:8192
TR v[210:211],v224 offset:8704
SHL v248,16,v32
SHL v250,16,v33
SHL v252,16,v34
SHL v254,16,v35
AND v249,0xffff0000,v32
M32 v[96:111],v[212:215],v[16:19],v[96:111]
TR v[212:213],v224 offset:10240
TR v[214:215],v224 offset:10752
SADD m0,s47,98304
AND v251,0xffff0000,v33
AND v253,0xffff0000,v34
AND v255,0xffff0000,v35
FMA v248,v248,v232,v233
FMA v250,v250,v232,v233
WT lgkmcnt(4)
M32 v[112:127],v[216:219],v[16:19],v[112:127]
TR v[216:217],v225 offset:8192
TR v[218:219],v225 offset:8704
FMA v252,v252,v232,v233
FMA v254,v254,v232,v233
FMA v249,v249,v232,v233
FMA v251,v251,v232,v233
FMA v253,v253,v232,v233
M32 v[128:143],v[220:223],v[16:19],v[128:143]
TR v[220:221],v225 offset:10240
TR v[222:223],v225 offset:10752
BL4 v228,s[8:11],s35 offen lds
FMA v255,v255,v232,v233
CV v32,v248,v249
CV v33,v250,v251
CV v34,v252,v253
CV v35,v254,v255
WT lgkmcnt(4)
M32 v[80:95],v[208:211],v[20:23],v[80:95]
TR v[208:209],v224 offset:16384
TR v[210:211],v224 offset:16896
SHL v248,16,v36
SHL v250,16,v37
SHL v252,16,v38
SHL v254,16,v39
AND v249,0xffff0000,v36
M32 v[96:111],v[212:215],v[20:23],v[96:111]
TR v[212:213],v224 offset:18432
TR v[214:215],v224 offset:18944
BL4 v229,s[8:11],s35 offen offset:1024 lds
AND v251,0xffff0000,v37
AND v253,0xffff0000,v38
AND v255,0xffff0000,v39
FMA v248,v248,v232,v233
FMA v250,v250,v232,v233
WT lgkmcnt(4)
M32 v[112:127],v[216:219],v[20:23],v[112:127]
TR v[216:217],v225 offset:16384
TR v[218:219],v225 offset:16896
FMA v252,v252,v232,v233
FMA v254,v254,v232,v233
FMA v249,v249,v232,v233
FMA v251,v251,v232,v233
FMA v253,v253,v232,v233
M32 v[128:143],v[220:223],v[20:23],v[128:143]
TR v[220:221],v225 offset:18432
TR v[222:223],v225 offset:18944
BL4 v230,s[12:15],s35 offen offset:2048 lds
FMA v255,v255,v232,v233
CV v36,v248,v249
CV v37,v250,v251
CV v38,v252,v253
CV v39,v254,v255
WT lgkmcnt(4)
M32 v[80:95],v[208:211],v[24:27],v[80:95]
TR v[208:209],v224 offset:24576
TR v[210:211],v224 offset:25088
SHL v248,16,v40
SHL v250,16,v41
SHL v252,16,v42
SHL v254,16,v43
AND v249,0xffff0000,v40
M32 v[96:111],v[212:215],v[24:27],v[96:111]
TR v[212:213],v224 offset:26624
TR v[214:215],v224 offset:27136
BL4 v231,s[12:15],s35 offen offset:3072 lds
AND v251,0xffff0000,v41
AND v253,0xffff0000,v42
AND v255,0xffff0000,v43
FMA v248,v248,v232,v233
FMA v250,v250,v232,v233
WT lgkmcnt(4)
M32 v[112:127],v[216:219],v[24:27],v[112:127]
TR v[216:217],v225 offset:24576
TR v[218:219],v225 offset:25088
FMA v252,v252,v232,v233
FMA v254,v254,v232,v233
FMA v249,v249,v232,v233
FMA v251,v251,v232,v233
FMA v253,v253,v232,v233
M32 v[128:143],v[220:223],v[24:27],v[128:143]
TR v[220:221],v225 offset:26624
TR v[222:223],v225 offset:27136
FMA v255,v255,v232,v233
CV v40,v248,v249
CV v41,v250,v251
CV v42,v252,v253
CV v43,v254,v255
WT lgkmcnt(4)
M32 v[80:95],v[208:211],v[28:31],v[80:95]
WT vmcnt(4)
s_barrier
v_add_u32 v224,65536,v226
v_add_u32 v225,65536,v227
TR v[208:209],v224 offset:0
TR v[210:211],v224 offset:512
SHL v248,16,v44
SHL v250,16,v45
SHL v252,16,v46
SHL v254,16,v47
AND v249,0xffff0000,v44
M32 v[96:111],v[212:215],v[28:31],v[96:111]
TR v[212:213],v224 offset:2048
TR v[214:215],v224 offset:2560
AND v251,0xffff0000,v45
AND v253,0xffff0000,v46
AND v255,0xffff0000,v47
FMA v248,v248,v232,v233
FMA v250,v250,v232,v233
WT lgkmcnt(4)
M32 v[112:127],v[216:219],v[28:31],v[112:127]
TR v[216:217],v225 offset:0
TR v[218:219],v225 offset:512
FMA v252,v252,v232,v233
FMA v254,v254,v232,v233
FMA v249,v249,v232,v233
FMA v251,v251,v232,v233
FMA v253,v253,v232,v233
M32 v[128:143],v[220:223],v[28:31],v[128:143]
TR v[220:221],v225 offset:2048
TR v[222:223],v225 offset:2560
FMA v255,v255,v232,v233
CV v44,v248,v249
CV v45,v250,v251
CV v46,v252,v253
CV v47,v254,v255
WT lgkmcnt(4)
M32 v[80:95],v[208:211],v[32:35],v[80:95]
TR v[208:209],v224 offset:8192
TR v[210:211],v224 offset:8704
SHL v248,16,v48
SHL v250,16,v49
SHL v252,16,v50
SHL v254,16,v51
AND v249,0xffff0000,v48
M32 v[96:111],v[212:215],v[32:35],v[96:111]
TR v[212:213],v224 offset:10240
TR v[214:215],v224 offset:10752
SADD m0,s47,0
AND v251,0xffff0000,v49
AND v253,0xffff0000,v50
AND v255,0xffff0000,v51
FMA v248,v248,v232,v233
FMA v250,v250,v232,v233
WT lgkmcnt(4)
M32 v[112:127],v[216:219],v[32:35],v[112:127]
TR v[216:217],v225 offset:8192
TR v[218:219],v225 offset:8704
FMA v252,v252,v232,v233
FMA v254,v254,v232,v233
FMA v249,v249,v232,v233
FMA v251,v251,v232,v233
FMA v253,v253,v232,v233
M32 v[128:143],v[220:223],v[32:35],v[128:143]
TR v[220:221],v225 offset:10240
TR v[222:223],v225 offset:10752
BL4 v228,s[8:11],s36 offen lds
FMA v255,v255,v232,v233
CV v48,v248,v249
CV v49,v250,v251
CV v50,v252,v253
CV v51,v254,v255
WT lgkmcnt(4)
M32 v[80:95],v[208:211],v[36:39],v[80:95]
TR v[208:209],v224 offset:16384
TR v[210:211],v224 offset:16896
SHL v248,16,v52
SHL v250,16,v53
SHL v252,16,v54
SHL v254,16,v55
AND v249,0xffff0000,v52
M32 v[96:111],v[212:215],v[36:39],v[96:111]
TR v[212:213],v224 offset:18432
TR v[214:215],v224 offset:18944
BL4 v229,s[8:11],s36 offen offset:1024 lds
AND v251,0xffff0000,v53
AND v253,0xffff0000,v54
AND v255,0xffff0000,v55
FMA v248,v248,v232,v233
FMA v250,v250,v232,v233
WT lgkmcnt(4)
M32 v[112:127],v[216:219],v[36:39],v[112:127]
TR v[216:217],v225 offset:16384
TR v[218:219],v225 offset:16896
FMA v252,v252,v232,v233
FMA v254,v254,v232,v233
FMA v249,v249,v232,v233
FMA v251,v251,v232,v233
FMA v253,v253,v232,v233
M32 v[128:143],v[220:223],v[36:39],v[128:143]
TR v[220:221],v225 offset:18432
TR v[222:223],v225 offset:18944
BL4 v230,s[12:15],s36 offen offset:2048 lds
FMA v255,v255,v232,v233
CV v52,v248,v249
CV v53,v250,v251
CV v54,v252,v253
CV v55,v254,v255
WT lgkmcnt(4)
M32 v[80:95],v[208:211],v[40:43],v[80:95]
TR v[208:209],v224 offset:24576
TR v[210:211],v224 offset:25088
SHL v248,16,v56
SHL v250,16,v57
SHL v252,16,v58
SHL v254,16,v59
AND v249,0xffff0000,v56
M32 v[96:111],v[212:215],v[40:43],v[96:111]
TR v[212:213],v224 offset:26624
TR v[214:215],v224 offset:27136
BL4 v231,s[12:15],s36 offen offset:3072 lds
AND v251,0xffff0000,v57
AND v253,0xffff0000,v58
AND v255,0xffff0000,v59
FMA v248,v248,v232,v233
FMA v250,v250,v232,v233
WT lgkmcnt(4)
M32 v[112:127],v[216:219],v[40:43],v[112:127]
TR v[216:217],v225 offset:24576
TR v[218:219],v225 offset:25088
FMA v252,v252,v232,v233
FMA v254,v254,v232,v233
FMA v249,v249,v232,v233
FMA v251,v251,v232,v233
FMA v253,v253,v232,v233
M32 v[128:143],v[220:223],v[40:43],v[128:143]
TR v[220:221],v225 offset:26624
TR v[222:223],v225 offset:27136
FMA v255,v255,v232,v233
CV v56,v248,v249
CV v57,v250,v251
CV v58,v252,v253
CV v59,v254,v255
WT lgkmcnt(4)
M32 v[80:95],v[208:211],v[44:47],v[80:95]
WT vmcnt(4)
s_barrier
v_add_u32 v224,98304,v226
v_add_u32 v225,98304,v227
TR v[208:209],v224 offset:0
TR v[210:211],v224 offset:512
SHL v248,16,v60
SHL v250,16,v61
SHL v252,16,v62
SHL v254,16,v63
AND v249,0xffff0000,v60
M32 v[96:111],v[212:215],v[44:47],v[96:111]
TR v[212:213],v224 offset:2048
TR v[214:215],v224 offset:2560
AND v251,0xffff0000,v61
AND v253,0xffff0000,v62
AND v255,0xffff0000,v63
FMA v248,v248,v232,v233
FMA v250,v250,v232,v233
WT lgkmcnt(4)
M32 v[112:127],v[216:219],v[44:47],v[112:127]
TR v[216:217],v225 offset:0
TR v[218:219],v225 offset:512
FMA v252,v252,v232,v233
FMA v254,v254,v232,v233
FMA v249,v249,v232,v233
FMA v251,v251,v232,v233
FMA v253,v253,v232,v233
M32 v[128:143],v[220:223],v[44:47],v[128:143]
TR v[220:221],v225 offset:2048
TR v[222:223],v225 offset:2560
FMA v255,v255,v232,v233
CV v60,v248,v249
CV v61,v250,v251
CV v62,v252,v253
CV v63,v254,v255
WT lgkmcnt(4)
M32 v[80:95],v[208:211],v[48:51],v[80:95]
TR v[208:209],v224 offset:8192
TR v[210:211],v224 offset:8704
SHL v248,16,v64
SHL v250,16,v65
SHL v252,16,v66
SHL v254,16,v67
AND v249,0xffff0000,v64
M32 v[96:111],v[212:215],v[48:51],v[96:111]
TR v[212:213],v224 offset:10240
TR v[214:215],v224 offset:10752
v_lshrrev_b32 v247,7,v234
v_mul_u32_u24 v247,384,v247
AND v251,0xffff0000,v65
AND v253,0xffff0000,v66
AND v255,0xffff0000,v67
FMA v248,v248,v232,v233
FMA v250,v250,v232,v233
WT lgkmcnt(4)
M32 v[112:127],v[216:219],v[48:51],v[112:127]
TR v[216:217],v225 offset:8192
TR v[218:219],v225 offset:8704
FMA v252,v252,v232,v233
FMA v254,v254,v232,v233
FMA v249,v249,v232,v233
FMA v251,v251,v232,v233
FMA v253,v253,v232,v233
M32 v[128:143],v[220:223],v[48:51],v[128:143]
TR v[220:221],v225 offset:10240
TR v[222:223],v225 offset:10752
v_sub_u32 v228,v228,v247
v_sub_u32 v229,v229,v247
FMA v255,v255,v232,v233
CV v64,v248,v249
CV v65,v250,v251
CV v66,v252,v253
CV v67,v254,v255
WT lgkmcnt(4)
M32 v[80:95],v[208:211],v[52:55],v[80:95]
TR v[208:209],v224 offset:16384
TR v[210:211],v224 offset:16896
SHL v248,16,v68
SHL v250,16,v69
SHL v252,16,v70
SHL v254,16,v71
AND v249,0xffff0000,v68
M32 v[96:111],v[212:215],v[52:55],v[96:111]
TR v[212:213],v224 offset:18432
TR v[214:215],v224 offset:18944
v_subrev_u32 v229,3072,v229
v_sub_u32 v230,v230,v247
AND v251,0xffff0000,v69
AND v253,0xffff0000,v70
AND v255,0xffff0000,v71
FMA v248,v248,v232,v233
FMA v250,v250,v232,v233
WT lgkmcnt(4)
M32 v[112:127],v[216:219],v[52:55],v[112:127]
TR v[216:217],v225 offset:16384
TR v[218:219],v225 offset:16896
FMA v252,v252,v232,v233
FMA v254,v254,v232,v233
FMA v249,v249,v232,v233
FMA v251,v251,v232,v233
FMA v253,v253,v232,v233
M32 v[128:143],v[220:223],v[52:55],v[128:143]
TR v[220:221],v225 offset:18432
TR v[222:223],v225 offset:18944
v_sub_u32 v231,v231,v247
v_subrev_u32 v231,3072,v231
FMA v255,v255,v232,v233
CV v68,v248,v249
CV v69,v250,v251
CV v70,v252,v253
CV v71,v254,v255
WT lgkmcnt(4)
M32 v[80:95],v[208:211],v[56:59],v[80:95]
TR v[208:209],v224 offset:24576
TR v[210:211],v224 offset:25088
SHL v248,16,v72
SHL v250,16,v73
SHL v252,16,v74
SHL v254,16,v75
AND v249,0xffff0000,v72
M32 v[96:111],v[212:215],v[56:59],v[96:111]
TR v[212:213],v224 offset:26624
TR v[214:215],v224 offset:27136
SADD m0,s47,32768
AND v251,0xffff0000,v73
AND v253,0xffff0000,v74
AND v255,0xffff0000,v75
FMA v248,v248,v232,v233
FMA v250,v250,v232,v233
WT lgkmcnt(4)
M32 v[112:127],v[216:219],v[56:59],v[112:127]
TR v[216:217],v225 offset:24576
TR v[218:219],v225 offset:25088
FMA v252,v252,v232,v233
FMA v254,v254,v232,v233
FMA v249,v249,v232,v233
FMA v251,v251,v232,v233
FMA v253,v253,v232,v233
M32 v[128:143],v[220:223],v[56:59],v[128:143]
TR v[220:221],v225 offset:26624
TR v[222:223],v225 offset:27136
BL4 v228,s[16:19],s37 offen lds
FMA v255,v255,v232,v233
CV v72,v248,v249
CV v73,v250,v251
CV v74,v252,v253
CV v75,v254,v255
WT lgkmcnt(4)
M32 v[80:95],v[208:211],v[60:63],v[80:95]
WT vmcnt(1)
s_barrier
v_mov_b32 v224,v226
v_mov_b32 v225,v227
TR v[208:209],v224 offset:0
TR v[210:211],v224 offset:512
SHL v248,16,v76
SHL v250,16,v77
SHL v252,16,v78
SHL v254,16,v79
AND v249,0xffff0000,v76
M32 v[96:111],v[212:215],v[60:63],v[96:111]
TR v[212:213],v224 offset:2048
TR v[214:215],v224 offset:2560
BL4 v229,s[16:19],s37 offen offset:1024 lds
AND v251,0xffff0000,v77
AND v253,0xffff0000,v78
AND v255,0xffff0000,v79
FMA v248,v248,v232,v233
FMA v250,v250,v232,v233
WT lgkmcnt(4)
M32 v[112:127],v[216:219],v[60:63],v[112:127]
TR v[216:217],v225 offset:0
TR v[218:219],v225 offset:512
FMA v252,v252,v232,v233
FMA v254,v254,v232,v233
FMA v249,v249,v232,v233
FMA v251,v251,v232,v233
FMA v253,v253,v232,v233
M32 v[128:143],v[220:223],v[60:63],v[128:143]
TR v[220:221],v225 offset:2048
TR v[222:223],v225 offset:2560
BL4 v230,s[20:23],s37 offen offset:2048 lds
FMA v255,v255,v232,v233
CV v76,v248,v249
CV v77,v250,v251
CV v78,v252,v253
CV v79,v254,v255
BL4 v231,s[20:23],s37 offen offset:3072 lds
WT lgkmcnt(4)
M32 v[80:95],v[208:211],v[64:67],v[80:95]
TR v[208:209],v224 offset:8192
TR v[210:211],v224 offset:8704
M32 v[96:111],v[212:215],v[64:67],v[96:111]
TR v[212:213],v224 offset:10240
TR v[214:215],v224 offset:10752
SADD m0,s47,65536
WT lgkmcnt(4)
M32 v[112:127],v[216:219],v[64:67],v[112:127]
TR v[216:217],v225 offset:8192
TR v[218:219],v225 offset:8704
M32 v[128:143],v[220:223],v[64:67],v[128:143]
TR v[220:221],v225 offset:10240
TR v[222:223],v225 offset:10752
BL4 v228,s[16:19],s38 offen lds
WT lgkmcnt(4)
M32 v[80:95],v[208:211],v[68:71],v[80:95]
TR v[208:209],v224 offset:16384
TR v[210:211],v224 offset:16896
M32 v[96:111],v[212:215],v[68:71],v[96:111]
TR v[212:213],v224 offset:18432
TR v[214:215],v224 offset:18944
BL4 v229,s[16:19],s38 offen offset:1024 lds
WT lgkmcnt(4)
M32 v[112:127],v[216:219],v[68:71],v[112:127]
TR v[216:217],v225 offset:16384
TR v[218:219],v225 offset:16896
M32 v[128:143],v[220:223],v[68:71],v[128:143]
TR v[220:221],v225 offset:18432
TR v[222:223],v225 offset:18944
BL4 v230,s[20:23],s38 offen offset:2048 lds
WT lgkmcnt(4)
M32 v[80:95],v[208:211],v[72:75],v[80:95]
TR v[208:209],v224 offset:24576
TR v[210:211],v224 offset:25088
M32 v[96:111],v[212:215],v[72:75],v[96:111]
TR v[212:213],v224 offset:26624
TR v[214:215],v224 offset:27136
BL4 v231,s[20:23],s38 offen offset:3072 lds
WT lgkmcnt(4)
M32 v[112:127],v[216:219],v[72:75],v[112:127]
TR v[216:217],v225 offset:24576
TR v[218:219],v225 offset:25088
M32 v[128:143],v[220:223],v[72:75],v[128:143]
TR v[220:221],v225 offset:26624
TR v[222:223],v225 offset:27136
WT lgkmcnt(4)
M32 v[80:95],v[208:211],v[76:79],v[80:95]
WT vmcnt(4)
s_barrier
v_add_u32 v224,32768,v226
v_add_u32 v225,32768,v227
TR v[208:209],v224 offset:0
TR v[210:211],v224 offset:512
M32 v[96:111],v[212:215],v[76:79],v[96:111]
TR v[212:213],v224 offset:2048
TR v[214:215],v224 offset:2560
WT lgkmcnt(4)
M32 v[112:127],v[216:219],v[76:79],v[112:127]
TR v[216:217],v225 offset:0
TR v[218:219],v225 offset:512
M32 v[128:143],v[220:223],v[76:79],v[128:143]
TR v[220:221],v225 offset:2048
TR v[222:223],v225 offset:2560
WT lgkmcnt(4)
M32 v[144:159],v[208:211],v[0:3],0
TR v[208:209],v224 offset:8192
TR v[210:211],v224 offset:8704
M32 v[160:175],v[212:215],v[0:3],0
TR v[212:213],v224 offset:10240
TR v[214:215],v224 offset:10752
SADD m0,s47,98304
WT lgkmcnt(4)
M32 v[176:191],v[216:219],v[0:3],0
TR v[216:217],v225 offset:8192
TR v[218:219],v225 offset:8704
M32 v[192:207],v[220:223],v[0:3],0
TR v[220:221],v225 offset:10240
TR v[222:223],v225 offset:10752
BL4 v228,s[16:19],s39 offen lds
WT lgkmcnt(4)
M32 v[144:159],v[208:211],v[4:7],v[144:159]
TR v[208:209],v224 offset:16384
TR v[210:211],v224 offset:16896
ds_write_b128 v238,v[112:115] offset:0
M32 v[160:175],v[212:215],v[4:7],v[160:175]
TR v[212:213],v224 offset:18432
TR v[214:215],v224 offset:18944
BL4 v229,s[16:19],s39 offen offset:1024 lds
ds_write_b128 v238,v[116:119] offset:1024
WT lgkmcnt(6)
M32 v[176:191],v[216:219],v[4:7],v[176:191]
TR v[216:217],v225 offset:16384
TR v[218:219],v225 offset:16896
ds_write_b128 v238,v[120:123] offset:2048
M32 v[192:207],v[220:223],v[4:7],v[192:207]
TR v[220:221],v225 offset:18432
TR v[222:223],v225 offset:18944
BL4 v230,s[20:23],s39 offen offset:2048 lds
ds_write_b128 v238,v[124:127] offset:3072
WT lgkmcnt(7)
M32 v[144:159],v[208:211],v[8:11],v[144:159]
TR v[208:209],v224 offset:24576
TR v[210:211],v224 offset:25088
M32 v[160:175],v[212:215],v[8:11],v[160:175]
TR v[212:213],v224 offset:26624
TR v[214:215],v224 offset:27136
BL4 v231,s[20:23],s39 offen offset:3072 lds
WT lgkmcnt(5)
M32 v[176:191],v[216:219],v[8:11],v[176:191]
TR v[216:217],v225 offset:24576
TR v[218:219],v225 offset:25088
M32 v[192:207],v[220:223],v[8:11],v[192:207]
TR v[220:221],v225 offset:26624
TR v[222:223],v225 offset:27136
WT lgkmcnt(4)
M32 v[144:159],v[208:211],v[12:15],v[144:159]
WT vmcnt(4)
WT lgkmcnt(8)
s_barrier
v_add_u32 v224,65536,v226
v_add_u32 v225,65536,v227
TR v[208:209],v224 offset:0
TR v[210:211],v224 offset:512
M32 v[160:175],v[212:215],v[12:15],v[160:175]
TR v[212:213],v224 offset:2048
TR v[214:215],v224 offset:2560
WT lgkmcnt(4)
M32 v[176:191],v[216:219],v[12:15],v[176:191]
TR v[216:217],v225 offset:0
TR v[218:219],v225 offset:512
M32 v[192:207],v[220:223],v[12:15],v[192:207]
TR v[220:221],v225 offset:2048
TR v[222:223],v225 offset:2560
WT lgkmcnt(4)
M32 v[144:159],v[208:211],v[16:19],v[144:159]
TR v[208:209],v224 offset:8192
TR v[210:211],v224 offset:8704
R128 v[240:243],v239 offset:0
R128 v[244:247],v239 offset:1024
M32 v[160:175],v[212:215],v[16:19],v[160:175]
TR v[212:213],v224 offset:10240
TR v[214:215],v224 offset:10752
SADD m0,s47,0
WT lgkmcnt(6)
M32 v[176:191],v[216:219],v[16:19],v[176:191]
TR v[216:217],v225 offset:8192
TR v[218:219],v225 offset:8704
WT lgkmcnt(4)
ADD v80,v80,v240
ADD v81,v81,v241
ADD v82,v82,v242
M32 v[192:207],v[220:223],v[16:19],v[192:207]
TR v[220:221],v225 offset:10240
TR v[222:223],v225 offset:10752
BL4 v228,s[16:19],s40 offen lds
ADD v83,v83,v243
ADD v84,v84,v244
ADD v85,v85,v245
ADD v86,v86,v246
WT lgkmcnt(4)
M32 v[144:159],v[208:211],v[20:23],v[144:159]
TR v[208:209],v224 offset:16384
TR v[210:211],v224 offset:16896
ADD v87,v87,v247
R128 v[240:243],v239 offset:2048
R128 v[244:247],v239 offset:3072
M32 v[160:175],v[212:215],v[20:23],v[160:175]
TR v[212:213],v224 offset:18432
TR v[214:215],v224 offset:18944
BL4 v229,s[16:19],s40 offen offset:1024 lds
WT lgkmcnt(6)
M32 v[176:191],v[216:219],v[20:23],v[176:191]
TR v[216:217],v225 offset:16384
TR v[218:219],v225 offset:16896
WT lgkmcnt(4)
ADD v88,v88,v240
ADD v89,v89,v241
ADD v90,v90,v242
ADD v91,v91,v243
M32 v[192:207],v[220:223],v[20:23],v[192:207]
TR v[220:221],v225 offset:18432
TR v[222:223],v225 offset:18944
BL4 v230,s[20:23],s40 offen offset:2048 lds
ADD v92,v92,v244
ADD v93,v93,v245
ADD v94,v94,v246
ADD v95,v95,v247
s_mul_i32 s55,s57,40960
WT lgkmcnt(4)
M32 v[144:159],v[208:211],v[24:27],v[144:159]
TR v[208:209],v224 offset:24576
TR v[210:211],v224 offset:25088
s_lshl_b32 s53,s63,13
SADD s55,s55,s53
s_mul_i32 s53,s62,2621440
SADD s55,s55,s53
M32 v[160:175],v[212:215],v[24:27],v[160:175]
TR v[212:213],v224 offset:26624
TR v[214:215],v224 offset:27136
BL4 v231,s[20:23],s40 offen offset:3072 lds
s_lshl_b32 s53,s48,11
SADD s55,s55,s53
SADD s56,s55,4096
MUL v80,s59,v80
WT lgkmcnt(4)
M32 v[176:191],v[216:219],v[24:27],v[176:191]
TR v[216:217],v225 offset:24576
TR v[218:219],v225 offset:25088
MUL v81,s59,v81
MUL v82,s59,v82
MUL v83,s59,v83
MUL v247,v80,v80
M32 v[192:207],v[220:223],v[24:27],v[192:207]
TR v[220:221],v225 offset:26624
TR v[222:223],v225 offset:27136
v_fmac_f32 v247,v81,v81
v_fmac_f32 v247,v82,v82
v_fmac_f32 v247,v83,v83
CV v248,v80,v81
WT lgkmcnt(4)
M32 v[144:159],v[208:211],v[28:31],v[144:159]
CV v249,v82,v83
v_mov_b32 v246,v247
MUL v84,s59,v84
MUL v85,s59,v85
WT vmcnt(4)
WT lgkmcnt(14)
s_barrier
v_add_u32 v224,98304,v226
v_add_u32 v225,98304,v227
TR v[208:209],v224 offset:0
TR v[210:211],v224 offset:512
M32 v[160:175],v[212:215],v[28:31],v[160:175]
TR v[212:213],v224 offset:2048
TR v[214:215],v224 offset:2560
WT lgkmcnt(4)
M32 v[176:191],v[216:219],v[28:31],v[176:191]
TR v[216:217],v225 offset:0
TR v[218:219],v225 offset:512
M32 v[192:207],v[220:223],v[28:31],v[192:207]
TR v[220:221],v225 offset:2048
TR v[222:223],v225 offset:2560
WT lgkmcnt(4)
M32 v[144:159],v[208:211],v[32:35],v[144:159]
TR v[208:209],v224 offset:8192
TR v[210:211],v224 offset:8704
ds_write_b128 v238,v[128:131] offset:0
ds_write_b128 v238,v[132:135] offset:1024
ds_write_b128 v238,v[136:139] offset:2048
ds_write_b128 v238,v[140:143] offset:3072
M32 v[160:175],v[212:215],v[32:35],v[160:175]
TR v[212:213],v224 offset:10240
TR v[214:215],v224 offset:10752
SADD m0,s47,32768
MUL v86,s59,v86
MUL v87,s59,v87
MUL v247,v84,v84
v_fmac_f32 v247,v85,v85
WT lgkmcnt(8)
M32 v[176:191],v[216:219],v[32:35],v[176:191]
TR v[216:217],v225 offset:8192
TR v[218:219],v225 offset:8704
v_fmac_f32 v247,v86,v86
v_fmac_f32 v247,v87,v87
CV v250,v84,v85
CV v251,v86,v87
M32 v[192:207],v[220:223],v[32:35],v[192:207]
TR v[220:221],v225 offset:10240
TR v[222:223],v225 offset:10752
BL4 v228,s[16:19],s41 offen lds
v_max_f32 v246,v246,v247
MUL v88,s59,v88
MUL v89,s59,v89
MUL v90,s59,v90
WT lgkmcnt(4)
M32 v[144:159],v[208:211],v[36:39],v[144:159]
TR v[208:209],v224 offset:16384
TR v[210:211],v224 offset:16896
MUL v91,s59,v91
MUL v247,v88,v88
v_fmac_f32 v247,v89,v89
v_fmac_f32 v247,v90,v90
M32 v[160:175],v[212:215],v[36:39],v[160:175]
TR v[212:213],v224 offset:18432
TR v[214:215],v224 offset:18944
BL4 v229,s[16:19],s41 offen offset:1024 lds
v_fmac_f32 v247,v91,v91
CV v252,v88,v89
CV v253,v90,v91
v_max_f32 v246,v246,v247
WT lgkmcnt(4)
M32 v[176:191],v[216:219],v[36:39],v[176:191]
TR v[216:217],v225 offset:16384
TR v[218:219],v225 offset:16896
MUL v92,s59,v92
MUL v93,s59,v93
MUL v94,s59,v94
MUL v95,s59,v95
M32 v[192:207],v[220:223],v[36:39],v[192:207]
TR v[220:221],v225 offset:18432
TR v[222:223],v225 offset:18944
BL4 v230,s[20:23],s41 offen offset:2048 lds
MUL v247,v92,v92
v_fmac_f32 v247,v93,v93
v_fmac_f32 v247,v94,v94
v_fmac_f32 v247,v95,v95
WT lgkmcnt(4)
M32 v[144:159],v[208:211],v[40:43],v[144:159]
TR v[208:209],v224 offset:24576
TR v[210:211],v224 offset:25088
CV v254,v92,v93
CV v255,v94,v95
v_max_f32 v246,v246,v247
v_permlane32_swap_b32 v248,v250
M32 v[160:175],v[212:215],v[40:43],v[160:175]
TR v[212:213],v224 offset:26624
TR v[214:215],v224 offset:27136
BL4 v231,s[20:23],s41 offen offset:3072 lds
v_permlane32_swap_b32 v249,v251
v_permlane32_swap_b32 v252,v254
v_permlane32_swap_b32 v253,v255
WT lgkmcnt(4)
M32 v[176:191],v[216:219],v[40:43],v[176:191]
TR v[216:217],v225 offset:24576
TR v[218:219],v225 offset:25088
BS4 v[248:251],v234,s[24:27],s55 offen sc1
BS4 v[252:255],v234,s[24:27],s55 offen offset:1024 sc1
v_max_f32_dpp v246,v246,v246 row_shr:1 row_mask:0xf bank_mask:0xf bound_ctrl:0
M32 v[192:207],v[220:223],v[40:43],v[192:207]
TR v[220:221],v225 offset:26624
TR v[222:223],v225 offset:27136
v_max_f32_dpp v246,v246,v246 row_shr:2 row_mask:0xf bank_mask:0xf bound_ctrl:0
s_nop 1
v_max_f32_dpp v246,v246,v246 row_shr:4 row_mask:0xf bank_mask:0xf bound_ctrl:0
s_nop 1
v_max_f32_dpp v246,v246,v246 row_shr:8 row_mask:0xf bank_mask:0xf bound_ctrl:0
WT lgkmcnt(4)
M32 v[144:159],v[208:211],v[44:47],v[144:159]
v_max_f32_dpp v246,v246,v246 row_bcast:15 row_mask:0xa bank_mask:0xf
s_nop 1
v_max_f32_dpp v246,v246,v246 row_bcast:31 row_mask:0xc bank_mask:0xf
buffer_store_dword v246,v235,s[24:27],s58 offen offset:0 sc1
WT vmcnt(7)
WT lgkmcnt(15)
s_barrier
v_mov_b32 v224,v226
v_mov_b32 v225,v227
TR v[208:209],v224 offset:0
TR v[210:211],v224 offset:512
M32 v[160:175],v[212:215],v[44:47],v[160:175]
TR v[212:213],v224 offset:2048
TR v[214:215],v224 offset:2560
WT lgkmcnt(4)
M32 v[176:191],v[216:219],v[44:47],v[176:191]
TR v[216:217],v225 offset:0
TR v[218:219],v225 offset:512
M32 v[192:207],v[220:223],v[44:47],v[192:207]
TR v[220:221],v225 offset:2048
TR v[222:223],v225 offset:2560
WT lgkmcnt(4)
M32 v[144:159],v[208:211],v[48:51],v[144:159]
TR v[208:209],v224 offset:8192
TR v[210:211],v224 offset:8704
R128 v[240:243],v239 offset:0
R128 v[244:247],v239 offset:1024
M32 v[160:175],v[212:215],v[48:51],v[160:175]
TR v[212:213],v224 offset:10240
TR v[214:215],v224 offset:10752
SADD m0,s47,65536
WT lgkmcnt(6)
M32 v[176:191],v[216:219],v[48:51],v[176:191]
TR v[216:217],v225 offset:8192
TR v[218:219],v225 offset:8704
WT lgkmcnt(4)
ADD v96,v96,v240
ADD v97,v97,v241
M32 v[192:207],v[220:223],v[48:51],v[192:207]
TR v[220:221],v225 offset:10240
TR v[222:223],v225 offset:10752
BL4 v228,s[16:19],s42 offen lds
ADD v98,v98,v242
ADD v99,v99,v243
ADD v100,v100,v244
WT lgkmcnt(4)
M32 v[144:159],v[208:211],v[52:55],v[144:159]
TR v[208:209],v224 offset:16384
TR v[210:211],v224 offset:16896
ADD v101,v101,v245
ADD v102,v102,v246
ADD v103,v103,v247
M32 v[160:175],v[212:215],v[52:55],v[160:175]
TR v[212:213],v224 offset:18432
TR v[214:215],v224 offset:18944
BL4 v229,s[16:19],s42 offen offset:1024 lds
R128 v[240:243],v239 offset:2048
R128 v[244:247],v239 offset:3072
WT lgkmcnt(6)
M32 v[176:191],v[216:219],v[52:55],v[176:191]
TR v[216:217],v225 offset:16384
TR v[218:219],v225 offset:16896
M32 v[192:207],v[220:223],v[52:55],v[192:207]
TR v[220:221],v225 offset:18432
TR v[222:223],v225 offset:18944
BL4 v230,s[20:23],s42 offen offset:2048 lds
WT lgkmcnt(4)
ADD v104,v104,v240
ADD v105,v105,v241
ADD v106,v106,v242
WT lgkmcnt(6)
M32 v[144:159],v[208:211],v[56:59],v[144:159]
TR v[208:209],v224 offset:24576
TR v[210:211],v224 offset:25088
ADD v107,v107,v243
ADD v108,v108,v244
ADD v109,v109,v245
M32 v[160:175],v[212:215],v[56:59],v[160:175]
TR v[212:213],v224 offset:26624
TR v[214:215],v224 offset:27136
BL4 v231,s[20:23],s42 offen offset:3072 lds
ADD v110,v110,v246
ADD v111,v111,v247
MUL v96,s59,v96
WT lgkmcnt(4)
M32 v[176:191],v[216:219],v[56:59],v[176:191]
TR v[216:217],v225 offset:24576
TR v[218:219],v225 offset:25088
MUL v97,s59,v97
MUL v98,s59,v98
MUL v99,s59,v99
M32 v[192:207],v[220:223],v[56:59],v[192:207]
TR v[220:221],v225 offset:26624
TR v[222:223],v225 offset:27136
MUL v247,v96,v96
v_fmac_f32 v247,v97,v97
v_fmac_f32 v247,v98,v98
WT lgkmcnt(4)
M32 v[144:159],v[208:211],v[60:63],v[144:159]
v_fmac_f32 v247,v99,v99
CV v248,v96,v97
CV v249,v98,v99
v_mov_b32 v246,v247
MUL v100,s59,v100
MUL v101,s59,v101
MUL v102,s59,v102
MUL v103,s59,v103
MUL v247,v100,v100
v_fmac_f32 v247,v101,v101
v_fmac_f32 v247,v102,v102
v_fmac_f32 v247,v103,v103
WT vmcnt(7)
s_barrier
v_add_u32 v224,32768,v226
v_add_u32 v225,32768,v227
TR v[208:209],v224 offset:0
TR v[210:211],v224 offset:512
M32 v[160:175],v[212:215],v[60:63],v[160:175]
TR v[212:213],v224 offset:2048
TR v[214:215],v224 offset:2560
WT lgkmcnt(4)
M32 v[176:191],v[216:219],v[60:63],v[176:191]
TR v[216:217],v225 offset:0
TR v[218:219],v225 offset:512
M32 v[192:207],v[220:223],v[60:63],v[192:207]
TR v[220:221],v225 offset:2048
TR v[222:223],v225 offset:2560
WT lgkmcnt(4)
M32 v[144:159],v[208:211],v[64:67],v[144:159]
TR v[208:209],v224 offset:8192
TR v[210:211],v224 offset:8704
CV v250,v100,v101
CV v251,v102,v103
v_max_f32 v246,v246,v247
M32 v[160:175],v[212:215],v[64:67],v[160:175]
TR v[212:213],v224 offset:10240
TR v[214:215],v224 offset:10752
SADD m0,s47,98304
MUL v104,s59,v104
MUL v105,s59,v105
MUL v106,s59,v106
WT lgkmcnt(4)
M32 v[176:191],v[216:219],v[64:67],v[176:191]
TR v[216:217],v225 offset:8192
TR v[218:219],v225 offset:8704
MUL v107,s59,v107
MUL v247,v104,v104
v_fmac_f32 v247,v105,v105
M32 v[192:207],v[220:223],v[64:67],v[192:207]
TR v[220:221],v225 offset:10240
TR v[222:223],v225 offset:10752
BL4 v228,s[16:19],s43 offen lds
v_fmac_f32 v247,v106,v106
v_fmac_f32 v247,v107,v107
CV v252,v104,v105
WT lgkmcnt(4)
M32 v[144:159],v[208:211],v[68:71],v[144:159]
TR v[208:209],v224 offset:16384
TR v[210:211],v224 offset:16896
CV v253,v106,v107
v_max_f32 v246,v246,v247
MUL v108,s59,v108
M32 v[160:175],v[212:215],v[68:71],v[160:175]
TR v[212:213],v224 offset:18432
TR v[214:215],v224 offset:18944
BL4 v229,s[16:19],s43 offen offset:1024 lds
MUL v109,s59,v109
MUL v110,s59,v110
MUL v111,s59,v111
WT lgkmcnt(4)
M32 v[176:191],v[216:219],v[68:71],v[176:191]
TR v[216:217],v225 offset:16384
TR v[218:219],v225 offset:16896
MUL v247,v108,v108
v_fmac_f32 v247,v109,v109
M32 v[192:207],v[220:223],v[68:71],v[192:207]
TR v[220:221],v225 offset:18432
TR v[222:223],v225 offset:18944
BL4 v230,s[20:23],s43 offen offset:2048 lds
v_fmac_f32 v247,v110,v110
v_fmac_f32 v247,v111,v111
WT lgkmcnt(4)
M32 v[144:159],v[208:211],v[72:75],v[144:159]
TR v[208:209],v224 offset:24576
TR v[210:211],v224 offset:25088
CV v254,v108,v109
CV v255,v110,v111
M32 v[160:175],v[212:215],v[72:75],v[160:175]
TR v[212:213],v224 offset:26624
TR v[214:215],v224 offset:27136
BL4 v231,s[20:23],s43 offen offset:3072 lds
v_max_f32 v246,v246,v247
v_permlane32_swap_b32 v248,v250
WT lgkmcnt(4)
M32 v[176:191],v[216:219],v[72:75],v[176:191]
TR v[216:217],v225 offset:24576
TR v[218:219],v225 offset:25088
v_permlane32_swap_b32 v249,v251
v_permlane32_swap_b32 v252,v254
M32 v[192:207],v[220:223],v[72:75],v[192:207]
TR v[220:221],v225 offset:26624
TR v[222:223],v225 offset:27136
v_permlane32_swap_b32 v253,v255
BS4 v[248:251],v234,s[24:27],s56 offen sc1
WT lgkmcnt(4)
M32 v[144:159],v[208:211],v[76:79],v[144:159]
BS4 v[252:255],v234,s[24:27],s56 offen offset:1024 sc1
v_max_f32_dpp v246,v246,v246 row_shr:1 row_mask:0xf bank_mask:0xf bound_ctrl:0
s_nop 1
v_max_f32_dpp v246,v246,v246 row_shr:2 row_mask:0xf bank_mask:0xf bound_ctrl:0
s_nop 1
v_max_f32_dpp v246,v246,v246 row_shr:4 row_mask:0xf bank_mask:0xf bound_ctrl:0
s_nop 1
v_max_f32_dpp v246,v246,v246 row_shr:8 row_mask:0xf bank_mask:0xf bound_ctrl:0
s_nop 1
v_max_f32_dpp v246,v246,v246 row_bcast:15 row_mask:0xa bank_mask:0xf
s_nop 1
v_max_f32_dpp v246,v246,v246 row_bcast:31 row_mask:0xc bank_mask:0xf
buffer_store_dword v246,v235,s[24:27],s58 offen offset:512 sc1
WT vmcnt(7)
s_barrier
v_add_u32 v224,65536,v226
v_add_u32 v225,65536,v227
v_mov_b32 v233,0
buffer_load_dword v232,v233,s[64:67],0 offen sc1
TR v[208:209],v224 offset:0
TR v[210:211],v224 offset:512
M32 v[160:175],v[212:215],v[76:79],v[160:175]
TR v[212:213],v224 offset:2048
TR v[214:215],v224 offset:2560
WT lgkmcnt(4)
M32 v[176:191],v[216:219],v[76:79],v[176:191]
TR v[216:217],v225 offset:0
TR v[218:219],v225 offset:512
M32 v[192:207],v[220:223],v[76:79],v[192:207]
TR v[220:221],v225 offset:2048
TR v[222:223],v225 offset:2560
WT lgkmcnt(4)
M32 v[80:95],v[208:211],v[0:3],0
TR v[208:209],v224 offset:8192
TR v[210:211],v224 offset:8704
M32 v[96:111],v[212:215],v[0:3],0
TR v[212:213],v224 offset:10240
TR v[214:215],v224 offset:10752
SADD m0,s47,0
WT lgkmcnt(4)
M32 v[112:127],v[216:219],v[0:3],0
TR v[216:217],v225 offset:8192
TR v[218:219],v225 offset:8704
M32 v[128:143],v[220:223],v[0:3],0
TR v[220:221],v225 offset:10240
TR v[222:223],v225 offset:10752
BL4 v228,s[16:19],s44 offen lds
WT lgkmcnt(4)
M32 v[80:95],v[208:211],v[4:7],v[80:95]
TR v[208:209],v224 offset:16384
TR v[210:211],v224 offset:16896
ds_write_b128 v238,v[176:179] offset:0
M32 v[96:111],v[212:215],v[4:7],v[96:111]
TR v[212:213],v224 offset:18432
TR v[214:215],v224 offset:18944
BL4 v229,s[16:19],s44 offen offset:1024 lds
ds_write_b128 v238,v[180:183] offset:1024
WT lgkmcnt(6)
M32 v[112:127],v[216:219],v[4:7],v[112:127]
TR v[216:217],v225 offset:16384
TR v[218:219],v225 offset:16896
ds_write_b128 v238,v[184:187] offset:2048
M32 v[128:143],v[220:223],v[4:7],v[128:143]
TR v[220:221],v225 offset:18432
TR v[222:223],v225 offset:18944
BL4 v230,s[20:23],s44 offen offset:2048 lds
ds_write_b128 v238,v[188:191] offset:3072
WT lgkmcnt(7)
M32 v[80:95],v[208:211],v[8:11],v[80:95]
TR v[208:209],v224 offset:24576
TR v[210:211],v224 offset:25088
M32 v[96:111],v[212:215],v[8:11],v[96:111]
TR v[212:213],v224 offset:26624
TR v[214:215],v224 offset:27136
BL4 v231,s[20:23],s44 offen offset:3072 lds
WT lgkmcnt(5)
M32 v[112:127],v[216:219],v[8:11],v[112:127]
TR v[216:217],v225 offset:24576
TR v[218:219],v225 offset:25088
M32 v[128:143],v[220:223],v[8:11],v[128:143]
TR v[220:221],v225 offset:26624
TR v[222:223],v225 offset:27136
WT lgkmcnt(4)
M32 v[80:95],v[208:211],v[12:15],v[80:95]
WT vmcnt(8)
WT lgkmcnt(8)
WT vmcnt(5)
WT vmcnt(4)
s_barrier
v_add_u32 v224,98304,v226
v_add_u32 v225,98304,v227
s_cmp_lg_u32 s30,0
s_cbranch_scc1 SQ_w1
v_readfirstlane_b32 s90,v232
s_nop 3
s_cmp_eq_u32 s90,1
s_cbranch_scc1 SQ_ok1
s_mov_b32 s52,0
SQ_clr1:
buffer_load_dword v232,v233,s[64:67],0 offen sc1
WT vmcnt(0)
s_mov_b64 s[94:95],0
v_cmp_ne_u32 vcc,0x1,v232
s_nop 3
s_and_b32 vcc_lo,vcc_lo,0x1
s_and_b32 vcc_hi,vcc_hi,0x0
s_or_b64 s[94:95],s[94:95],vcc
s_cmp_eq_u64 s[94:95],0
s_cbranch_scc1 SQ_clr1_ok
SADD s52,s52,1
s_cmp_lt_u32 s52,200000
s_cbranch_scc0 SQ_clr1_ok
s_sleep 2
s_branch SQ_clr1
SQ_clr1_ok:
SQ_ok1:
s_lshl_b32 s89,s29,7
s_lshl_b32 s90,s28,2
SADD s89,s89,s90
SADD s89,s89,23461888
v_mov_b32 v235,0x5ca1ab1e
v_mov_b32 v236,s89
s_mov_b64 exec,1
buffer_store_dword v235,v236,s[24:27],0 offen sc1
s_mov_b64 exec,-1
SQ_w1:
TR v[208:209],v224 offset:0
TR v[210:211],v224 offset:512
s_nop 1
M32 v[96:111],v[212:215],v[12:15],v[96:111]
TR v[212:213],v224 offset:2048
TR v[214:215],v224 offset:2560
WT lgkmcnt(4)
M32 v[112:127],v[216:219],v[12:15],v[112:127]
TR v[216:217],v225 offset:0
TR v[218:219],v225 offset:512
M32 v[128:143],v[220:223],v[12:15],v[128:143]
TR v[220:221],v225 offset:2048
TR v[222:223],v225 offset:2560
WT lgkmcnt(4)
M32 v[80:95],v[208:211],v[16:19],v[80:95]
TR v[208:209],v224 offset:8192
TR v[210:211],v224 offset:8704
R128 v[240:243],v239 offset:0
R128 v[244:247],v239 offset:1024
M32 v[96:111],v[212:215],v[16:19],v[96:111]
TR v[212:213],v224 offset:10240
TR v[214:215],v224 offset:10752
SADD m0,s47,32768
WT lgkmcnt(6)
M32 v[112:127],v[216:219],v[16:19],v[112:127]
TR v[216:217],v225 offset:8192
TR v[218:219],v225 offset:8704
WT lgkmcnt(4)
ADD v144,v144,v240
ADD v145,v145,v241
ADD v146,v146,v242
ADD v147,v147,v243
M32 v[128:143],v[220:223],v[16:19],v[128:143]
TR v[220:221],v225 offset:10240
TR v[222:223],v225 offset:10752
BL4 v228,s[16:19],s45 offen lds
ADD v148,v148,v244
ADD v149,v149,v245
ADD v150,v150,v246
ADD v151,v151,v247
WT lgkmcnt(4)
M32 v[80:95],v[208:211],v[20:23],v[80:95]
TR v[208:209],v224 offset:16384
TR v[210:211],v224 offset:16896
R128 v[240:243],v239 offset:2048
R128 v[244:247],v239 offset:3072
M32 v[96:111],v[212:215],v[20:23],v[96:111]
TR v[212:213],v224 offset:18432
TR v[214:215],v224 offset:18944
BL4 v229,s[16:19],s45 offen offset:1024 lds
WT lgkmcnt(6)
M32 v[112:127],v[216:219],v[20:23],v[112:127]
TR v[216:217],v225 offset:16384
TR v[218:219],v225 offset:16896
WT lgkmcnt(4)
ADD v152,v152,v240
ADD v153,v153,v241
ADD v154,v154,v242
ADD v155,v155,v243
M32 v[128:143],v[220:223],v[20:23],v[128:143]
TR v[220:221],v225 offset:18432
TR v[222:223],v225 offset:18944
BL4 v230,s[20:23],s45 offen offset:2048 lds
ADD v156,v156,v244
ADD v157,v157,v245
ADD v158,v158,v246
ADD v159,v159,v247
s_mul_i32 s55,s57,110592
WT lgkmcnt(4)
M32 v[80:95],v[208:211],v[24:27],v[80:95]
TR v[208:209],v224 offset:24576
TR v[210:211],v224 offset:25088
s_lshl_b32 s53,s60,12
SADD s55,s55,s53
s_lshl_b32 s53,s48,11
SADD s55,s55,s53
SADD s55,s55,8126464
M32 v[96:111],v[212:215],v[24:27],v[96:111]
TR v[212:213],v224 offset:26624
TR v[214:215],v224 offset:27136
BL4 v231,s[20:23],s45 offen offset:3072 lds
MUL v144,0xbfb8aa3b,v144
MUL v145,0xbfb8aa3b,v145
MUL v146,0xbfb8aa3b,v146
MUL v147,0xbfb8aa3b,v147
EX v144,v144
WT lgkmcnt(4)
M32 v[112:127],v[216:219],v[24:27],v[112:127]
TR v[216:217],v225 offset:24576
TR v[218:219],v225 offset:25088
EX v145,v145
EX v146,v146
EX v147,v147
MUL v148,0xbfb8aa3b,v148
M32 v[128:143],v[220:223],v[24:27],v[128:143]
TR v[220:221],v225 offset:26624
TR v[222:223],v225 offset:27136
MUL v149,0xbfb8aa3b,v149
MUL v150,0xbfb8aa3b,v150
MUL v151,0xbfb8aa3b,v151
EX v148,v148
WT lgkmcnt(4)
M32 v[80:95],v[208:211],v[28:31],v[80:95]
EX v149,v149
EX v150,v150
EX v151,v151
MUL v152,0xbfb8aa3b,v152
WT vmcnt(4)
WT lgkmcnt(14)
s_barrier
v_mov_b32 v224,v226
v_mov_b32 v225,v227
TR v[208:209],v224 offset:0
TR v[210:211],v224 offset:512
M32 v[96:111],v[212:215],v[28:31],v[96:111]
TR v[212:213],v224 offset:2048
TR v[214:215],v224 offset:2560
WT lgkmcnt(4)
M32 v[112:127],v[216:219],v[28:31],v[112:127]
TR v[216:217],v225 offset:0
TR v[218:219],v225 offset:512
M32 v[128:143],v[220:223],v[28:31],v[128:143]
TR v[220:221],v225 offset:2048
TR v[222:223],v225 offset:2560
WT lgkmcnt(4)
M32 v[80:95],v[208:211],v[32:35],v[80:95]
TR v[208:209],v224 offset:8192
TR v[210:211],v224 offset:8704
ds_write_b128 v238,v[192:195] offset:0
ds_write_b128 v238,v[196:199] offset:1024
ds_write_b128 v238,v[200:203] offset:2048
ds_write_b128 v238,v[204:207] offset:3072
M32 v[96:111],v[212:215],v[32:35],v[96:111]
TR v[212:213],v224 offset:10240
TR v[214:215],v224 offset:10752
SADD m0,s47,65536
MUL v153,0xbfb8aa3b,v153
MUL v154,0xbfb8aa3b,v154
MUL v155,0xbfb8aa3b,v155
EX v152,v152
WT lgkmcnt(8)
M32 v[112:127],v[216:219],v[32:35],v[112:127]
TR v[216:217],v225 offset:8192
TR v[218:219],v225 offset:8704
EX v153,v153
EX v154,v154
EX v155,v155
MUL v156,0xbfb8aa3b,v156
M32 v[128:143],v[220:223],v[32:35],v[128:143]
TR v[220:221],v225 offset:10240
TR v[222:223],v225 offset:10752
BL4 v228,s[16:19],s46 offen lds
MUL v157,0xbfb8aa3b,v157
MUL v158,0xbfb8aa3b,v158
MUL v159,0xbfb8aa3b,v159
EX v156,v156
WT lgkmcnt(4)
M32 v[80:95],v[208:211],v[36:39],v[80:95]
TR v[208:209],v224 offset:16384
TR v[210:211],v224 offset:16896
EX v157,v157
EX v158,v158
EX v159,v159
ADD v144,1.0,v144
M32 v[96:111],v[212:215],v[36:39],v[96:111]
TR v[212:213],v224 offset:18432
TR v[214:215],v224 offset:18944
BL4 v229,s[16:19],s46 offen offset:1024 lds
ADD v145,1.0,v145
ADD v146,1.0,v146
ADD v147,1.0,v147
RCP v144,v144
WT lgkmcnt(4)
M32 v[112:127],v[216:219],v[36:39],v[112:127]
TR v[216:217],v225 offset:16384
TR v[218:219],v225 offset:16896
RCP v145,v145
RCP v146,v146
RCP v147,v147
ADD v148,1.0,v148
M32 v[128:143],v[220:223],v[36:39],v[128:143]
TR v[220:221],v225 offset:18432
TR v[222:223],v225 offset:18944
BL4 v230,s[20:23],s46 offen offset:2048 lds
ADD v149,1.0,v149
ADD v150,1.0,v150
ADD v151,1.0,v151
RCP v148,v148
WT lgkmcnt(4)
M32 v[80:95],v[208:211],v[40:43],v[80:95]
TR v[208:209],v224 offset:24576
TR v[210:211],v224 offset:25088
RCP v149,v149
RCP v150,v150
RCP v151,v151
ADD v152,1.0,v152
M32 v[96:111],v[212:215],v[40:43],v[96:111]
TR v[212:213],v224 offset:26624
TR v[214:215],v224 offset:27136
BL4 v231,s[20:23],s46 offen offset:3072 lds
ADD v153,1.0,v153
ADD v154,1.0,v154
ADD v155,1.0,v155
RCP v152,v152
WT lgkmcnt(4)
M32 v[112:127],v[216:219],v[40:43],v[112:127]
TR v[216:217],v225 offset:24576
TR v[218:219],v225 offset:25088
RCP v153,v153
RCP v154,v154
RCP v155,v155
ADD v156,1.0,v156
M32 v[128:143],v[220:223],v[40:43],v[128:143]
TR v[220:221],v225 offset:26624
TR v[222:223],v225 offset:27136
ADD v157,1.0,v157
ADD v158,1.0,v158
ADD v159,1.0,v159
RCP v156,v156
WT lgkmcnt(4)
M32 v[80:95],v[208:211],v[44:47],v[80:95]
RCP v157,v157
RCP v158,v158
RCP v159,v159
WT vmcnt(4)
WT lgkmcnt(15)
s_barrier
v_add_u32 v224,32768,v226
v_add_u32 v225,32768,v227
TR v[208:209],v224 offset:0
TR v[210:211],v224 offset:512
M32 v[96:111],v[212:215],v[44:47],v[96:111]
TR v[212:213],v224 offset:2048
TR v[214:215],v224 offset:2560
WT lgkmcnt(4)
M32 v[112:127],v[216:219],v[44:47],v[112:127]
TR v[216:217],v225 offset:0
TR v[218:219],v225 offset:512
M32 v[128:143],v[220:223],v[44:47],v[128:143]
TR v[220:221],v225 offset:2048
TR v[222:223],v225 offset:2560
WT lgkmcnt(4)
M32 v[80:95],v[208:211],v[48:51],v[80:95]
TR v[208:209],v224 offset:8192
TR v[210:211],v224 offset:8704
R128 v[240:243],v239 offset:0
R128 v[244:247],v239 offset:1024
M32 v[96:111],v[212:215],v[48:51],v[96:111]
TR v[212:213],v224 offset:10240
TR v[214:215],v224 offset:10752
WT lgkmcnt(6)
M32 v[112:127],v[216:219],v[48:51],v[112:127]
TR v[216:217],v225 offset:8192
TR v[218:219],v225 offset:8704
WT lgkmcnt(4)
ADD v160,v160,v240
ADD v161,v161,v241
M32 v[128:143],v[220:223],v[48:51],v[128:143]
TR v[220:221],v225 offset:10240
TR v[222:223],v225 offset:10752
ADD v162,v162,v242
ADD v163,v163,v243
ADD v164,v164,v244
WT lgkmcnt(4)
M32 v[80:95],v[208:211],v[52:55],v[80:95]
TR v[208:209],v224 offset:16384
TR v[210:211],v224 offset:16896
ADD v165,v165,v245
ADD v166,v166,v246
ADD v167,v167,v247
M32 v[96:111],v[212:215],v[52:55],v[96:111]
TR v[212:213],v224 offset:18432
TR v[214:215],v224 offset:18944
R128 v[240:243],v239 offset:2048
R128 v[244:247],v239 offset:3072
WT lgkmcnt(6)
M32 v[112:127],v[216:219],v[52:55],v[112:127]
TR v[216:217],v225 offset:16384
TR v[218:219],v225 offset:16896
M32 v[128:143],v[220:223],v[52:55],v[128:143]
TR v[220:221],v225 offset:18432
TR v[222:223],v225 offset:18944
WT lgkmcnt(4)
ADD v168,v168,v240
ADD v169,v169,v241
WT lgkmcnt(6)
M32 v[80:95],v[208:211],v[56:59],v[80:95]
TR v[208:209],v224 offset:24576
TR v[210:211],v224 offset:25088
ADD v170,v170,v242
ADD v171,v171,v243
M32 v[96:111],v[212:215],v[56:59],v[96:111]
TR v[212:213],v224 offset:26624
TR v[214:215],v224 offset:27136
ADD v172,v172,v244
ADD v173,v173,v245
WT lgkmcnt(4)
M32 v[112:127],v[216:219],v[56:59],v[112:127]
TR v[216:217],v225 offset:24576
TR v[218:219],v225 offset:25088
ADD v174,v174,v246
ADD v175,v175,v247
M32 v[128:143],v[220:223],v[56:59],v[128:143]
TR v[220:221],v225 offset:26624
TR v[222:223],v225 offset:27136
MUL v160,v160,v144
MUL v161,v161,v145
WT lgkmcnt(4)
M32 v[80:95],v[208:211],v[60:63],v[80:95]
MUL v162,v162,v146
MUL v163,v163,v147
CV v248,v160,v161
CV v249,v162,v163
MUL v164,v164,v148
MUL v165,v165,v149
MUL v166,v166,v150
MUL v167,v167,v151
WT vmcnt(0)
s_barrier
v_add_u32 v224,65536,v226
v_add_u32 v225,65536,v227
s_and_b32 s31,s30,3
s_lshr_b32 s43,s30,2
s_and_b32 s9,s2,7
s_lshr_b32 s10,s2,3
s_lshl_b32 s41,s9,3
s_lshr_b32 s42,s10,2
SADD s41,s41,s42
s_and_b32 s42,s10,3
s_and_b32 s5,s10,7
s_lshr_b32 s10,s10,3
s_lshl_b32 s4,s9,2
SADD s4,s4,s10
s_lshr_b32 s6,s5,1
s_lshr_b32 s9,s4,1
s_mul_i32 s9,s9,5
s_and_b32 s10,s4,1
s_lshl_b32 s10,s10,1
SADD s9,s9,s10
s_lshl_b32 s18,s9,9
s_mul_i32 s11,s31,163840
SADD s11,s11,s18
SADD s11,s11,2621440
s_mul_i32 s22,s31,6144
s_mul_i32 s23,s31,5632
s_mul_i32 s12,s31,165888
SADD s12,s12,5242880
SADD s23,s23,24576
s_mov_b32 s16,0
s_lshl_b32 s9,s6,2
s_lshl_b32 s92,15,s9
s_lshl_b32 s9,s92,16
s_or_b32 s92,s92,s9
v_lshrrev_b32 v247,4,v234
s_mul_i32 s9,s4,20
SADD s10,s9,19
s_lshr_b32 s9,s9,7
s_lshr_b32 s10,s10,7
v_lshrrev_b32 v240,4,v247
AND v241,15,v247
AND v242,1,v240
v_mov_b32 v243,s9
v_mov_b32 v244,s10
v_cmp_eq_u32 vcc,1,v242
s_nop 1
v_cndmask_b32 v243,v243,v244,vcc
v_lshrrev_b32 v242,1,v240
v_mul_u32_u24 v244,5,v242
v_add_u32 v244,v244,v243
SHL v244,7,v244
v_lshl_add_u32 v244,v241,2,v244
v_add_u32 v245,23461888,v244
v_add_u32 v244,10,v243
SHL v244,7,v244
v_lshl_add_u32 v244,v241,2,v244
v_add_u32 v246,23461888,v244
SHL v244,2,v241
v_add_u32 v244,23472128,v244
v_cmp_le_u32 vcc,2,v240
s_nop 1
v_cndmask_b32 v246,v246,v244,vcc
v_mov_b32 v235,v245
v_mov_b32 v236,v246
buffer_load_dword v237,v235,s[24:27],0 offen sc1
buffer_load_dword v232,v236,s[24:27],0 offen sc1
v_mov_b32 v204,v234
v_lshrrev_b32 v205,4,v234
v_add_u32 v240,0,v205
v_cmp_le_u32 vcc,96,v240
SHL v241,4,v240
v_add_u32 v242,39424,v241
v_cndmask_b32 v192,v241,v242,vcc
v_add_u32 v240,64,v205
v_cmp_le_u32 vcc,96,v240
SHL v241,4,v240
v_add_u32 v242,39424,v241
v_cndmask_b32 v193,v241,v242,vcc
v_add_u32 v240,128,v205
v_cmp_le_u32 vcc,96,v240
SHL v241,4,v240
v_add_u32 v242,39424,v241
v_cndmask_b32 v194,v241,v242,vcc
s_mul_i32 s9,s4,20
v_add_u32 v240,0,v205
v_mul_u32_u24 v241,745,v240
v_lshrrev_b32 v241,16,v241
v_mul_u32_u24 v242,88,v241
v_sub_u32 v240,v240,v242
v_mul_u32_u24 v241,41472,v241
v_mul_u32_u24 v242,2979,v240
v_lshrrev_b32 v242,16,v242
v_mul_u32_u24 v243,22,v242
v_sub_u32 v240,v240,v243
v_mul_u32_u24 v242,10368,v242
v_add_u32 v241,v241,v242
v_add_u32 v242,s9,v240
v_add_u32 v243,620,v240
v_cmp_gt_u32 vcc,20,v240
s_nop 1
v_cndmask_b32 v242,v243,v242,vcc
v_lshl_add_u32 v241,v242,4,v241
v_mov_b32 v195,v241
v_add_u32 v240,64,v205
v_mul_u32_u24 v241,745,v240
v_lshrrev_b32 v241,16,v241
v_mul_u32_u24 v242,88,v241
v_sub_u32 v240,v240,v242
v_mul_u32_u24 v241,41472,v241
v_mul_u32_u24 v242,2979,v240
v_lshrrev_b32 v242,16,v242
v_mul_u32_u24 v243,22,v242
v_sub_u32 v240,v240,v243
v_mul_u32_u24 v242,10368,v242
v_add_u32 v241,v241,v242
v_add_u32 v242,s9,v240
v_add_u32 v243,620,v240
v_cmp_gt_u32 vcc,20,v240
s_nop 1
v_cndmask_b32 v242,v243,v242,vcc
v_lshl_add_u32 v241,v242,4,v241
v_subrev_u32 v196,1024,v241
v_add_u32 v240,128,v205
v_mul_u32_u24 v241,745,v240
v_lshrrev_b32 v241,16,v241
v_mul_u32_u24 v242,88,v241
v_sub_u32 v240,v240,v242
v_mul_u32_u24 v241,41472,v241
v_mul_u32_u24 v242,2979,v240
v_lshrrev_b32 v242,16,v242
v_mul_u32_u24 v243,22,v242
v_sub_u32 v240,v240,v243
v_mul_u32_u24 v242,10368,v242
v_add_u32 v241,v241,v242
v_add_u32 v242,s9,v240
v_add_u32 v243,620,v240
v_cmp_gt_u32 vcc,20,v240
s_nop 1
v_cndmask_b32 v242,v243,v242,vcc
v_lshl_add_u32 v241,v242,4,v241
v_subrev_u32 v197,2048,v241
v_add_u32 v240,192,v205
v_mul_u32_u24 v241,745,v240
v_lshrrev_b32 v241,16,v241
v_mul_u32_u24 v242,88,v241
v_sub_u32 v240,v240,v242
v_mul_u32_u24 v241,41472,v241
v_mul_u32_u24 v242,2979,v240
v_lshrrev_b32 v242,16,v242
v_mul_u32_u24 v243,22,v242
v_sub_u32 v240,v240,v243
v_mul_u32_u24 v242,10368,v242
v_add_u32 v241,v241,v242
v_add_u32 v242,s9,v240
v_add_u32 v243,620,v240
v_cmp_gt_u32 vcc,20,v240
s_nop 1
v_cndmask_b32 v242,v243,v242,vcc
v_lshl_add_u32 v241,v242,4,v241
v_subrev_u32 v198,3072,v241
v_add_u32 v240,256,v205
v_mul_u32_u24 v241,745,v240
v_lshrrev_b32 v241,16,v241
v_mul_u32_u24 v242,88,v241
v_sub_u32 v240,v240,v242
v_mul_u32_u24 v241,41472,v241
v_mul_u32_u24 v242,2979,v240
v_lshrrev_b32 v242,16,v242
v_mul_u32_u24 v243,22,v242
v_sub_u32 v240,v240,v243
v_mul_u32_u24 v242,10368,v242
v_add_u32 v241,v241,v242
v_add_u32 v242,s9,v240
v_add_u32 v243,620,v240
v_cmp_gt_u32 vcc,20,v240
s_nop 1
v_cndmask_b32 v242,v243,v242,vcc
v_lshl_add_u32 v241,v242,4,v241
v_mov_b32 v199,v241
v_add_u32 v240,320,v205
v_mul_u32_u24 v241,745,v240
v_lshrrev_b32 v241,16,v241
v_mul_u32_u24 v242,88,v241
v_sub_u32 v240,v240,v242
v_mul_u32_u24 v241,41472,v241
v_mul_u32_u24 v242,2979,v240
v_lshrrev_b32 v242,16,v242
v_mul_u32_u24 v243,22,v242
v_sub_u32 v240,v240,v243
v_mul_u32_u24 v242,10368,v242
v_add_u32 v241,v241,v242
v_add_u32 v242,s9,v240
v_add_u32 v243,620,v240
v_cmp_gt_u32 vcc,20,v240
s_nop 1
v_cndmask_b32 v242,v243,v242,vcc
v_lshl_add_u32 v241,v242,4,v241
v_subrev_u32 v200,1024,v241
TR v[208:209],v224 offset:0
TR v[210:211],v224 offset:512
M32 v[96:111],v[212:215],v[60:63],v[96:111]
TR v[212:213],v224 offset:2048
TR v[214:215],v224 offset:2560
WT lgkmcnt(4)
M32 v[112:127],v[216:219],v[60:63],v[112:127]
TR v[216:217],v225 offset:0
TR v[218:219],v225 offset:512
M32 v[128:143],v[220:223],v[60:63],v[128:143]
TR v[220:221],v225 offset:2048
TR v[222:223],v225 offset:2560
WT lgkmcnt(4)
M32 v[80:95],v[208:211],v[64:67],v[80:95]
TR v[208:209],v224 offset:8192
TR v[210:211],v224 offset:8704
CV v250,v164,v165
CV v251,v166,v167
M32 v[96:111],v[212:215],v[64:67],v[96:111]
TR v[212:213],v224 offset:10240
TR v[214:215],v224 offset:10752
MUL v168,v168,v152
MUL v169,v169,v153
WT lgkmcnt(4)
M32 v[112:127],v[216:219],v[64:67],v[112:127]
TR v[216:217],v225 offset:8192
TR v[218:219],v225 offset:8704
MUL v170,v170,v154
MUL v171,v171,v155
M32 v[128:143],v[220:223],v[64:67],v[128:143]
TR v[220:221],v225 offset:10240
TR v[222:223],v225 offset:10752
CV v252,v168,v169
CV v253,v170,v171
WT lgkmcnt(4)
M32 v[80:95],v[208:211],v[68:71],v[80:95]
TR v[208:209],v224 offset:16384
TR v[210:211],v224 offset:16896
MUL v172,v172,v156
M32 v[96:111],v[212:215],v[68:71],v[96:111]
TR v[212:213],v224 offset:18432
TR v[214:215],v224 offset:18944
MUL v173,v173,v157
WT lgkmcnt(4)
M32 v[112:127],v[216:219],v[68:71],v[112:127]
TR v[216:217],v225 offset:16384
TR v[218:219],v225 offset:16896
MUL v174,v174,v158
M32 v[128:143],v[220:223],v[68:71],v[128:143]
TR v[220:221],v225 offset:18432
TR v[222:223],v225 offset:18944
MUL v175,v175,v159
WT lgkmcnt(4)
M32 v[80:95],v[208:211],v[72:75],v[80:95]
TR v[208:209],v224 offset:24576
TR v[210:211],v224 offset:25088
CV v254,v172,v173
M32 v[96:111],v[212:215],v[72:75],v[96:111]
TR v[212:213],v224 offset:26624
TR v[214:215],v224 offset:27136
CV v255,v174,v175
WT lgkmcnt(4)
M32 v[112:127],v[216:219],v[72:75],v[112:127]
TR v[216:217],v225 offset:24576
TR v[218:219],v225 offset:25088
v_permlane32_swap_b32 v248,v250
M32 v[128:143],v[220:223],v[72:75],v[128:143]
TR v[220:221],v225 offset:26624
TR v[222:223],v225 offset:27136
v_permlane32_swap_b32 v249,v251
WT vmcnt(0)
s_mov_b64 s[94:95],0
v_cmp_ne_u32 vcc,0x5ca1ab1e,v237
s_nop 3
s_and_b32 vcc_lo,vcc_lo,s92
s_and_b32 vcc_hi,vcc_hi,s92
s_or_b64 s[94:95],s[94:95],vcc
v_cmp_ne_u32 vcc,0x5ca1ab1e,v232
s_nop 3
s_and_b32 vcc_lo,vcc_lo,s92
s_and_b32 vcc_hi,vcc_hi,0x0
s_or_b64 s[94:95],s[94:95],vcc
s_cmp_eq_u64 s[94:95],0
s_cselect_b32 s93,1,0
s_cbranch_scc0 ER_skip2
s_cmp_eq_u32 s43,1
s_cbranch_scc1 T1_h2
s_lshl_b32 s9,s31,1
s_lshl_b32 s10,s5,3
SADD s9,s9,s10
s_mul_i32 s7,s9,40960
SADD s7,s7,s18
s_and_b32 s10,s4,1
s_lshl_b32 s9,s10,9
SADD s8,s7,s9
s_cmp_eq_u32 s10,0
s_cselect_b32 s9,1024,8
SADD s7,s7,s9
AND v241,31,v205
SHL v242,4,v241
BL4 v[176:179],v204,s[24:27],s8 offen sc1
buffer_load_dwordx2 v[184:185],v242,s[24:27],s7 offen sc1
SADD s8,s8,40960
SADD s7,s7,40960
BL4 v[180:183],v204,s[24:27],s8 offen sc1
buffer_load_dwordx2 v[186:187],v242,s[24:27],s7 offen sc1
s_branch T1_j2
T1_h2:
s_mov_b32 s13,s6
s_mov_b32 s14,0
s_mov_b32 s15,4
s_mul_i32 s7,s13,655360
SADD s7,s7,s11
s_mul_i32 s33,s13,663552
SADD s33,s33,s12
s_cmp_eq_u32 s15,0
s_cselect_b32 s7,0x7ff00000,s7
s_cselect_b32 s33,0x7ff00000,s33
SADD s34,s7,81920
SADD s8,s14,s22
SADD s21,s14,s23
SADD s13,s13,1
s_and_b32 s13,s13,3
SADD s14,s14,47104
s_cmp_eq_u32 s14,141312
s_cselect_b32 s14,0,s14
s_cmp_lg_u32 s15,0
s_subb_u32 s15,s15,0
SADD m0,s8,0
s_nop 0
BL4 v192,s[24:27],s7 offen sc1 lds
SADD m0,s8,1024
s_nop 0
BL4 v193,s[24:27],s7 offen sc1 lds
SADD m0,s8,2048
s_nop 0
BL4 v194,s[24:27],s7 offen sc1 lds
SADD m0,s8,3072
s_nop 0
BL4 v192,s[24:27],s34 offen sc1 lds
SADD m0,s8,4096
s_nop 0
BL4 v193,s[24:27],s34 offen sc1 lds
SADD m0,s8,5120
s_nop 0
BL4 v194,s[24:27],s34 offen sc1 lds
s_mov_b32 m0,s21
s_nop 0
BL4 v195,s[24:27],s33 offen sc1 lds
s_mov_b32 m0,s21
s_nop 0
BL4 v196,s[24:27],s33 offen offset:1024 sc1 lds
s_mov_b32 m0,s21
s_nop 0
BL4 v197,s[24:27],s33 offen offset:2048 sc1 lds
s_mov_b32 m0,s21
s_nop 0
BL4 v198,s[24:27],s33 offen offset:3072 sc1 lds
SADD m0,s21,4096
s_nop 0
BL4 v199,s[24:27],s33 offen sc1 lds
SADD m0,s21,4096
s_mov_b32 exec_hi,0
BL4 v200,s[24:27],s33 offen offset:1024 sc1 lds
s_mov_b32 exec_hi,-1
T1_j2:
ER_skip2:
WT lgkmcnt(4)
s_nop 2
M32 v[80:95],v[208:211],v[76:79],v[80:95]
v_permlane32_swap_b32 v252,v254
M32 v[96:111],v[212:215],v[76:79],v[96:111]
v_permlane32_swap_b32 v253,v255
WT lgkmcnt(0)
M32 v[112:127],v[216:219],v[76:79],v[112:127]
BS4 v[248:251],v234,s[24:27],s55 offen sc1
M32 v[128:143],v[220:223],v[76:79],v[128:143]
BS4 v[252:255],v234,s[24:27],s55 offen offset:1024 sc1
s_nop 11
s_barrier
s_lshl_b32 s53,s30,13
SADD s53,s53,65536
v_add_u32 v238,s53,v234
s_xor_b32 s53,s30,4
s_lshl_b32 s53,s53,13
SADD s53,s53,65536
v_add_u32 v239,s53,v234
ds_write_b128 v238,v[112:115] offset:0
ds_write_b128 v238,v[116:119] offset:1024
ds_write_b128 v238,v[120:123] offset:2048
ds_write_b128 v238,v[124:127] offset:3072
ds_write_b128 v238,v[128:131] offset:4096
ds_write_b128 v238,v[132:135] offset:5120
ds_write_b128 v238,v[136:139] offset:6144
ds_write_b128 v238,v[140:143] offset:7168
s_lshl_b32 s91,s28,9
s_lshl_b32 s89,s29,5
SADD s91,s91,s89
s_lshl_b32 s89,s30,2
SADD s91,s91,s89
SADD s91,s91,23463936
s_cmp_eq_u32 s93,1
s_cbranch_scc1 T1_go3
WT vmcnt(2)
s_mov_b64 s[94:95],0
v_cmp_ne_u32 vcc,0x5ca1ab1e,v237
s_nop 3
s_and_b32 vcc_lo,vcc_lo,s92
s_and_b32 vcc_hi,vcc_hi,s92
s_or_b64 s[94:95],s[94:95],vcc
v_cmp_ne_u32 vcc,0x5ca1ab1e,v232
s_nop 3
s_and_b32 vcc_lo,vcc_lo,s92
s_and_b32 vcc_hi,vcc_hi,0x0
s_or_b64 s[94:95],s[94:95],vcc
s_cmp_eq_u64 s[94:95],0
s_cbranch_scc1 T1_go3
s_mov_b32 s52,0
T1_spin3:
buffer_load_dword v20,v235,s[24:27],0 offen sc1
buffer_load_dword v21,v236,s[24:27],0 offen sc1
WT vmcnt(0)
s_mov_b64 s[94:95],0
v_cmp_ne_u32 vcc,0x5ca1ab1e,v20
s_nop 3
s_and_b32 vcc_lo,vcc_lo,s92
s_and_b32 vcc_hi,vcc_hi,s92
s_or_b64 s[94:95],s[94:95],vcc
v_cmp_ne_u32 vcc,0x5ca1ab1e,v21
s_nop 3
s_and_b32 vcc_lo,vcc_lo,s92
s_and_b32 vcc_hi,vcc_hi,0x0
s_or_b64 s[94:95],s[94:95],vcc
s_cmp_eq_u64 s[94:95],0
s_cbranch_scc1 T1_spin3_ok
SADD s52,s52,1
s_cmp_lt_u32 s52,200000
s_cbranch_scc0 T1_spin3_ok
s_sleep 2
s_branch T1_spin3
T1_spin3_ok:
T1_go3:
s_cmp_eq_u32 s93,1
s_cbranch_scc1 T1_done4
s_cmp_eq_u32 s43,1
s_cbranch_scc1 T1_h4
s_lshl_b32 s9,s31,1
s_lshl_b32 s10,s5,3
SADD s9,s9,s10
s_mul_i32 s7,s9,40960
SADD s7,s7,s18
s_and_b32 s10,s4,1
s_lshl_b32 s9,s10,9
SADD s8,s7,s9
s_cmp_eq_u32 s10,0
s_cselect_b32 s9,1024,8
SADD s7,s7,s9
AND v41,31,v205
SHL v42,4,v41
BL4 v[176:179],v204,s[24:27],s8 offen sc1
buffer_load_dwordx2 v[184:185],v42,s[24:27],s7 offen sc1
SADD s8,s8,40960
SADD s7,s7,40960
BL4 v[180:183],v204,s[24:27],s8 offen sc1
buffer_load_dwordx2 v[186:187],v42,s[24:27],s7 offen sc1
s_branch T1_j4
T1_h4:
s_mov_b32 s13,s6
s_mov_b32 s14,0
s_mov_b32 s15,4
s_mul_i32 s7,s13,655360
SADD s7,s7,s11
s_mul_i32 s33,s13,663552
SADD s33,s33,s12
s_cmp_eq_u32 s15,0
s_cselect_b32 s7,0x7ff00000,s7
s_cselect_b32 s33,0x7ff00000,s33
SADD s34,s7,81920
SADD s8,s14,s22
SADD s21,s14,s23
SADD s13,s13,1
s_and_b32 s13,s13,3
SADD s14,s14,47104
s_cmp_eq_u32 s14,141312
s_cselect_b32 s14,0,s14
s_cmp_lg_u32 s15,0
s_subb_u32 s15,s15,0
SADD m0,s8,0
s_nop 0
BL4 v192,s[24:27],s7 offen sc1 lds
SADD m0,s8,1024
s_nop 0
BL4 v193,s[24:27],s7 offen sc1 lds
SADD m0,s8,2048
s_nop 0
BL4 v194,s[24:27],s7 offen sc1 lds
SADD m0,s8,3072
s_nop 0
BL4 v192,s[24:27],s34 offen sc1 lds
SADD m0,s8,4096
s_nop 0
BL4 v193,s[24:27],s34 offen sc1 lds
SADD m0,s8,5120
s_nop 0
BL4 v194,s[24:27],s34 offen sc1 lds
s_mov_b32 m0,s21
s_nop 0
BL4 v195,s[24:27],s33 offen sc1 lds
s_mov_b32 m0,s21
s_nop 0
BL4 v196,s[24:27],s33 offen offset:1024 sc1 lds
s_mov_b32 m0,s21
s_nop 0
BL4 v197,s[24:27],s33 offen offset:2048 sc1 lds
s_mov_b32 m0,s21
s_nop 0
BL4 v198,s[24:27],s33 offen offset:3072 sc1 lds
SADD m0,s21,4096
s_nop 0
BL4 v199,s[24:27],s33 offen sc1 lds
SADD m0,s21,4096
s_mov_b32 exec_hi,0
BL4 v200,s[24:27],s33 offen offset:1024 sc1 lds
s_mov_b32 exec_hi,-1
T1_j4:
T1_done4:
WT lgkmcnt(0)
s_barrier
R128 v[44:47],v239 offset:0
R128 v[48:51],v239 offset:1024
R128 v[52:55],v239 offset:2048
R128 v[56:59],v239 offset:3072
R128 v[0:3],v239 offset:4096
R128 v[4:7],v239 offset:5120
R128 v[8:11],v239 offset:6144
R128 v[12:15],v239 offset:7168
WT lgkmcnt(4)
ADD v80,v80,v44
ADD v81,v81,v45
ADD v82,v82,v46
ADD v83,v83,v47
ADD v84,v84,v48
ADD v85,v85,v49
ADD v86,v86,v50
ADD v87,v87,v51
ADD v88,v88,v52
ADD v89,v89,v53
ADD v90,v90,v54
ADD v91,v91,v55
ADD v92,v92,v56
ADD v93,v93,v57
ADD v94,v94,v58
ADD v95,v95,v59
WT lgkmcnt(0)
ADD v96,v96,v0
ADD v97,v97,v1
ADD v98,v98,v2
ADD v99,v99,v3
ADD v100,v100,v4
ADD v101,v101,v5
ADD v102,v102,v6
ADD v103,v103,v7
ADD v104,v104,v8
ADD v105,v105,v9
ADD v106,v106,v10
ADD v107,v107,v11
ADD v108,v108,v12
ADD v109,v109,v13
ADD v110,v110,v14
ADD v111,v111,v15
s_mul_i32 s55,s57,110592
s_lshl_b32 s53,s61,12
SADD s55,s55,s53
s_lshl_b32 s53,s48,11
SADD s55,s55,s53
SADD s55,s55,8126464
MUL v80,0xbfb8aa3b,v80
MUL v81,0xbfb8aa3b,v81
MUL v82,0xbfb8aa3b,v82
MUL v83,0xbfb8aa3b,v83
EX v80,v80
EX v81,v81
EX v82,v82
EX v83,v83
MUL v84,0xbfb8aa3b,v84
MUL v85,0xbfb8aa3b,v85
MUL v86,0xbfb8aa3b,v86
MUL v87,0xbfb8aa3b,v87
EX v84,v84
EX v85,v85
EX v86,v86
EX v87,v87
MUL v88,0xbfb8aa3b,v88
MUL v89,0xbfb8aa3b,v89
MUL v90,0xbfb8aa3b,v90
MUL v91,0xbfb8aa3b,v91
EX v88,v88
EX v89,v89
EX v90,v90
EX v91,v91
MUL v92,0xbfb8aa3b,v92
MUL v93,0xbfb8aa3b,v93
MUL v94,0xbfb8aa3b,v94
MUL v95,0xbfb8aa3b,v95
EX v92,v92
EX v93,v93
EX v94,v94
EX v95,v95
ADD v80,1.0,v80
ADD v81,1.0,v81
ADD v82,1.0,v82
ADD v83,1.0,v83
RCP v80,v80
RCP v81,v81
RCP v82,v82
RCP v83,v83
ADD v84,1.0,v84
ADD v85,1.0,v85
ADD v86,1.0,v86
ADD v87,1.0,v87
RCP v84,v84
RCP v85,v85
RCP v86,v86
RCP v87,v87
ADD v88,1.0,v88
ADD v89,1.0,v89
ADD v90,1.0,v90
ADD v91,1.0,v91
RCP v88,v88
RCP v89,v89
RCP v90,v90
RCP v91,v91
ADD v92,1.0,v92
ADD v93,1.0,v93
ADD v94,1.0,v94
ADD v95,1.0,v95
RCP v92,v92
RCP v93,v93
RCP v94,v94
RCP v95,v95
MUL v96,v96,v80
MUL v97,v97,v81
MUL v98,v98,v82
MUL v99,v99,v83
CV v248,v96,v97
CV v249,v98,v99
MUL v100,v100,v84
MUL v101,v101,v85
MUL v102,v102,v86
MUL v103,v103,v87
CV v250,v100,v101
CV v251,v102,v103
MUL v104,v104,v88
MUL v105,v105,v89
MUL v106,v106,v90
MUL v107,v107,v91
CV v252,v104,v105
CV v253,v106,v107
MUL v108,v108,v92
MUL v109,v109,v93
MUL v110,v110,v94
MUL v111,v111,v95
CV v254,v108,v109
CV v255,v110,v111
v_permlane32_swap_b32 v248,v250
v_permlane32_swap_b32 v249,v251
v_permlane32_swap_b32 v252,v254
v_permlane32_swap_b32 v253,v255
BS4 v[248:251],v234,s[24:27],s55 offen sc1
BS4 v[252:255],v234,s[24:27],s55 offen offset:1024 sc1
s_branch T1_common
K1_v:
WT lgkmcnt(4)
M32 v[80:95],v[0:3],v[208:211],0
TR v[208:209],v224 offset:8192
TR v[210:211],v224 offset:8704
SHL v248,16,v16
SHL v250,16,v17
SHL v252,16,v18
SHL v254,16,v19
AND v249,0xffff0000,v16
M32 v[96:111],v[0:3],v[212:215],0
TR v[212:213],v224 offset:10240
TR v[214:215],v224 offset:10752
SADD m0,s47,65536
AND v251,0xffff0000,v17
AND v253,0xffff0000,v18
AND v255,0xffff0000,v19
FMA v248,v248,v232,v233
FMA v250,v250,v232,v233
WT lgkmcnt(4)
M32 v[112:127],v[0:3],v[216:219],0
TR v[216:217],v225 offset:8192
TR v[218:219],v225 offset:8704
FMA v252,v252,v232,v233
FMA v254,v254,v232,v233
FMA v249,v249,v232,v233
FMA v251,v251,v232,v233
FMA v253,v253,v232,v233
M32 v[128:143],v[0:3],v[220:223],0
TR v[220:221],v225 offset:10240
TR v[222:223],v225 offset:10752
BL4 v228,s[8:11],s34 offen lds
FMA v255,v255,v232,v233
CV v16,v248,v249
CV v17,v250,v251
CV v18,v252,v253
CV v19,v254,v255
WT lgkmcnt(4)
M32 v[80:95],v[4:7],v[208:211],v[80:95]
TR v[208:209],v224 offset:16384
TR v[210:211],v224 offset:16896
SHL v248,16,v20
SHL v250,16,v21
SHL v252,16,v22
SHL v254,16,v23
AND v249,0xffff0000,v20
M32 v[96:111],v[4:7],v[212:215],v[96:111]
TR v[212:213],v224 offset:18432
TR v[214:215],v224 offset:18944
BL4 v229,s[8:11],s34 offen offset:1024 lds
AND v251,0xffff0000,v21
AND v253,0xffff0000,v22
AND v255,0xffff0000,v23
FMA v248,v248,v232,v233
FMA v250,v250,v232,v233
WT lgkmcnt(4)
M32 v[112:127],v[4:7],v[216:219],v[112:127]
TR v[216:217],v225 offset:16384
TR v[218:219],v225 offset:16896
FMA v252,v252,v232,v233
FMA v254,v254,v232,v233
FMA v249,v249,v232,v233
FMA v251,v251,v232,v233
FMA v253,v253,v232,v233
M32 v[128:143],v[4:7],v[220:223],v[128:143]
TR v[220:221],v225 offset:18432
TR v[222:223],v225 offset:18944
BL4 v230,s[12:15],s34 offen offset:2048 lds
FMA v255,v255,v232,v233
CV v20,v248,v249
CV v21,v250,v251
CV v22,v252,v253
CV v23,v254,v255
WT lgkmcnt(4)
M32 v[80:95],v[8:11],v[208:211],v[80:95]
TR v[208:209],v224 offset:24576
TR v[210:211],v224 offset:25088
SHL v248,16,v24
SHL v250,16,v25
SHL v252,16,v26
SHL v254,16,v27
AND v249,0xffff0000,v24
M32 v[96:111],v[8:11],v[212:215],v[96:111]
TR v[212:213],v224 offset:26624
TR v[214:215],v224 offset:27136
BL4 v231,s[12:15],s34 offen offset:3072 lds
AND v251,0xffff0000,v25
AND v253,0xffff0000,v26
AND v255,0xffff0000,v27
FMA v248,v248,v232,v233
FMA v250,v250,v232,v233
WT lgkmcnt(4)
M32 v[112:127],v[8:11],v[216:219],v[112:127]
TR v[216:217],v225 offset:24576
TR v[218:219],v225 offset:25088
FMA v252,v252,v232,v233
FMA v254,v254,v232,v233
FMA v249,v249,v232,v233
FMA v251,v251,v232,v233
FMA v253,v253,v232,v233
M32 v[128:143],v[8:11],v[220:223],v[128:143]
TR v[220:221],v225 offset:26624
TR v[222:223],v225 offset:27136
FMA v255,v255,v232,v233
CV v24,v248,v249
CV v25,v250,v251
CV v26,v252,v253
CV v27,v254,v255
WT lgkmcnt(4)
M32 v[80:95],v[12:15],v[208:211],v[80:95]
WT vmcnt(4)
s_barrier
v_add_u32 v224,32768,v226
v_add_u32 v225,32768,v227
TR v[208:209],v224 offset:0
TR v[210:211],v224 offset:512
SHL v248,16,v28
SHL v250,16,v29
SHL v252,16,v30
SHL v254,16,v31
AND v249,0xffff0000,v28
M32 v[96:111],v[12:15],v[212:215],v[96:111]
TR v[212:213],v224 offset:2048
TR v[214:215],v224 offset:2560
AND v251,0xffff0000,v29
AND v253,0xffff0000,v30
AND v255,0xffff0000,v31
FMA v248,v248,v232,v233
FMA v250,v250,v232,v233
WT lgkmcnt(4)
M32 v[112:127],v[12:15],v[216:219],v[112:127]
TR v[216:217],v225 offset:0
TR v[218:219],v225 offset:512
FMA v252,v252,v232,v233
FMA v254,v254,v232,v233
FMA v249,v249,v232,v233
FMA v251,v251,v232,v233
FMA v253,v253,v232,v233
M32 v[128:143],v[12:15],v[220:223],v[128:143]
TR v[220:221],v225 offset:2048
TR v[222:223],v225 offset:2560
FMA v255,v255,v232,v233
CV v28,v248,v249
CV v29,v250,v251
CV v30,v252,v253
CV v31,v254,v255
WT lgkmcnt(4)
M32 v[80:95],v[16:19],v[208:211],v[80:95]
TR v[208:209],v224 offset:8192
TR v[210:211],v224 offset:8704
SHL v248,16,v32
SHL v250,16,v33
SHL v252,16,v34
SHL v254,16,v35
AND v249,0xffff0000,v32
M32 v[96:111],v[16:19],v[212:215],v[96:111]
TR v[212:213],v224 offset:10240
TR v[214:215],v224 offset:10752
SADD m0,s47,98304
AND v251,0xffff0000,v33
AND v253,0xffff0000,v34
AND v255,0xffff0000,v35
FMA v248,v248,v232,v233
FMA v250,v250,v232,v233
WT lgkmcnt(4)
M32 v[112:127],v[16:19],v[216:219],v[112:127]
TR v[216:217],v225 offset:8192
TR v[218:219],v225 offset:8704
FMA v252,v252,v232,v233
FMA v254,v254,v232,v233
FMA v249,v249,v232,v233
FMA v251,v251,v232,v233
FMA v253,v253,v232,v233
M32 v[128:143],v[16:19],v[220:223],v[128:143]
TR v[220:221],v225 offset:10240
TR v[222:223],v225 offset:10752
BL4 v228,s[8:11],s35 offen lds
FMA v255,v255,v232,v233
CV v32,v248,v249
CV v33,v250,v251
CV v34,v252,v253
CV v35,v254,v255
WT lgkmcnt(4)
M32 v[80:95],v[20:23],v[208:211],v[80:95]
TR v[208:209],v224 offset:16384
TR v[210:211],v224 offset:16896
SHL v248,16,v36
SHL v250,16,v37
SHL v252,16,v38
SHL v254,16,v39
AND v249,0xffff0000,v36
M32 v[96:111],v[20:23],v[212:215],v[96:111]
TR v[212:213],v224 offset:18432
TR v[214:215],v224 offset:18944
BL4 v229,s[8:11],s35 offen offset:1024 lds
AND v251,0xffff0000,v37
AND v253,0xffff0000,v38
AND v255,0xffff0000,v39
FMA v248,v248,v232,v233
FMA v250,v250,v232,v233
WT lgkmcnt(4)
M32 v[112:127],v[20:23],v[216:219],v[112:127]
TR v[216:217],v225 offset:16384
TR v[218:219],v225 offset:16896
FMA v252,v252,v232,v233
FMA v254,v254,v232,v233
FMA v249,v249,v232,v233
FMA v251,v251,v232,v233
FMA v253,v253,v232,v233
M32 v[128:143],v[20:23],v[220:223],v[128:143]
TR v[220:221],v225 offset:18432
TR v[222:223],v225 offset:18944
BL4 v230,s[12:15],s35 offen offset:2048 lds
FMA v255,v255,v232,v233
CV v36,v248,v249
CV v37,v250,v251
CV v38,v252,v253
CV v39,v254,v255
WT lgkmcnt(4)
M32 v[80:95],v[24:27],v[208:211],v[80:95]
TR v[208:209],v224 offset:24576
TR v[210:211],v224 offset:25088
SHL v248,16,v40
SHL v250,16,v41
SHL v252,16,v42
SHL v254,16,v43
AND v249,0xffff0000,v40
M32 v[96:111],v[24:27],v[212:215],v[96:111]
TR v[212:213],v224 offset:26624
TR v[214:215],v224 offset:27136
BL4 v231,s[12:15],s35 offen offset:3072 lds
AND v251,0xffff0000,v41
AND v253,0xffff0000,v42
AND v255,0xffff0000,v43
FMA v248,v248,v232,v233
FMA v250,v250,v232,v233
WT lgkmcnt(4)
M32 v[112:127],v[24:27],v[216:219],v[112:127]
TR v[216:217],v225 offset:24576
TR v[218:219],v225 offset:25088
FMA v252,v252,v232,v233
FMA v254,v254,v232,v233
FMA v249,v249,v232,v233
FMA v251,v251,v232,v233
FMA v253,v253,v232,v233
M32 v[128:143],v[24:27],v[220:223],v[128:143]
TR v[220:221],v225 offset:26624
TR v[222:223],v225 offset:27136
FMA v255,v255,v232,v233
CV v40,v248,v249
CV v41,v250,v251
CV v42,v252,v253
CV v43,v254,v255
WT lgkmcnt(4)
M32 v[80:95],v[28:31],v[208:211],v[80:95]
WT vmcnt(4)
s_barrier
v_add_u32 v224,65536,v226
v_add_u32 v225,65536,v227
TR v[208:209],v224 offset:0
TR v[210:211],v224 offset:512
SHL v248,16,v44
SHL v250,16,v45
SHL v252,16,v46
SHL v254,16,v47
AND v249,0xffff0000,v44
M32 v[96:111],v[28:31],v[212:215],v[96:111]
TR v[212:213],v224 offset:2048
TR v[214:215],v224 offset:2560
AND v251,0xffff0000,v45
AND v253,0xffff0000,v46
AND v255,0xffff0000,v47
FMA v248,v248,v232,v233
FMA v250,v250,v232,v233
WT lgkmcnt(4)
M32 v[112:127],v[28:31],v[216:219],v[112:127]
TR v[216:217],v225 offset:0
TR v[218:219],v225 offset:512
FMA v252,v252,v232,v233
FMA v254,v254,v232,v233
FMA v249,v249,v232,v233
FMA v251,v251,v232,v233
FMA v253,v253,v232,v233
M32 v[128:143],v[28:31],v[220:223],v[128:143]
TR v[220:221],v225 offset:2048
TR v[222:223],v225 offset:2560
FMA v255,v255,v232,v233
CV v44,v248,v249
CV v45,v250,v251
CV v46,v252,v253
CV v47,v254,v255
WT lgkmcnt(4)
M32 v[80:95],v[32:35],v[208:211],v[80:95]
TR v[208:209],v224 offset:8192
TR v[210:211],v224 offset:8704
SHL v248,16,v48
SHL v250,16,v49
SHL v252,16,v50
SHL v254,16,v51
AND v249,0xffff0000,v48
M32 v[96:111],v[32:35],v[212:215],v[96:111]
TR v[212:213],v224 offset:10240
TR v[214:215],v224 offset:10752
SADD m0,s47,0
AND v251,0xffff0000,v49
AND v253,0xffff0000,v50
AND v255,0xffff0000,v51
FMA v248,v248,v232,v233
FMA v250,v250,v232,v233
WT lgkmcnt(4)
M32 v[112:127],v[32:35],v[216:219],v[112:127]
TR v[216:217],v225 offset:8192
TR v[218:219],v225 offset:8704
FMA v252,v252,v232,v233
FMA v254,v254,v232,v233
FMA v249,v249,v232,v233
FMA v251,v251,v232,v233
FMA v253,v253,v232,v233
M32 v[128:143],v[32:35],v[220:223],v[128:143]
TR v[220:221],v225 offset:10240
TR v[222:223],v225 offset:10752
BL4 v228,s[8:11],s36 offen lds
FMA v255,v255,v232,v233
CV v48,v248,v249
CV v49,v250,v251
CV v50,v252,v253
CV v51,v254,v255
WT lgkmcnt(4)
M32 v[80:95],v[36:39],v[208:211],v[80:95]
TR v[208:209],v224 offset:16384
TR v[210:211],v224 offset:16896
SHL v248,16,v52
SHL v250,16,v53
SHL v252,16,v54
SHL v254,16,v55
AND v249,0xffff0000,v52
M32 v[96:111],v[36:39],v[212:215],v[96:111]
TR v[212:213],v224 offset:18432
TR v[214:215],v224 offset:18944
BL4 v229,s[8:11],s36 offen offset:1024 lds
AND v251,0xffff0000,v53
AND v253,0xffff0000,v54
AND v255,0xffff0000,v55
FMA v248,v248,v232,v233
FMA v250,v250,v232,v233
WT lgkmcnt(4)
M32 v[112:127],v[36:39],v[216:219],v[112:127]
TR v[216:217],v225 offset:16384
TR v[218:219],v225 offset:16896
FMA v252,v252,v232,v233
FMA v254,v254,v232,v233
FMA v249,v249,v232,v233
FMA v251,v251,v232,v233
FMA v253,v253,v232,v233
M32 v[128:143],v[36:39],v[220:223],v[128:143]
TR v[220:221],v225 offset:18432
TR v[222:223],v225 offset:18944
BL4 v230,s[12:15],s36 offen offset:2048 lds
FMA v255,v255,v232,v233
CV v52,v248,v249
CV v53,v250,v251
CV v54,v252,v253
CV v55,v254,v255
WT lgkmcnt(4)
M32 v[80:95],v[40:43],v[208:211],v[80:95]
TR v[208:209],v224 offset:24576
TR v[210:211],v224 offset:25088
SHL v248,16,v56
SHL v250,16,v57
SHL v252,16,v58
SHL v254,16,v59
AND v249,0xffff0000,v56
M32 v[96:111],v[40:43],v[212:215],v[96:111]
TR v[212:213],v224 offset:26624
TR v[214:215],v224 offset:27136
BL4 v231,s[12:15],s36 offen offset:3072 lds
AND v251,0xffff0000,v57
AND v253,0xffff0000,v58
AND v255,0xffff0000,v59
FMA v248,v248,v232,v233
FMA v250,v250,v232,v233
WT lgkmcnt(4)
M32 v[112:127],v[40:43],v[216:219],v[112:127]
TR v[216:217],v225 offset:24576
TR v[218:219],v225 offset:25088
FMA v252,v252,v232,v233
FMA v254,v254,v232,v233
FMA v249,v249,v232,v233
FMA v251,v251,v232,v233
FMA v253,v253,v232,v233
M32 v[128:143],v[40:43],v[220:223],v[128:143]
TR v[220:221],v225 offset:26624
TR v[222:223],v225 offset:27136
FMA v255,v255,v232,v233
CV v56,v248,v249
CV v57,v250,v251
CV v58,v252,v253
CV v59,v254,v255
WT lgkmcnt(4)
M32 v[80:95],v[44:47],v[208:211],v[80:95]
WT vmcnt(4)
s_barrier
v_add_u32 v224,98304,v226
v_add_u32 v225,98304,v227
TR v[208:209],v224 offset:0
TR v[210:211],v224 offset:512
SHL v248,16,v60
SHL v250,16,v61
SHL v252,16,v62
SHL v254,16,v63
AND v249,0xffff0000,v60
M32 v[96:111],v[44:47],v[212:215],v[96:111]
TR v[212:213],v224 offset:2048
TR v[214:215],v224 offset:2560
AND v251,0xffff0000,v61
AND v253,0xffff0000,v62
AND v255,0xffff0000,v63
FMA v248,v248,v232,v233
FMA v250,v250,v232,v233
WT lgkmcnt(4)
M32 v[112:127],v[44:47],v[216:219],v[112:127]
TR v[216:217],v225 offset:0
TR v[218:219],v225 offset:512
FMA v252,v252,v232,v233
FMA v254,v254,v232,v233
FMA v249,v249,v232,v233
FMA v251,v251,v232,v233
FMA v253,v253,v232,v233
M32 v[128:143],v[44:47],v[220:223],v[128:143]
TR v[220:221],v225 offset:2048
TR v[222:223],v225 offset:2560
FMA v255,v255,v232,v233
CV v60,v248,v249
CV v61,v250,v251
CV v62,v252,v253
CV v63,v254,v255
WT lgkmcnt(4)
M32 v[80:95],v[48:51],v[208:211],v[80:95]
TR v[208:209],v224 offset:8192
TR v[210:211],v224 offset:8704
SHL v248,16,v64
SHL v250,16,v65
SHL v252,16,v66
SHL v254,16,v67
AND v249,0xffff0000,v64
M32 v[96:111],v[48:51],v[212:215],v[96:111]
TR v[212:213],v224 offset:10240
TR v[214:215],v224 offset:10752
v_lshrrev_b32 v247,7,v234
v_mul_u32_u24 v247,384,v247
AND v251,0xffff0000,v65
AND v253,0xffff0000,v66
AND v255,0xffff0000,v67
FMA v248,v248,v232,v233
FMA v250,v250,v232,v233
WT lgkmcnt(4)
M32 v[112:127],v[48:51],v[216:219],v[112:127]
TR v[216:217],v225 offset:8192
TR v[218:219],v225 offset:8704
FMA v252,v252,v232,v233
FMA v254,v254,v232,v233
FMA v249,v249,v232,v233
FMA v251,v251,v232,v233
FMA v253,v253,v232,v233
M32 v[128:143],v[48:51],v[220:223],v[128:143]
TR v[220:221],v225 offset:10240
TR v[222:223],v225 offset:10752
v_sub_u32 v228,v228,v247
v_sub_u32 v229,v229,v247
FMA v255,v255,v232,v233
CV v64,v248,v249
CV v65,v250,v251
CV v66,v252,v253
CV v67,v254,v255
WT lgkmcnt(4)
M32 v[80:95],v[52:55],v[208:211],v[80:95]
TR v[208:209],v224 offset:16384
TR v[210:211],v224 offset:16896
SHL v248,16,v68
SHL v250,16,v69
SHL v252,16,v70
SHL v254,16,v71
AND v249,0xffff0000,v68
M32 v[96:111],v[52:55],v[212:215],v[96:111]
TR v[212:213],v224 offset:18432
TR v[214:215],v224 offset:18944
v_subrev_u32 v229,3072,v229
v_sub_u32 v230,v230,v247
AND v251,0xffff0000,v69
AND v253,0xffff0000,v70
AND v255,0xffff0000,v71
FMA v248,v248,v232,v233
FMA v250,v250,v232,v233
WT lgkmcnt(4)
M32 v[112:127],v[52:55],v[216:219],v[112:127]
TR v[216:217],v225 offset:16384
TR v[218:219],v225 offset:16896
FMA v252,v252,v232,v233
FMA v254,v254,v232,v233
FMA v249,v249,v232,v233
FMA v251,v251,v232,v233
FMA v253,v253,v232,v233
M32 v[128:143],v[52:55],v[220:223],v[128:143]
TR v[220:221],v225 offset:18432
TR v[222:223],v225 offset:18944
v_sub_u32 v231,v231,v247
v_subrev_u32 v231,3072,v231
FMA v255,v255,v232,v233
CV v68,v248,v249
CV v69,v250,v251
CV v70,v252,v253
CV v71,v254,v255
WT lgkmcnt(4)
M32 v[80:95],v[56:59],v[208:211],v[80:95]
TR v[208:209],v224 offset:24576
TR v[210:211],v224 offset:25088
SHL v248,16,v72
SHL v250,16,v73
SHL v252,16,v74
SHL v254,16,v75
AND v249,0xffff0000,v72
M32 v[96:111],v[56:59],v[212:215],v[96:111]
TR v[212:213],v224 offset:26624
TR v[214:215],v224 offset:27136
SADD m0,s47,32768
AND v251,0xffff0000,v73
AND v253,0xffff0000,v74
AND v255,0xffff0000,v75
FMA v248,v248,v232,v233
FMA v250,v250,v232,v233
WT lgkmcnt(4)
M32 v[112:127],v[56:59],v[216:219],v[112:127]
TR v[216:217],v225 offset:24576
TR v[218:219],v225 offset:25088
FMA v252,v252,v232,v233
FMA v254,v254,v232,v233
FMA v249,v249,v232,v233
FMA v251,v251,v232,v233
FMA v253,v253,v232,v233
M32 v[128:143],v[56:59],v[220:223],v[128:143]
TR v[220:221],v225 offset:26624
TR v[222:223],v225 offset:27136
BL4 v228,s[16:19],s37 offen lds
FMA v255,v255,v232,v233
CV v72,v248,v249
CV v73,v250,v251
CV v74,v252,v253
CV v75,v254,v255
WT lgkmcnt(4)
M32 v[80:95],v[60:63],v[208:211],v[80:95]
WT vmcnt(1)
s_barrier
v_mov_b32 v224,v226
v_mov_b32 v225,v227
TR v[208:209],v224 offset:0
TR v[210:211],v224 offset:512
SHL v248,16,v76
SHL v250,16,v77
SHL v252,16,v78
SHL v254,16,v79
AND v249,0xffff0000,v76
M32 v[96:111],v[60:63],v[212:215],v[96:111]
TR v[212:213],v224 offset:2048
TR v[214:215],v224 offset:2560
BL4 v229,s[16:19],s37 offen offset:1024 lds
AND v251,0xffff0000,v77
AND v253,0xffff0000,v78
AND v255,0xffff0000,v79
FMA v248,v248,v232,v233
FMA v250,v250,v232,v233
WT lgkmcnt(4)
M32 v[112:127],v[60:63],v[216:219],v[112:127]
TR v[216:217],v225 offset:0
TR v[218:219],v225 offset:512
FMA v252,v252,v232,v233
FMA v254,v254,v232,v233
FMA v249,v249,v232,v233
FMA v251,v251,v232,v233
FMA v253,v253,v232,v233
M32 v[128:143],v[60:63],v[220:223],v[128:143]
TR v[220:221],v225 offset:2048
TR v[222:223],v225 offset:2560
BL4 v230,s[20:23],s37 offen offset:2048 lds
FMA v255,v255,v232,v233
CV v76,v248,v249
CV v77,v250,v251
CV v78,v252,v253
CV v79,v254,v255
BL4 v231,s[20:23],s37 offen offset:3072 lds
WT lgkmcnt(4)
M32 v[80:95],v[64:67],v[208:211],v[80:95]
TR v[208:209],v224 offset:8192
TR v[210:211],v224 offset:8704
M32 v[96:111],v[64:67],v[212:215],v[96:111]
TR v[212:213],v224 offset:10240
TR v[214:215],v224 offset:10752
SADD m0,s47,65536
WT lgkmcnt(4)
M32 v[112:127],v[64:67],v[216:219],v[112:127]
TR v[216:217],v225 offset:8192
TR v[218:219],v225 offset:8704
M32 v[128:143],v[64:67],v[220:223],v[128:143]
TR v[220:221],v225 offset:10240
TR v[222:223],v225 offset:10752
BL4 v228,s[16:19],s38 offen lds
WT lgkmcnt(4)
M32 v[80:95],v[68:71],v[208:211],v[80:95]
TR v[208:209],v224 offset:16384
TR v[210:211],v224 offset:16896
M32 v[96:111],v[68:71],v[212:215],v[96:111]
TR v[212:213],v224 offset:18432
TR v[214:215],v224 offset:18944
BL4 v229,s[16:19],s38 offen offset:1024 lds
WT lgkmcnt(4)
M32 v[112:127],v[68:71],v[216:219],v[112:127]
TR v[216:217],v225 offset:16384
TR v[218:219],v225 offset:16896
M32 v[128:143],v[68:71],v[220:223],v[128:143]
TR v[220:221],v225 offset:18432
TR v[222:223],v225 offset:18944
BL4 v230,s[20:23],s38 offen offset:2048 lds
WT lgkmcnt(4)
M32 v[80:95],v[72:75],v[208:211],v[80:95]
TR v[208:209],v224 offset:24576
TR v[210:211],v224 offset:25088
M32 v[96:111],v[72:75],v[212:215],v[96:111]
TR v[212:213],v224 offset:26624
TR v[214:215],v224 offset:27136
BL4 v231,s[20:23],s38 offen offset:3072 lds
WT lgkmcnt(4)
M32 v[112:127],v[72:75],v[216:219],v[112:127]
TR v[216:217],v225 offset:24576
TR v[218:219],v225 offset:25088
M32 v[128:143],v[72:75],v[220:223],v[128:143]
TR v[220:221],v225 offset:26624
TR v[222:223],v225 offset:27136
WT lgkmcnt(4)
M32 v[80:95],v[76:79],v[208:211],v[80:95]
WT vmcnt(4)
s_barrier
v_add_u32 v224,32768,v226
v_add_u32 v225,32768,v227
TR v[208:209],v224 offset:0
TR v[210:211],v224 offset:512
M32 v[96:111],v[76:79],v[212:215],v[96:111]
TR v[212:213],v224 offset:2048
TR v[214:215],v224 offset:2560
WT lgkmcnt(4)
M32 v[112:127],v[76:79],v[216:219],v[112:127]
TR v[216:217],v225 offset:0
TR v[218:219],v225 offset:512
M32 v[128:143],v[76:79],v[220:223],v[128:143]
TR v[220:221],v225 offset:2048
TR v[222:223],v225 offset:2560
s_cmp_ge_u32 s29,12
s_cbranch_scc1 K1_v1
WT lgkmcnt(4)
M32 v[144:159],v[208:211],v[0:3],0
TR v[208:209],v224 offset:8192
TR v[210:211],v224 offset:8704
M32 v[160:175],v[212:215],v[0:3],0
TR v[212:213],v224 offset:10240
TR v[214:215],v224 offset:10752
SADD m0,s47,98304
WT lgkmcnt(4)
M32 v[176:191],v[216:219],v[0:3],0
TR v[216:217],v225 offset:8192
TR v[218:219],v225 offset:8704
M32 v[192:207],v[220:223],v[0:3],0
TR v[220:221],v225 offset:10240
TR v[222:223],v225 offset:10752
BL4 v228,s[16:19],s39 offen lds
WT lgkmcnt(4)
M32 v[144:159],v[208:211],v[4:7],v[144:159]
TR v[208:209],v224 offset:16384
TR v[210:211],v224 offset:16896
ds_write_b128 v238,v[112:115] offset:0
M32 v[160:175],v[212:215],v[4:7],v[160:175]
TR v[212:213],v224 offset:18432
TR v[214:215],v224 offset:18944
BL4 v229,s[16:19],s39 offen offset:1024 lds
ds_write_b128 v238,v[116:119] offset:1024
WT lgkmcnt(6)
M32 v[176:191],v[216:219],v[4:7],v[176:191]
TR v[216:217],v225 offset:16384
TR v[218:219],v225 offset:16896
ds_write_b128 v238,v[120:123] offset:2048
M32 v[192:207],v[220:223],v[4:7],v[192:207]
TR v[220:221],v225 offset:18432
TR v[222:223],v225 offset:18944
BL4 v230,s[20:23],s39 offen offset:2048 lds
ds_write_b128 v238,v[124:127] offset:3072
WT lgkmcnt(7)
M32 v[144:159],v[208:211],v[8:11],v[144:159]
TR v[208:209],v224 offset:24576
TR v[210:211],v224 offset:25088
M32 v[160:175],v[212:215],v[8:11],v[160:175]
TR v[212:213],v224 offset:26624
TR v[214:215],v224 offset:27136
BL4 v231,s[20:23],s39 offen offset:3072 lds
WT lgkmcnt(5)
M32 v[176:191],v[216:219],v[8:11],v[176:191]
TR v[216:217],v225 offset:24576
TR v[218:219],v225 offset:25088
M32 v[192:207],v[220:223],v[8:11],v[192:207]
TR v[220:221],v225 offset:26624
TR v[222:223],v225 offset:27136
WT lgkmcnt(4)
M32 v[144:159],v[208:211],v[12:15],v[144:159]
WT vmcnt(4)
WT lgkmcnt(8)
s_barrier
v_add_u32 v224,65536,v226
v_add_u32 v225,65536,v227
TR v[208:209],v224 offset:0
TR v[210:211],v224 offset:512
M32 v[160:175],v[212:215],v[12:15],v[160:175]
TR v[212:213],v224 offset:2048
TR v[214:215],v224 offset:2560
WT lgkmcnt(4)
M32 v[176:191],v[216:219],v[12:15],v[176:191]
TR v[216:217],v225 offset:0
TR v[218:219],v225 offset:512
M32 v[192:207],v[220:223],v[12:15],v[192:207]
TR v[220:221],v225 offset:2048
TR v[222:223],v225 offset:2560
WT lgkmcnt(4)
M32 v[144:159],v[208:211],v[16:19],v[144:159]
TR v[208:209],v224 offset:8192
TR v[210:211],v224 offset:8704
R128 v[240:243],v239 offset:0
R128 v[244:247],v239 offset:1024
M32 v[160:175],v[212:215],v[16:19],v[160:175]
TR v[212:213],v224 offset:10240
TR v[214:215],v224 offset:10752
SADD m0,s47,0
WT lgkmcnt(6)
M32 v[176:191],v[216:219],v[16:19],v[176:191]
TR v[216:217],v225 offset:8192
TR v[218:219],v225 offset:8704
WT lgkmcnt(4)
ADD v80,v80,v240
ADD v81,v81,v241
ADD v82,v82,v242
M32 v[192:207],v[220:223],v[16:19],v[192:207]
TR v[220:221],v225 offset:10240
TR v[222:223],v225 offset:10752
BL4 v228,s[16:19],s40 offen lds
ADD v83,v83,v243
ADD v84,v84,v244
ADD v85,v85,v245
WT lgkmcnt(4)
M32 v[144:159],v[208:211],v[20:23],v[144:159]
TR v[208:209],v224 offset:16384
TR v[210:211],v224 offset:16896
ADD v86,v86,v246
ADD v87,v87,v247
R128 v[240:243],v239 offset:2048
M32 v[160:175],v[212:215],v[20:23],v[160:175]
TR v[212:213],v224 offset:18432
TR v[214:215],v224 offset:18944
BL4 v229,s[16:19],s40 offen offset:1024 lds
R128 v[244:247],v239 offset:3072
WT lgkmcnt(6)
M32 v[176:191],v[216:219],v[20:23],v[176:191]
TR v[216:217],v225 offset:16384
TR v[218:219],v225 offset:16896
M32 v[192:207],v[220:223],v[20:23],v[192:207]
TR v[220:221],v225 offset:18432
TR v[222:223],v225 offset:18944
BL4 v230,s[20:23],s40 offen offset:2048 lds
WT lgkmcnt(4)
ADD v88,v88,v240
ADD v89,v89,v241
ADD v90,v90,v242
WT lgkmcnt(5)
M32 v[144:159],v[208:211],v[24:27],v[144:159]
TR v[208:209],v224 offset:24576
TR v[210:211],v224 offset:25088
ADD v91,v91,v243
ADD v92,v92,v244
ADD v93,v93,v245
ADD v94,v94,v246
M32 v[160:175],v[212:215],v[24:27],v[160:175]
TR v[212:213],v224 offset:26624
TR v[214:215],v224 offset:27136
BL4 v231,s[20:23],s40 offen offset:3072 lds
ADD v95,v95,v247
s_mul_i32 s55,s57,41472
SADD s55,s55,5242880
s_or_b32 s53,s63,s48
WT lgkmcnt(4)
M32 v[176:191],v[216:219],v[24:27],v[176:191]
TR v[216:217],v225 offset:24576
TR v[218:219],v225 offset:25088
s_cmp_eq_u32 s53,0
s_cselect_b32 s56,s55,0x7ff00000
s_lshl_b32 s53,s63,11
M32 v[192:207],v[220:223],v[24:27],v[192:207]
TR v[220:221],v225 offset:26624
TR v[222:223],v225 offset:27136
SADD s55,s55,s53
s_lshl_b32 s53,s48,9
SADD s55,s55,s53
WT lgkmcnt(4)
M32 v[144:159],v[208:211],v[28:31],v[144:159]
v_lshrrev_b32 v240,4,v234
v_lshrrev_b32 v241,1,v240
v_mul_u32_u24 v241,10368,v241
WT vmcnt(4)
WT lgkmcnt(12)
s_barrier
v_add_u32 v224,98304,v226
v_add_u32 v225,98304,v227
TR v[208:209],v224 offset:0
TR v[210:211],v224 offset:512
M32 v[160:175],v[212:215],v[28:31],v[160:175]
TR v[212:213],v224 offset:2048
TR v[214:215],v224 offset:2560
WT lgkmcnt(4)
M32 v[176:191],v[216:219],v[28:31],v[176:191]
TR v[216:217],v225 offset:0
TR v[218:219],v225 offset:512
M32 v[192:207],v[220:223],v[28:31],v[192:207]
TR v[220:221],v225 offset:2048
TR v[222:223],v225 offset:2560
WT lgkmcnt(4)
M32 v[144:159],v[208:211],v[32:35],v[144:159]
TR v[208:209],v224 offset:8192
TR v[210:211],v224 offset:8704
ds_write_b128 v238,v[128:131] offset:0
ds_write_b128 v238,v[132:135] offset:1024
ds_write_b128 v238,v[136:139] offset:2048
M32 v[160:175],v[212:215],v[32:35],v[160:175]
TR v[212:213],v224 offset:10240
TR v[214:215],v224 offset:10752
SADD m0,s47,32768
ds_write_b128 v238,v[140:143] offset:3072
AND v242,1,v240
v_lshl_add_u32 v241,v242,4,v241
WT lgkmcnt(8)
M32 v[176:191],v[216:219],v[32:35],v[176:191]
TR v[216:217],v225 offset:8192
TR v[218:219],v225 offset:8704
v_add_u32 v241,10240,v241
v_cmp_gt_u32 vcc,8,v240
M32 v[192:207],v[220:223],v[32:35],v[192:207]
TR v[220:221],v225 offset:10240
TR v[222:223],v225 offset:10752
BL4 v228,s[16:19],s41 offen lds
v_mov_b32 v243,0x80000000
v_cndmask_b32 v241,v243,v241,vcc
WT lgkmcnt(5)
M32 v[144:159],v[208:211],v[36:39],v[144:159]
TR v[208:209],v224 offset:16384
TR v[210:211],v224 offset:16896
v_cmp_eq_u32 vcc,0,v242
v_mov_b32 v244,0
M32 v[160:175],v[212:215],v[36:39],v[160:175]
TR v[212:213],v224 offset:18432
TR v[214:215],v224 offset:18944
BL4 v229,s[16:19],s41 offen offset:1024 lds
v_mov_b32 v245,0x3f803f80
v_cndmask_b32 v244,v244,v245,vcc
WT lgkmcnt(4)
M32 v[176:191],v[216:219],v[36:39],v[176:191]
TR v[216:217],v225 offset:16384
TR v[218:219],v225 offset:16896
v_mov_b32 v245,v244
v_mov_b32 v246,v244
M32 v[192:207],v[220:223],v[36:39],v[192:207]
TR v[220:221],v225 offset:18432
TR v[222:223],v225 offset:18944
BL4 v230,s[20:23],s41 offen offset:2048 lds
v_mov_b32 v247,v244
BS4 v[244:247],v241,s[24:27],s56 offen sc1
WT lgkmcnt(4)
M32 v[144:159],v[208:211],v[40:43],v[144:159]
TR v[208:209],v224 offset:24576
TR v[210:211],v224 offset:25088
CV v248,v80,v81
CV v249,v82,v83
M32 v[160:175],v[212:215],v[40:43],v[160:175]
TR v[212:213],v224 offset:26624
TR v[214:215],v224 offset:27136
BL4 v231,s[20:23],s41 offen offset:3072 lds
CV v250,v84,v85
CV v251,v86,v87
WT lgkmcnt(4)
M32 v[176:191],v[216:219],v[40:43],v[176:191]
TR v[216:217],v225 offset:24576
TR v[218:219],v225 offset:25088
CV v252,v88,v89
CV v253,v90,v91
M32 v[192:207],v[220:223],v[40:43],v[192:207]
TR v[220:221],v225 offset:26624
TR v[222:223],v225 offset:27136
CV v254,v92,v93
CV v255,v94,v95
WT lgkmcnt(4)
M32 v[144:159],v[208:211],v[44:47],v[144:159]
BS4 v[248:251],v236,s[24:27],s55 offen sc1
BS4 v[252:255],v237,s[24:27],s55 offen sc1
WT vmcnt(7)
WT lgkmcnt(15)
s_barrier
v_mov_b32 v224,v226
v_mov_b32 v225,v227
TR v[208:209],v224 offset:0
TR v[210:211],v224 offset:512
M32 v[160:175],v[212:215],v[44:47],v[160:175]
TR v[212:213],v224 offset:2048
TR v[214:215],v224 offset:2560
WT lgkmcnt(4)
M32 v[176:191],v[216:219],v[44:47],v[176:191]
TR v[216:217],v225 offset:0
TR v[218:219],v225 offset:512
M32 v[192:207],v[220:223],v[44:47],v[192:207]
TR v[220:221],v225 offset:2048
TR v[222:223],v225 offset:2560
WT lgkmcnt(4)
M32 v[144:159],v[208:211],v[48:51],v[144:159]
TR v[208:209],v224 offset:8192
TR v[210:211],v224 offset:8704
R128 v[240:243],v239 offset:0
R128 v[244:247],v239 offset:1024
M32 v[160:175],v[212:215],v[48:51],v[160:175]
TR v[212:213],v224 offset:10240
TR v[214:215],v224 offset:10752
SADD m0,s47,65536
WT lgkmcnt(6)
M32 v[176:191],v[216:219],v[48:51],v[176:191]
TR v[216:217],v225 offset:8192
TR v[218:219],v225 offset:8704
M32 v[192:207],v[220:223],v[48:51],v[192:207]
TR v[220:221],v225 offset:10240
TR v[222:223],v225 offset:10752
BL4 v228,s[16:19],s42 offen lds
WT lgkmcnt(6)
ADD v96,v96,v240
WT lgkmcnt(4)
M32 v[144:159],v[208:211],v[52:55],v[144:159]
TR v[208:209],v224 offset:16384
TR v[210:211],v224 offset:16896
ADD v97,v97,v241
ADD v98,v98,v242
M32 v[160:175],v[212:215],v[52:55],v[160:175]
TR v[212:213],v224 offset:18432
TR v[214:215],v224 offset:18944
BL4 v229,s[16:19],s42 offen offset:1024 lds
ADD v99,v99,v243
ADD v100,v100,v244
WT lgkmcnt(4)
M32 v[176:191],v[216:219],v[52:55],v[176:191]
TR v[216:217],v225 offset:16384
TR v[218:219],v225 offset:16896
ADD v101,v101,v245
ADD v102,v102,v246
M32 v[192:207],v[220:223],v[52:55],v[192:207]
TR v[220:221],v225 offset:18432
TR v[222:223],v225 offset:18944
BL4 v230,s[20:23],s42 offen offset:2048 lds
ADD v103,v103,v247
R128 v[240:243],v239 offset:2048
WT lgkmcnt(5)
M32 v[144:159],v[208:211],v[56:59],v[144:159]
TR v[208:209],v224 offset:24576
TR v[210:211],v224 offset:25088
R128 v[244:247],v239 offset:3072
M32 v[160:175],v[212:215],v[56:59],v[160:175]
TR v[212:213],v224 offset:26624
TR v[214:215],v224 offset:27136
BL4 v231,s[20:23],s42 offen offset:3072 lds
WT lgkmcnt(6)
M32 v[176:191],v[216:219],v[56:59],v[176:191]
TR v[216:217],v225 offset:24576
TR v[218:219],v225 offset:25088
WT lgkmcnt(4)
ADD v104,v104,v240
M32 v[192:207],v[220:223],v[56:59],v[192:207]
TR v[220:221],v225 offset:26624
TR v[222:223],v225 offset:27136
ADD v105,v105,v241
ADD v106,v106,v242
WT lgkmcnt(4)
M32 v[144:159],v[208:211],v[60:63],v[144:159]
ADD v107,v107,v243
ADD v108,v108,v244
ADD v109,v109,v245
ADD v110,v110,v246
ADD v111,v111,v247
CV v248,v96,v97
CV v249,v98,v99
CV v250,v100,v101
WT vmcnt(6)
s_barrier
v_add_u32 v224,32768,v226
v_add_u32 v225,32768,v227
TR v[208:209],v224 offset:0
TR v[210:211],v224 offset:512
M32 v[160:175],v[212:215],v[60:63],v[160:175]
TR v[212:213],v224 offset:2048
TR v[214:215],v224 offset:2560
WT lgkmcnt(4)
M32 v[176:191],v[216:219],v[60:63],v[176:191]
TR v[216:217],v225 offset:0
TR v[218:219],v225 offset:512
M32 v[192:207],v[220:223],v[60:63],v[192:207]
TR v[220:221],v225 offset:2048
TR v[222:223],v225 offset:2560
WT lgkmcnt(4)
M32 v[144:159],v[208:211],v[64:67],v[144:159]
TR v[208:209],v224 offset:8192
TR v[210:211],v224 offset:8704
CV v251,v102,v103
M32 v[160:175],v[212:215],v[64:67],v[160:175]
TR v[212:213],v224 offset:10240
TR v[214:215],v224 offset:10752
SADD m0,s47,98304
CV v252,v104,v105
WT lgkmcnt(4)
M32 v[176:191],v[216:219],v[64:67],v[176:191]
TR v[216:217],v225 offset:8192
TR v[218:219],v225 offset:8704
CV v253,v106,v107
M32 v[192:207],v[220:223],v[64:67],v[192:207]
TR v[220:221],v225 offset:10240
TR v[222:223],v225 offset:10752
BL4 v228,s[16:19],s43 offen lds
CV v254,v108,v109
WT lgkmcnt(4)
M32 v[144:159],v[208:211],v[68:71],v[144:159]
TR v[208:209],v224 offset:16384
TR v[210:211],v224 offset:16896
CV v255,v110,v111
M32 v[160:175],v[212:215],v[68:71],v[160:175]
TR v[212:213],v224 offset:18432
TR v[214:215],v224 offset:18944
BL4 v229,s[16:19],s43 offen offset:1024 lds
BS4 v[248:251],v236,s[24:27],s55 offen offset:1024 sc1
WT lgkmcnt(4)
M32 v[176:191],v[216:219],v[68:71],v[176:191]
TR v[216:217],v225 offset:16384
TR v[218:219],v225 offset:16896
BS4 v[252:255],v237,s[24:27],s55 offen offset:1024 sc1
M32 v[192:207],v[220:223],v[68:71],v[192:207]
TR v[220:221],v225 offset:18432
TR v[222:223],v225 offset:18944
BL4 v230,s[20:23],s43 offen offset:2048 lds
WT lgkmcnt(4)
M32 v[144:159],v[208:211],v[72:75],v[144:159]
TR v[208:209],v224 offset:24576
TR v[210:211],v224 offset:25088
M32 v[160:175],v[212:215],v[72:75],v[160:175]
TR v[212:213],v224 offset:26624
TR v[214:215],v224 offset:27136
BL4 v231,s[20:23],s43 offen offset:3072 lds
WT lgkmcnt(4)
M32 v[176:191],v[216:219],v[72:75],v[176:191]
TR v[216:217],v225 offset:24576
TR v[218:219],v225 offset:25088
M32 v[192:207],v[220:223],v[72:75],v[192:207]
TR v[220:221],v225 offset:26624
TR v[222:223],v225 offset:27136
WT lgkmcnt(4)
M32 v[144:159],v[208:211],v[76:79],v[144:159]
WT vmcnt(6)
s_barrier
v_add_u32 v224,65536,v226
v_add_u32 v225,65536,v227
v_mov_b32 v233,0
buffer_load_dword v232,v233,s[64:67],0 offen sc1
TR v[208:209],v224 offset:0
TR v[210:211],v224 offset:512
M32 v[160:175],v[212:215],v[76:79],v[160:175]
TR v[212:213],v224 offset:2048
TR v[214:215],v224 offset:2560
WT lgkmcnt(4)
M32 v[176:191],v[216:219],v[76:79],v[176:191]
TR v[216:217],v225 offset:0
TR v[218:219],v225 offset:512
M32 v[192:207],v[220:223],v[76:79],v[192:207]
TR v[220:221],v225 offset:2048
TR v[222:223],v225 offset:2560
WT lgkmcnt(4)
M32 v[80:95],v[208:211],v[0:3],0
TR v[208:209],v224 offset:8192
TR v[210:211],v224 offset:8704
M32 v[96:111],v[212:215],v[0:3],0
TR v[212:213],v224 offset:10240
TR v[214:215],v224 offset:10752
SADD m0,s47,0
WT lgkmcnt(4)
M32 v[112:127],v[216:219],v[0:3],0
TR v[216:217],v225 offset:8192
TR v[218:219],v225 offset:8704
M32 v[128:143],v[220:223],v[0:3],0
TR v[220:221],v225 offset:10240
TR v[222:223],v225 offset:10752
BL4 v228,s[16:19],s44 offen lds
WT lgkmcnt(4)
M32 v[80:95],v[208:211],v[4:7],v[80:95]
TR v[208:209],v224 offset:16384
TR v[210:211],v224 offset:16896
ds_write_b128 v238,v[176:179] offset:0
M32 v[96:111],v[212:215],v[4:7],v[96:111]
TR v[212:213],v224 offset:18432
TR v[214:215],v224 offset:18944
BL4 v229,s[16:19],s44 offen offset:1024 lds
ds_write_b128 v238,v[180:183] offset:1024
WT lgkmcnt(6)
M32 v[112:127],v[216:219],v[4:7],v[112:127]
TR v[216:217],v225 offset:16384
TR v[218:219],v225 offset:16896
ds_write_b128 v238,v[184:187] offset:2048
M32 v[128:143],v[220:223],v[4:7],v[128:143]
TR v[220:221],v225 offset:18432
TR v[222:223],v225 offset:18944
BL4 v230,s[20:23],s44 offen offset:2048 lds
ds_write_b128 v238,v[188:191] offset:3072
WT lgkmcnt(7)
M32 v[80:95],v[208:211],v[8:11],v[80:95]
TR v[208:209],v224 offset:24576
TR v[210:211],v224 offset:25088
M32 v[96:111],v[212:215],v[8:11],v[96:111]
TR v[212:213],v224 offset:26624
TR v[214:215],v224 offset:27136
BL4 v231,s[20:23],s44 offen offset:3072 lds
WT lgkmcnt(5)
M32 v[112:127],v[216:219],v[8:11],v[112:127]
TR v[216:217],v225 offset:24576
TR v[218:219],v225 offset:25088
M32 v[128:143],v[220:223],v[8:11],v[128:143]
TR v[220:221],v225 offset:26624
TR v[222:223],v225 offset:27136
WT lgkmcnt(4)
M32 v[80:95],v[208:211],v[12:15],v[80:95]
WT vmcnt(5)
WT lgkmcnt(8)
WT vmcnt(7)
WT vmcnt(4)
s_barrier
v_add_u32 v224,98304,v226
v_add_u32 v225,98304,v227
s_cmp_lg_u32 s30,0
s_cbranch_scc1 SQ_w5
v_readfirstlane_b32 s90,v232
s_nop 3
s_cmp_eq_u32 s90,1
s_cbranch_scc1 SQ_ok5
s_mov_b32 s52,0
SQ_clr5:
buffer_load_dword v232,v233,s[64:67],0 offen sc1
WT vmcnt(0)
s_mov_b64 s[94:95],0
v_cmp_ne_u32 vcc,0x1,v232
s_nop 3
s_and_b32 vcc_lo,vcc_lo,0x1
s_and_b32 vcc_hi,vcc_hi,0x0
s_or_b64 s[94:95],s[94:95],vcc
s_cmp_eq_u64 s[94:95],0
s_cbranch_scc1 SQ_clr5_ok
SADD s52,s52,1
s_cmp_lt_u32 s52,200000
s_cbranch_scc0 SQ_clr5_ok
s_sleep 2
s_branch SQ_clr5
SQ_clr5_ok:
SQ_ok5:
s_lshl_b32 s89,s29,7
s_lshl_b32 s90,s28,2
SADD s89,s89,s90
SADD s89,s89,23461888
v_mov_b32 v235,0x5ca1ab1e
v_mov_b32 v236,s89
s_mov_b64 exec,1
buffer_store_dword v235,v236,s[24:27],0 offen sc1
s_mov_b64 exec,-1
SQ_w5:
TR v[208:209],v224 offset:0
TR v[210:211],v224 offset:512
s_nop 1
M32 v[96:111],v[212:215],v[12:15],v[96:111]
TR v[212:213],v224 offset:2048
TR v[214:215],v224 offset:2560
WT lgkmcnt(4)
M32 v[112:127],v[216:219],v[12:15],v[112:127]
TR v[216:217],v225 offset:0
TR v[218:219],v225 offset:512
M32 v[128:143],v[220:223],v[12:15],v[128:143]
TR v[220:221],v225 offset:2048
TR v[222:223],v225 offset:2560
WT lgkmcnt(4)
M32 v[80:95],v[208:211],v[16:19],v[80:95]
TR v[208:209],v224 offset:8192
TR v[210:211],v224 offset:8704
R128 v[240:243],v239 offset:0
R128 v[244:247],v239 offset:1024
M32 v[96:111],v[212:215],v[16:19],v[96:111]
TR v[212:213],v224 offset:10240
TR v[214:215],v224 offset:10752
SADD m0,s47,32768
WT lgkmcnt(6)
M32 v[112:127],v[216:219],v[16:19],v[112:127]
TR v[216:217],v225 offset:8192
TR v[218:219],v225 offset:8704
WT lgkmcnt(4)
ADD v144,v144,v240
ADD v145,v145,v241
ADD v146,v146,v242
ADD v147,v147,v243
M32 v[128:143],v[220:223],v[16:19],v[128:143]
TR v[220:221],v225 offset:10240
TR v[222:223],v225 offset:10752
BL4 v228,s[16:19],s45 offen lds
ADD v148,v148,v244
ADD v149,v149,v245
ADD v150,v150,v246
ADD v151,v151,v247
WT lgkmcnt(4)
M32 v[80:95],v[208:211],v[20:23],v[80:95]
TR v[208:209],v224 offset:16384
TR v[210:211],v224 offset:16896
R128 v[240:243],v239 offset:2048
R128 v[244:247],v239 offset:3072
M32 v[96:111],v[212:215],v[20:23],v[96:111]
TR v[212:213],v224 offset:18432
TR v[214:215],v224 offset:18944
BL4 v229,s[16:19],s45 offen offset:1024 lds
WT lgkmcnt(6)
M32 v[112:127],v[216:219],v[20:23],v[112:127]
TR v[216:217],v225 offset:16384
TR v[218:219],v225 offset:16896
WT lgkmcnt(4)
ADD v152,v152,v240
ADD v153,v153,v241
ADD v154,v154,v242
ADD v155,v155,v243
M32 v[128:143],v[220:223],v[20:23],v[128:143]
TR v[220:221],v225 offset:18432
TR v[222:223],v225 offset:18944
BL4 v230,s[20:23],s45 offen offset:2048 lds
ADD v156,v156,v244
ADD v157,v157,v245
ADD v158,v158,v246
ADD v159,v159,v247
s_mul_i32 s55,s57,110592
WT lgkmcnt(4)
M32 v[80:95],v[208:211],v[24:27],v[80:95]
TR v[208:209],v224 offset:24576
TR v[210:211],v224 offset:25088
s_lshl_b32 s53,s60,12
SADD s55,s55,s53
s_lshl_b32 s53,s48,11
SADD s55,s55,s53
SADD s55,s55,8126464
M32 v[96:111],v[212:215],v[24:27],v[96:111]
TR v[212:213],v224 offset:26624
TR v[214:215],v224 offset:27136
BL4 v231,s[20:23],s45 offen offset:3072 lds
MUL v144,0xbfb8aa3b,v144
MUL v145,0xbfb8aa3b,v145
MUL v146,0xbfb8aa3b,v146
MUL v147,0xbfb8aa3b,v147
EX v144,v144
WT lgkmcnt(4)
M32 v[112:127],v[216:219],v[24:27],v[112:127]
TR v[216:217],v225 offset:24576
TR v[218:219],v225 offset:25088
EX v145,v145
EX v146,v146
EX v147,v147
MUL v148,0xbfb8aa3b,v148
M32 v[128:143],v[220:223],v[24:27],v[128:143]
TR v[220:221],v225 offset:26624
TR v[222:223],v225 offset:27136
MUL v149,0xbfb8aa3b,v149
MUL v150,0xbfb8aa3b,v150
MUL v151,0xbfb8aa3b,v151
EX v148,v148
WT lgkmcnt(4)
M32 v[80:95],v[208:211],v[28:31],v[80:95]
EX v149,v149
EX v150,v150
EX v151,v151
MUL v152,0xbfb8aa3b,v152
WT vmcnt(4)
WT lgkmcnt(14)
s_barrier
v_mov_b32 v224,v226
v_mov_b32 v225,v227
TR v[208:209],v224 offset:0
TR v[210:211],v224 offset:512
M32 v[96:111],v[212:215],v[28:31],v[96:111]
TR v[212:213],v224 offset:2048
TR v[214:215],v224 offset:2560
WT lgkmcnt(4)
M32 v[112:127],v[216:219],v[28:31],v[112:127]
TR v[216:217],v225 offset:0
TR v[218:219],v225 offset:512
M32 v[128:143],v[220:223],v[28:31],v[128:143]
TR v[220:221],v225 offset:2048
TR v[222:223],v225 offset:2560
WT lgkmcnt(4)
M32 v[80:95],v[208:211],v[32:35],v[80:95]
TR v[208:209],v224 offset:8192
TR v[210:211],v224 offset:8704
ds_write_b128 v238,v[192:195] offset:0
ds_write_b128 v238,v[196:199] offset:1024
ds_write_b128 v238,v[200:203] offset:2048
ds_write_b128 v238,v[204:207] offset:3072
M32 v[96:111],v[212:215],v[32:35],v[96:111]
TR v[212:213],v224 offset:10240
TR v[214:215],v224 offset:10752
SADD m0,s47,65536
MUL v153,0xbfb8aa3b,v153
MUL v154,0xbfb8aa3b,v154
MUL v155,0xbfb8aa3b,v155
EX v152,v152
WT lgkmcnt(8)
M32 v[112:127],v[216:219],v[32:35],v[112:127]
TR v[216:217],v225 offset:8192
TR v[218:219],v225 offset:8704
EX v153,v153
EX v154,v154
EX v155,v155
MUL v156,0xbfb8aa3b,v156
M32 v[128:143],v[220:223],v[32:35],v[128:143]
TR v[220:221],v225 offset:10240
TR v[222:223],v225 offset:10752
BL4 v228,s[16:19],s46 offen lds
MUL v157,0xbfb8aa3b,v157
MUL v158,0xbfb8aa3b,v158
MUL v159,0xbfb8aa3b,v159
EX v156,v156
WT lgkmcnt(4)
M32 v[80:95],v[208:211],v[36:39],v[80:95]
TR v[208:209],v224 offset:16384
TR v[210:211],v224 offset:16896
EX v157,v157
EX v158,v158
EX v159,v159
ADD v144,1.0,v144
M32 v[96:111],v[212:215],v[36:39],v[96:111]
TR v[212:213],v224 offset:18432
TR v[214:215],v224 offset:18944
BL4 v229,s[16:19],s46 offen offset:1024 lds
ADD v145,1.0,v145
ADD v146,1.0,v146
ADD v147,1.0,v147
RCP v144,v144
WT lgkmcnt(4)
M32 v[112:127],v[216:219],v[36:39],v[112:127]
TR v[216:217],v225 offset:16384
TR v[218:219],v225 offset:16896
RCP v145,v145
RCP v146,v146
RCP v147,v147
ADD v148,1.0,v148
M32 v[128:143],v[220:223],v[36:39],v[128:143]
TR v[220:221],v225 offset:18432
TR v[222:223],v225 offset:18944
BL4 v230,s[20:23],s46 offen offset:2048 lds
ADD v149,1.0,v149
ADD v150,1.0,v150
ADD v151,1.0,v151
RCP v148,v148
WT lgkmcnt(4)
M32 v[80:95],v[208:211],v[40:43],v[80:95]
TR v[208:209],v224 offset:24576
TR v[210:211],v224 offset:25088
RCP v149,v149
RCP v150,v150
RCP v151,v151
ADD v152,1.0,v152
M32 v[96:111],v[212:215],v[40:43],v[96:111]
TR v[212:213],v224 offset:26624
TR v[214:215],v224 offset:27136
BL4 v231,s[20:23],s46 offen offset:3072 lds
ADD v153,1.0,v153
ADD v154,1.0,v154
ADD v155,1.0,v155
RCP v152,v152
WT lgkmcnt(4)
M32 v[112:127],v[216:219],v[40:43],v[112:127]
TR v[216:217],v225 offset:24576
TR v[218:219],v225 offset:25088
RCP v153,v153
RCP v154,v154
RCP v155,v155
ADD v156,1.0,v156
M32 v[128:143],v[220:223],v[40:43],v[128:143]
TR v[220:221],v225 offset:26624
TR v[222:223],v225 offset:27136
ADD v157,1.0,v157
ADD v158,1.0,v158
ADD v159,1.0,v159
RCP v156,v156
WT lgkmcnt(4)
M32 v[80:95],v[208:211],v[44:47],v[80:95]
RCP v157,v157
RCP v158,v158
RCP v159,v159
WT vmcnt(4)
WT lgkmcnt(15)
s_barrier
v_add_u32 v224,32768,v226
v_add_u32 v225,32768,v227
TR v[208:209],v224 offset:0
TR v[210:211],v224 offset:512
M32 v[96:111],v[212:215],v[44:47],v[96:111]
TR v[212:213],v224 offset:2048
TR v[214:215],v224 offset:2560
WT lgkmcnt(4)
M32 v[112:127],v[216:219],v[44:47],v[112:127]
TR v[216:217],v225 offset:0
TR v[218:219],v225 offset:512
M32 v[128:143],v[220:223],v[44:47],v[128:143]
TR v[220:221],v225 offset:2048
TR v[222:223],v225 offset:2560
WT lgkmcnt(4)
M32 v[80:95],v[208:211],v[48:51],v[80:95]
TR v[208:209],v224 offset:8192
TR v[210:211],v224 offset:8704
R128 v[240:243],v239 offset:0
R128 v[244:247],v239 offset:1024
M32 v[96:111],v[212:215],v[48:51],v[96:111]
TR v[212:213],v224 offset:10240
TR v[214:215],v224 offset:10752
WT lgkmcnt(6)
M32 v[112:127],v[216:219],v[48:51],v[112:127]
TR v[216:217],v225 offset:8192
TR v[218:219],v225 offset:8704
WT lgkmcnt(4)
ADD v160,v160,v240
ADD v161,v161,v241
M32 v[128:143],v[220:223],v[48:51],v[128:143]
TR v[220:221],v225 offset:10240
TR v[222:223],v225 offset:10752
ADD v162,v162,v242
ADD v163,v163,v243
ADD v164,v164,v244
WT lgkmcnt(4)
M32 v[80:95],v[208:211],v[52:55],v[80:95]
TR v[208:209],v224 offset:16384
TR v[210:211],v224 offset:16896
ADD v165,v165,v245
ADD v166,v166,v246
ADD v167,v167,v247
M32 v[96:111],v[212:215],v[52:55],v[96:111]
TR v[212:213],v224 offset:18432
TR v[214:215],v224 offset:18944
R128 v[240:243],v239 offset:2048
R128 v[244:247],v239 offset:3072
WT lgkmcnt(6)
M32 v[112:127],v[216:219],v[52:55],v[112:127]
TR v[216:217],v225 offset:16384
TR v[218:219],v225 offset:16896
M32 v[128:143],v[220:223],v[52:55],v[128:143]
TR v[220:221],v225 offset:18432
TR v[222:223],v225 offset:18944
WT lgkmcnt(4)
ADD v168,v168,v240
ADD v169,v169,v241
WT lgkmcnt(6)
M32 v[80:95],v[208:211],v[56:59],v[80:95]
TR v[208:209],v224 offset:24576
TR v[210:211],v224 offset:25088
ADD v170,v170,v242
ADD v171,v171,v243
M32 v[96:111],v[212:215],v[56:59],v[96:111]
TR v[212:213],v224 offset:26624
TR v[214:215],v224 offset:27136
ADD v172,v172,v244
ADD v173,v173,v245
WT lgkmcnt(4)
M32 v[112:127],v[216:219],v[56:59],v[112:127]
TR v[216:217],v225 offset:24576
TR v[218:219],v225 offset:25088
ADD v174,v174,v246
ADD v175,v175,v247
M32 v[128:143],v[220:223],v[56:59],v[128:143]
TR v[220:221],v225 offset:26624
TR v[222:223],v225 offset:27136
MUL v160,v160,v144
MUL v161,v161,v145
WT lgkmcnt(4)
M32 v[80:95],v[208:211],v[60:63],v[80:95]
MUL v162,v162,v146
MUL v163,v163,v147
CV v248,v160,v161
CV v249,v162,v163
MUL v164,v164,v148
MUL v165,v165,v149
MUL v166,v166,v150
MUL v167,v167,v151
WT vmcnt(0)
s_barrier
v_add_u32 v224,65536,v226
v_add_u32 v225,65536,v227
s_and_b32 s31,s30,3
s_lshr_b32 s43,s30,2
s_and_b32 s9,s2,7
s_lshr_b32 s10,s2,3
s_lshl_b32 s41,s9,3
s_lshr_b32 s42,s10,2
SADD s41,s41,s42
s_and_b32 s42,s10,3
s_and_b32 s5,s10,7
s_lshr_b32 s10,s10,3
s_lshl_b32 s4,s9,2
SADD s4,s4,s10
s_lshr_b32 s6,s5,1
s_lshr_b32 s9,s4,1
s_mul_i32 s9,s9,5
s_and_b32 s10,s4,1
s_lshl_b32 s10,s10,1
SADD s9,s9,s10
s_lshl_b32 s18,s9,9
s_mul_i32 s11,s31,163840
SADD s11,s11,s18
SADD s11,s11,2621440
s_mul_i32 s22,s31,6144
s_mul_i32 s23,s31,5632
s_mul_i32 s12,s31,165888
SADD s12,s12,5242880
SADD s23,s23,24576
s_mov_b32 s16,0
s_lshl_b32 s9,s6,2
s_lshl_b32 s92,15,s9
s_lshl_b32 s9,s92,16
s_or_b32 s92,s92,s9
v_lshrrev_b32 v247,4,v234
s_mul_i32 s9,s4,20
SADD s10,s9,19
s_lshr_b32 s9,s9,7
s_lshr_b32 s10,s10,7
v_lshrrev_b32 v240,4,v247
AND v241,15,v247
AND v242,1,v240
v_mov_b32 v243,s9
v_mov_b32 v244,s10
v_cmp_eq_u32 vcc,1,v242
s_nop 1
v_cndmask_b32 v243,v243,v244,vcc
v_lshrrev_b32 v242,1,v240
v_mul_u32_u24 v244,5,v242
v_add_u32 v244,v244,v243
SHL v244,7,v244
v_lshl_add_u32 v244,v241,2,v244
v_add_u32 v245,23461888,v244
v_add_u32 v244,10,v243
SHL v244,7,v244
v_lshl_add_u32 v244,v241,2,v244
v_add_u32 v246,23461888,v244
SHL v244,2,v241
v_add_u32 v244,23472128,v244
v_cmp_le_u32 vcc,2,v240
s_nop 1
v_cndmask_b32 v246,v246,v244,vcc
v_mov_b32 v235,v245
v_mov_b32 v236,v246
buffer_load_dword v237,v235,s[24:27],0 offen sc1
buffer_load_dword v232,v236,s[24:27],0 offen sc1
v_mov_b32 v204,v234
v_lshrrev_b32 v205,4,v234
v_add_u32 v240,0,v205
v_cmp_le_u32 vcc,96,v240
SHL v241,4,v240
v_add_u32 v242,39424,v241
v_cndmask_b32 v192,v241,v242,vcc
v_add_u32 v240,64,v205
v_cmp_le_u32 vcc,96,v240
SHL v241,4,v240
v_add_u32 v242,39424,v241
v_cndmask_b32 v193,v241,v242,vcc
v_add_u32 v240,128,v205
v_cmp_le_u32 vcc,96,v240
SHL v241,4,v240
v_add_u32 v242,39424,v241
v_cndmask_b32 v194,v241,v242,vcc
s_mul_i32 s9,s4,20
v_add_u32 v240,0,v205
v_mul_u32_u24 v241,745,v240
v_lshrrev_b32 v241,16,v241
v_mul_u32_u24 v242,88,v241
v_sub_u32 v240,v240,v242
v_mul_u32_u24 v241,41472,v241
v_mul_u32_u24 v242,2979,v240
v_lshrrev_b32 v242,16,v242
v_mul_u32_u24 v243,22,v242
v_sub_u32 v240,v240,v243
v_mul_u32_u24 v242,10368,v242
v_add_u32 v241,v241,v242
v_add_u32 v242,s9,v240
v_add_u32 v243,620,v240
v_cmp_gt_u32 vcc,20,v240
s_nop 1
v_cndmask_b32 v242,v243,v242,vcc
v_lshl_add_u32 v241,v242,4,v241
v_mov_b32 v195,v241
v_add_u32 v240,64,v205
v_mul_u32_u24 v241,745,v240
v_lshrrev_b32 v241,16,v241
v_mul_u32_u24 v242,88,v241
v_sub_u32 v240,v240,v242
v_mul_u32_u24 v241,41472,v241
v_mul_u32_u24 v242,2979,v240
v_lshrrev_b32 v242,16,v242
v_mul_u32_u24 v243,22,v242
v_sub_u32 v240,v240,v243
v_mul_u32_u24 v242,10368,v242
v_add_u32 v241,v241,v242
v_add_u32 v242,s9,v240
v_add_u32 v243,620,v240
v_cmp_gt_u32 vcc,20,v240
s_nop 1
v_cndmask_b32 v242,v243,v242,vcc
v_lshl_add_u32 v241,v242,4,v241
v_subrev_u32 v196,1024,v241
v_add_u32 v240,128,v205
v_mul_u32_u24 v241,745,v240
v_lshrrev_b32 v241,16,v241
v_mul_u32_u24 v242,88,v241
v_sub_u32 v240,v240,v242
v_mul_u32_u24 v241,41472,v241
v_mul_u32_u24 v242,2979,v240
v_lshrrev_b32 v242,16,v242
v_mul_u32_u24 v243,22,v242
v_sub_u32 v240,v240,v243
v_mul_u32_u24 v242,10368,v242
v_add_u32 v241,v241,v242
v_add_u32 v242,s9,v240
v_add_u32 v243,620,v240
v_cmp_gt_u32 vcc,20,v240
s_nop 1
v_cndmask_b32 v242,v243,v242,vcc
v_lshl_add_u32 v241,v242,4,v241
v_subrev_u32 v197,2048,v241
v_add_u32 v240,192,v205
v_mul_u32_u24 v241,745,v240
v_lshrrev_b32 v241,16,v241
v_mul_u32_u24 v242,88,v241
v_sub_u32 v240,v240,v242
v_mul_u32_u24 v241,41472,v241
v_mul_u32_u24 v242,2979,v240
v_lshrrev_b32 v242,16,v242
v_mul_u32_u24 v243,22,v242
v_sub_u32 v240,v240,v243
v_mul_u32_u24 v242,10368,v242
v_add_u32 v241,v241,v242
v_add_u32 v242,s9,v240
v_add_u32 v243,620,v240
v_cmp_gt_u32 vcc,20,v240
s_nop 1
v_cndmask_b32 v242,v243,v242,vcc
v_lshl_add_u32 v241,v242,4,v241
v_subrev_u32 v198,3072,v241
v_add_u32 v240,256,v205
v_mul_u32_u24 v241,745,v240
v_lshrrev_b32 v241,16,v241
v_mul_u32_u24 v242,88,v241
v_sub_u32 v240,v240,v242
v_mul_u32_u24 v241,41472,v241
v_mul_u32_u24 v242,2979,v240
v_lshrrev_b32 v242,16,v242
v_mul_u32_u24 v243,22,v242
v_sub_u32 v240,v240,v243
v_mul_u32_u24 v242,10368,v242
v_add_u32 v241,v241,v242
v_add_u32 v242,s9,v240
v_add_u32 v243,620,v240
v_cmp_gt_u32 vcc,20,v240
s_nop 1
v_cndmask_b32 v242,v243,v242,vcc
v_lshl_add_u32 v241,v242,4,v241
v_mov_b32 v199,v241
v_add_u32 v240,320,v205
v_mul_u32_u24 v241,745,v240
v_lshrrev_b32 v241,16,v241
v_mul_u32_u24 v242,88,v241
v_sub_u32 v240,v240,v242
v_mul_u32_u24 v241,41472,v241
v_mul_u32_u24 v242,2979,v240
v_lshrrev_b32 v242,16,v242
v_mul_u32_u24 v243,22,v242
v_sub_u32 v240,v240,v243
v_mul_u32_u24 v242,10368,v242
v_add_u32 v241,v241,v242
v_add_u32 v242,s9,v240
v_add_u32 v243,620,v240
v_cmp_gt_u32 vcc,20,v240
s_nop 1
v_cndmask_b32 v242,v243,v242,vcc
v_lshl_add_u32 v241,v242,4,v241
v_subrev_u32 v200,1024,v241
TR v[208:209],v224 offset:0
TR v[210:211],v224 offset:512
M32 v[96:111],v[212:215],v[60:63],v[96:111]
TR v[212:213],v224 offset:2048
TR v[214:215],v224 offset:2560
WT lgkmcnt(4)
M32 v[112:127],v[216:219],v[60:63],v[112:127]
TR v[216:217],v225 offset:0
TR v[218:219],v225 offset:512
M32 v[128:143],v[220:223],v[60:63],v[128:143]
TR v[220:221],v225 offset:2048
TR v[222:223],v225 offset:2560
WT lgkmcnt(4)
M32 v[80:95],v[208:211],v[64:67],v[80:95]
TR v[208:209],v224 offset:8192
TR v[210:211],v224 offset:8704
CV v250,v164,v165
CV v251,v166,v167
M32 v[96:111],v[212:215],v[64:67],v[96:111]
TR v[212:213],v224 offset:10240
TR v[214:215],v224 offset:10752
MUL v168,v168,v152
MUL v169,v169,v153
WT lgkmcnt(4)
M32 v[112:127],v[216:219],v[64:67],v[112:127]
TR v[216:217],v225 offset:8192
TR v[218:219],v225 offset:8704
MUL v170,v170,v154
MUL v171,v171,v155
M32 v[128:143],v[220:223],v[64:67],v[128:143]
TR v[220:221],v225 offset:10240
TR v[222:223],v225 offset:10752
CV v252,v168,v169
CV v253,v170,v171
WT lgkmcnt(4)
M32 v[80:95],v[208:211],v[68:71],v[80:95]
TR v[208:209],v224 offset:16384
TR v[210:211],v224 offset:16896
MUL v172,v172,v156
M32 v[96:111],v[212:215],v[68:71],v[96:111]
TR v[212:213],v224 offset:18432
TR v[214:215],v224 offset:18944
MUL v173,v173,v157
WT lgkmcnt(4)
M32 v[112:127],v[216:219],v[68:71],v[112:127]
TR v[216:217],v225 offset:16384
TR v[218:219],v225 offset:16896
MUL v174,v174,v158
M32 v[128:143],v[220:223],v[68:71],v[128:143]
TR v[220:221],v225 offset:18432
TR v[222:223],v225 offset:18944
MUL v175,v175,v159
WT lgkmcnt(4)
M32 v[80:95],v[208:211],v[72:75],v[80:95]
TR v[208:209],v224 offset:24576
TR v[210:211],v224 offset:25088
CV v254,v172,v173
M32 v[96:111],v[212:215],v[72:75],v[96:111]
TR v[212:213],v224 offset:26624
TR v[214:215],v224 offset:27136
CV v255,v174,v175
WT lgkmcnt(4)
M32 v[112:127],v[216:219],v[72:75],v[112:127]
TR v[216:217],v225 offset:24576
TR v[218:219],v225 offset:25088
v_permlane32_swap_b32 v248,v250
M32 v[128:143],v[220:223],v[72:75],v[128:143]
TR v[220:221],v225 offset:26624
TR v[222:223],v225 offset:27136
v_permlane32_swap_b32 v249,v251
WT vmcnt(0)
s_mov_b64 s[94:95],0
v_cmp_ne_u32 vcc,0x5ca1ab1e,v237
s_nop 3
s_and_b32 vcc_lo,vcc_lo,s92
s_and_b32 vcc_hi,vcc_hi,s92
s_or_b64 s[94:95],s[94:95],vcc
v_cmp_ne_u32 vcc,0x5ca1ab1e,v232
s_nop 3
s_and_b32 vcc_lo,vcc_lo,s92
s_and_b32 vcc_hi,vcc_hi,0x0
s_or_b64 s[94:95],s[94:95],vcc
s_cmp_eq_u64 s[94:95],0
s_cselect_b32 s93,1,0
s_cbranch_scc0 ER_skip6
s_cmp_eq_u32 s43,1
s_cbranch_scc1 T1_h6
s_lshl_b32 s9,s31,1
s_lshl_b32 s10,s5,3
SADD s9,s9,s10
s_mul_i32 s7,s9,40960
SADD s7,s7,s18
s_and_b32 s10,s4,1
s_lshl_b32 s9,s10,9
SADD s8,s7,s9
s_cmp_eq_u32 s10,0
s_cselect_b32 s9,1024,8
SADD s7,s7,s9
AND v241,31,v205
SHL v242,4,v241
BL4 v[176:179],v204,s[24:27],s8 offen sc1
buffer_load_dwordx2 v[184:185],v242,s[24:27],s7 offen sc1
SADD s8,s8,40960
SADD s7,s7,40960
BL4 v[180:183],v204,s[24:27],s8 offen sc1
buffer_load_dwordx2 v[186:187],v242,s[24:27],s7 offen sc1
s_branch T1_j6
T1_h6:
s_mov_b32 s13,s6
s_mov_b32 s14,0
s_mov_b32 s15,4
s_mul_i32 s7,s13,655360
SADD s7,s7,s11
s_mul_i32 s33,s13,663552
SADD s33,s33,s12
s_cmp_eq_u32 s15,0
s_cselect_b32 s7,0x7ff00000,s7
s_cselect_b32 s33,0x7ff00000,s33
SADD s34,s7,81920
SADD s8,s14,s22
SADD s21,s14,s23
SADD s13,s13,1
s_and_b32 s13,s13,3
SADD s14,s14,47104
s_cmp_eq_u32 s14,141312
s_cselect_b32 s14,0,s14
s_cmp_lg_u32 s15,0
s_subb_u32 s15,s15,0
SADD m0,s8,0
s_nop 0
BL4 v192,s[24:27],s7 offen sc1 lds
SADD m0,s8,1024
s_nop 0
BL4 v193,s[24:27],s7 offen sc1 lds
SADD m0,s8,2048
s_nop 0
BL4 v194,s[24:27],s7 offen sc1 lds
SADD m0,s8,3072
s_nop 0
BL4 v192,s[24:27],s34 offen sc1 lds
SADD m0,s8,4096
s_nop 0
BL4 v193,s[24:27],s34 offen sc1 lds
SADD m0,s8,5120
s_nop 0
BL4 v194,s[24:27],s34 offen sc1 lds
s_mov_b32 m0,s21
s_nop 0
BL4 v195,s[24:27],s33 offen sc1 lds
s_mov_b32 m0,s21
s_nop 0
BL4 v196,s[24:27],s33 offen offset:1024 sc1 lds
s_mov_b32 m0,s21
s_nop 0
BL4 v197,s[24:27],s33 offen offset:2048 sc1 lds
s_mov_b32 m0,s21
s_nop 0
BL4 v198,s[24:27],s33 offen offset:3072 sc1 lds
SADD m0,s21,4096
s_nop 0
BL4 v199,s[24:27],s33 offen sc1 lds
SADD m0,s21,4096
s_mov_b32 exec_hi,0
BL4 v200,s[24:27],s33 offen offset:1024 sc1 lds
s_mov_b32 exec_hi,-1
T1_j6:
ER_skip6:
WT lgkmcnt(4)
s_nop 2
M32 v[80:95],v[208:211],v[76:79],v[80:95]
v_permlane32_swap_b32 v252,v254
M32 v[96:111],v[212:215],v[76:79],v[96:111]
v_permlane32_swap_b32 v253,v255
WT lgkmcnt(0)
M32 v[112:127],v[216:219],v[76:79],v[112:127]
BS4 v[248:251],v234,s[24:27],s55 offen sc1
M32 v[128:143],v[220:223],v[76:79],v[128:143]
BS4 v[252:255],v234,s[24:27],s55 offen offset:1024 sc1
s_nop 11
s_barrier
s_lshl_b32 s53,s30,13
SADD s53,s53,65536
v_add_u32 v238,s53,v234
s_xor_b32 s53,s30,4
s_lshl_b32 s53,s53,13
SADD s53,s53,65536
v_add_u32 v239,s53,v234
ds_write_b128 v238,v[112:115] offset:0
ds_write_b128 v238,v[116:119] offset:1024
ds_write_b128 v238,v[120:123] offset:2048
ds_write_b128 v238,v[124:127] offset:3072
ds_write_b128 v238,v[128:131] offset:4096
ds_write_b128 v238,v[132:135] offset:5120
ds_write_b128 v238,v[136:139] offset:6144
ds_write_b128 v238,v[140:143] offset:7168
s_lshl_b32 s91,s28,9
s_lshl_b32 s89,s29,5
SADD s91,s91,s89
s_lshl_b32 s89,s30,2
SADD s91,s91,s89
SADD s91,s91,23463936
s_cmp_eq_u32 s93,1
s_cbranch_scc1 T1_go7
WT vmcnt(2)
s_mov_b64 s[94:95],0
v_cmp_ne_u32 vcc,0x5ca1ab1e,v237
s_nop 3
s_and_b32 vcc_lo,vcc_lo,s92
s_and_b32 vcc_hi,vcc_hi,s92
s_or_b64 s[94:95],s[94:95],vcc
v_cmp_ne_u32 vcc,0x5ca1ab1e,v232
s_nop 3
s_and_b32 vcc_lo,vcc_lo,s92
s_and_b32 vcc_hi,vcc_hi,0x0
s_or_b64 s[94:95],s[94:95],vcc
s_cmp_eq_u64 s[94:95],0
s_cbranch_scc1 T1_go7
s_mov_b32 s52,0
T1_spin7:
buffer_load_dword v20,v235,s[24:27],0 offen sc1
buffer_load_dword v21,v236,s[24:27],0 offen sc1
WT vmcnt(0)
s_mov_b64 s[94:95],0
v_cmp_ne_u32 vcc,0x5ca1ab1e,v20
s_nop 3
s_and_b32 vcc_lo,vcc_lo,s92
s_and_b32 vcc_hi,vcc_hi,s92
s_or_b64 s[94:95],s[94:95],vcc
v_cmp_ne_u32 vcc,0x5ca1ab1e,v21
s_nop 3
s_and_b32 vcc_lo,vcc_lo,s92
s_and_b32 vcc_hi,vcc_hi,0x0
s_or_b64 s[94:95],s[94:95],vcc
s_cmp_eq_u64 s[94:95],0
s_cbranch_scc1 T1_spin7_ok
SADD s52,s52,1
s_cmp_lt_u32 s52,200000
s_cbranch_scc0 T1_spin7_ok
s_sleep 2
s_branch T1_spin7
T1_spin7_ok:
T1_go7:
s_cmp_eq_u32 s93,1
s_cbranch_scc1 T1_done8
s_cmp_eq_u32 s43,1
s_cbranch_scc1 T1_h8
s_lshl_b32 s9,s31,1
s_lshl_b32 s10,s5,3
SADD s9,s9,s10
s_mul_i32 s7,s9,40960
SADD s7,s7,s18
s_and_b32 s10,s4,1
s_lshl_b32 s9,s10,9
SADD s8,s7,s9
s_cmp_eq_u32 s10,0
s_cselect_b32 s9,1024,8
SADD s7,s7,s9
AND v41,31,v205
SHL v42,4,v41
BL4 v[176:179],v204,s[24:27],s8 offen sc1
buffer_load_dwordx2 v[184:185],v42,s[24:27],s7 offen sc1
SADD s8,s8,40960
SADD s7,s7,40960
BL4 v[180:183],v204,s[24:27],s8 offen sc1
buffer_load_dwordx2 v[186:187],v42,s[24:27],s7 offen sc1
s_branch T1_j8
T1_h8:
s_mov_b32 s13,s6
s_mov_b32 s14,0
s_mov_b32 s15,4
s_mul_i32 s7,s13,655360
SADD s7,s7,s11
s_mul_i32 s33,s13,663552
SADD s33,s33,s12
s_cmp_eq_u32 s15,0
s_cselect_b32 s7,0x7ff00000,s7
s_cselect_b32 s33,0x7ff00000,s33
SADD s34,s7,81920
SADD s8,s14,s22
SADD s21,s14,s23
SADD s13,s13,1
s_and_b32 s13,s13,3
SADD s14,s14,47104
s_cmp_eq_u32 s14,141312
s_cselect_b32 s14,0,s14
s_cmp_lg_u32 s15,0
s_subb_u32 s15,s15,0
SADD m0,s8,0
s_nop 0
BL4 v192,s[24:27],s7 offen sc1 lds
SADD m0,s8,1024
s_nop 0
BL4 v193,s[24:27],s7 offen sc1 lds
SADD m0,s8,2048
s_nop 0
BL4 v194,s[24:27],s7 offen sc1 lds
SADD m0,s8,3072
s_nop 0
BL4 v192,s[24:27],s34 offen sc1 lds
SADD m0,s8,4096
s_nop 0
BL4 v193,s[24:27],s34 offen sc1 lds
SADD m0,s8,5120
s_nop 0
BL4 v194,s[24:27],s34 offen sc1 lds
s_mov_b32 m0,s21
s_nop 0
BL4 v195,s[24:27],s33 offen sc1 lds
s_mov_b32 m0,s21
s_nop 0
BL4 v196,s[24:27],s33 offen offset:1024 sc1 lds
s_mov_b32 m0,s21
s_nop 0
BL4 v197,s[24:27],s33 offen offset:2048 sc1 lds
s_mov_b32 m0,s21
s_nop 0
BL4 v198,s[24:27],s33 offen offset:3072 sc1 lds
SADD m0,s21,4096
s_nop 0
BL4 v199,s[24:27],s33 offen sc1 lds
SADD m0,s21,4096
s_mov_b32 exec_hi,0
BL4 v200,s[24:27],s33 offen offset:1024 sc1 lds
s_mov_b32 exec_hi,-1
T1_j8:
T1_done8:
WT lgkmcnt(0)
s_barrier
R128 v[44:47],v239 offset:0
R128 v[48:51],v239 offset:1024
R128 v[52:55],v239 offset:2048
R128 v[56:59],v239 offset:3072
R128 v[0:3],v239 offset:4096
R128 v[4:7],v239 offset:5120
R128 v[8:11],v239 offset:6144
R128 v[12:15],v239 offset:7168
WT lgkmcnt(4)
ADD v80,v80,v44
ADD v81,v81,v45
ADD v82,v82,v46
ADD v83,v83,v47
ADD v84,v84,v48
ADD v85,v85,v49
ADD v86,v86,v50
ADD v87,v87,v51
ADD v88,v88,v52
ADD v89,v89,v53
ADD v90,v90,v54
ADD v91,v91,v55
ADD v92,v92,v56
ADD v93,v93,v57
ADD v94,v94,v58
ADD v95,v95,v59
WT lgkmcnt(0)
ADD v96,v96,v0
ADD v97,v97,v1
ADD v98,v98,v2
ADD v99,v99,v3
ADD v100,v100,v4
ADD v101,v101,v5
ADD v102,v102,v6
ADD v103,v103,v7
ADD v104,v104,v8
ADD v105,v105,v9
ADD v106,v106,v10
ADD v107,v107,v11
ADD v108,v108,v12
ADD v109,v109,v13
ADD v110,v110,v14
ADD v111,v111,v15
s_mul_i32 s55,s57,110592
s_lshl_b32 s53,s61,12
SADD s55,s55,s53
s_lshl_b32 s53,s48,11
SADD s55,s55,s53
SADD s55,s55,8126464
MUL v80,0xbfb8aa3b,v80
MUL v81,0xbfb8aa3b,v81
MUL v82,0xbfb8aa3b,v82
MUL v83,0xbfb8aa3b,v83
EX v80,v80
EX v81,v81
EX v82,v82
EX v83,v83
MUL v84,0xbfb8aa3b,v84
MUL v85,0xbfb8aa3b,v85
MUL v86,0xbfb8aa3b,v86
MUL v87,0xbfb8aa3b,v87
EX v84,v84
EX v85,v85
EX v86,v86
EX v87,v87
MUL v88,0xbfb8aa3b,v88
MUL v89,0xbfb8aa3b,v89
MUL v90,0xbfb8aa3b,v90
MUL v91,0xbfb8aa3b,v91
EX v88,v88
EX v89,v89
EX v90,v90
EX v91,v91
MUL v92,0xbfb8aa3b,v92
MUL v93,0xbfb8aa3b,v93
MUL v94,0xbfb8aa3b,v94
MUL v95,0xbfb8aa3b,v95
EX v92,v92
EX v93,v93
EX v94,v94
EX v95,v95
ADD v80,1.0,v80
ADD v81,1.0,v81
ADD v82,1.0,v82
ADD v83,1.0,v83
RCP v80,v80
RCP v81,v81
RCP v82,v82
RCP v83,v83
ADD v84,1.0,v84
ADD v85,1.0,v85
ADD v86,1.0,v86
ADD v87,1.0,v87
RCP v84,v84
RCP v85,v85
RCP v86,v86
RCP v87,v87
ADD v88,1.0,v88
ADD v89,1.0,v89
ADD v90,1.0,v90
ADD v91,1.0,v91
RCP v88,v88
RCP v89,v89
RCP v90,v90
RCP v91,v91
ADD v92,1.0,v92
ADD v93,1.0,v93
ADD v94,1.0,v94
ADD v95,1.0,v95
RCP v92,v92
RCP v93,v93
RCP v94,v94
RCP v95,v95
MUL v96,v96,v80
MUL v97,v97,v81
MUL v98,v98,v82
MUL v99,v99,v83
CV v248,v96,v97
CV v249,v98,v99
MUL v100,v100,v84
MUL v101,v101,v85
MUL v102,v102,v86
MUL v103,v103,v87
CV v250,v100,v101
CV v251,v102,v103
MUL v104,v104,v88
MUL v105,v105,v89
MUL v106,v106,v90
MUL v107,v107,v91
CV v252,v104,v105
CV v253,v106,v107
MUL v108,v108,v92
MUL v109,v109,v93
MUL v110,v110,v94
MUL v111,v111,v95
CV v254,v108,v109
CV v255,v110,v111
v_permlane32_swap_b32 v248,v250
v_permlane32_swap_b32 v249,v251
v_permlane32_swap_b32 v252,v254
v_permlane32_swap_b32 v253,v255
BS4 v[248:251],v234,s[24:27],s55 offen sc1
BS4 v[252:255],v234,s[24:27],s55 offen offset:1024 sc1
s_branch T1_common
K1_v1:
WT lgkmcnt(4)
M32 v[144:159],v[208:211],v[0:3],0
TR v[208:209],v224 offset:8192
TR v[210:211],v224 offset:8704
M32 v[160:175],v[212:215],v[0:3],0
TR v[212:213],v224 offset:10240
TR v[214:215],v224 offset:10752
SADD m0,s47,98304
WT lgkmcnt(4)
M32 v[176:191],v[216:219],v[0:3],0
TR v[216:217],v225 offset:8192
TR v[218:219],v225 offset:8704
M32 v[192:207],v[220:223],v[0:3],0
TR v[220:221],v225 offset:10240
TR v[222:223],v225 offset:10752
BL4 v228,s[16:19],s39 offen lds
WT lgkmcnt(4)
M32 v[144:159],v[208:211],v[4:7],v[144:159]
TR v[208:209],v224 offset:16384
TR v[210:211],v224 offset:16896
ds_write_b128 v238,v[112:115] offset:0
M32 v[160:175],v[212:215],v[4:7],v[160:175]
TR v[212:213],v224 offset:18432
TR v[214:215],v224 offset:18944
BL4 v229,s[16:19],s39 offen offset:1024 lds
ds_write_b128 v238,v[116:119] offset:1024
WT lgkmcnt(6)
M32 v[176:191],v[216:219],v[4:7],v[176:191]
TR v[216:217],v225 offset:16384
TR v[218:219],v225 offset:16896
ds_write_b128 v238,v[120:123] offset:2048
M32 v[192:207],v[220:223],v[4:7],v[192:207]
TR v[220:221],v225 offset:18432
TR v[222:223],v225 offset:18944
BL4 v230,s[20:23],s39 offen offset:2048 lds
ds_write_b128 v238,v[124:127] offset:3072
WT lgkmcnt(7)
M32 v[144:159],v[208:211],v[8:11],v[144:159]
TR v[208:209],v224 offset:24576
TR v[210:211],v224 offset:25088
M32 v[160:175],v[212:215],v[8:11],v[160:175]
TR v[212:213],v224 offset:26624
TR v[214:215],v224 offset:27136
BL4 v231,s[20:23],s39 offen offset:3072 lds
WT lgkmcnt(5)
M32 v[176:191],v[216:219],v[8:11],v[176:191]
TR v[216:217],v225 offset:24576
TR v[218:219],v225 offset:25088
M32 v[192:207],v[220:223],v[8:11],v[192:207]
TR v[220:221],v225 offset:26624
TR v[222:223],v225 offset:27136
WT lgkmcnt(4)
M32 v[144:159],v[208:211],v[12:15],v[144:159]
WT vmcnt(4)
WT lgkmcnt(8)
s_barrier
v_add_u32 v224,65536,v226
v_add_u32 v225,65536,v227
TR v[208:209],v224 offset:0
TR v[210:211],v224 offset:512
M32 v[160:175],v[212:215],v[12:15],v[160:175]
TR v[212:213],v224 offset:2048
TR v[214:215],v224 offset:2560
WT lgkmcnt(4)
M32 v[176:191],v[216:219],v[12:15],v[176:191]
TR v[216:217],v225 offset:0
TR v[218:219],v225 offset:512
M32 v[192:207],v[220:223],v[12:15],v[192:207]
TR v[220:221],v225 offset:2048
TR v[222:223],v225 offset:2560
WT lgkmcnt(4)
M32 v[144:159],v[208:211],v[16:19],v[144:159]
TR v[208:209],v224 offset:8192
TR v[210:211],v224 offset:8704
R128 v[240:243],v239 offset:0
R128 v[244:247],v239 offset:1024
M32 v[160:175],v[212:215],v[16:19],v[160:175]
TR v[212:213],v224 offset:10240
TR v[214:215],v224 offset:10752
SADD m0,s47,0
WT lgkmcnt(6)
M32 v[176:191],v[216:219],v[16:19],v[176:191]
TR v[216:217],v225 offset:8192
TR v[218:219],v225 offset:8704
WT lgkmcnt(4)
ADD v80,v80,v240
ADD v81,v81,v241
ADD v82,v82,v242
M32 v[192:207],v[220:223],v[16:19],v[192:207]
TR v[220:221],v225 offset:10240
TR v[222:223],v225 offset:10752
BL4 v228,s[16:19],s40 offen lds
ADD v83,v83,v243
ADD v84,v84,v244
ADD v85,v85,v245
WT lgkmcnt(4)
M32 v[144:159],v[208:211],v[20:23],v[144:159]
TR v[208:209],v224 offset:16384
TR v[210:211],v224 offset:16896
ADD v86,v86,v246
ADD v87,v87,v247
R128 v[240:243],v239 offset:2048
M32 v[160:175],v[212:215],v[20:23],v[160:175]
TR v[212:213],v224 offset:18432
TR v[214:215],v224 offset:18944
BL4 v229,s[16:19],s40 offen offset:1024 lds
R128 v[244:247],v239 offset:3072
WT lgkmcnt(6)
M32 v[176:191],v[216:219],v[20:23],v[176:191]
TR v[216:217],v225 offset:16384
TR v[218:219],v225 offset:16896
M32 v[192:207],v[220:223],v[20:23],v[192:207]
TR v[220:221],v225 offset:18432
TR v[222:223],v225 offset:18944
BL4 v230,s[20:23],s40 offen offset:2048 lds
WT lgkmcnt(4)
ADD v88,v88,v240
ADD v89,v89,v241
ADD v90,v90,v242
WT lgkmcnt(5)
M32 v[144:159],v[208:211],v[24:27],v[144:159]
TR v[208:209],v224 offset:24576
TR v[210:211],v224 offset:25088
ADD v91,v91,v243
ADD v92,v92,v244
ADD v93,v93,v245
ADD v94,v94,v246
M32 v[160:175],v[212:215],v[24:27],v[160:175]
TR v[212:213],v224 offset:26624
TR v[214:215],v224 offset:27136
BL4 v231,s[20:23],s40 offen offset:3072 lds
ADD v95,v95,v247
s_mul_i32 s55,s57,41472
SADD s55,s55,5242880
s_or_b32 s53,s63,s48
WT lgkmcnt(4)
M32 v[176:191],v[216:219],v[24:27],v[176:191]
TR v[216:217],v225 offset:24576
TR v[218:219],v225 offset:25088
s_cmp_eq_u32 s53,0
s_cselect_b32 s56,s55,0x7ff00000
s_lshl_b32 s53,s63,11
M32 v[192:207],v[220:223],v[24:27],v[192:207]
TR v[220:221],v225 offset:26624
TR v[222:223],v225 offset:27136
SADD s55,s55,s53
s_lshl_b32 s53,s48,9
SADD s55,s55,s53
WT lgkmcnt(4)
M32 v[144:159],v[208:211],v[28:31],v[144:159]
v_lshrrev_b32 v240,4,v234
v_lshrrev_b32 v241,1,v240
v_mul_u32_u24 v241,10368,v241
WT vmcnt(4)
WT lgkmcnt(12)
s_barrier
v_add_u32 v224,98304,v226
v_add_u32 v225,98304,v227
TR v[208:209],v224 offset:0
TR v[210:211],v224 offset:512
M32 v[160:175],v[212:215],v[28:31],v[160:175]
TR v[212:213],v224 offset:2048
TR v[214:215],v224 offset:2560
WT lgkmcnt(4)
M32 v[176:191],v[216:219],v[28:31],v[176:191]
TR v[216:217],v225 offset:0
TR v[218:219],v225 offset:512
M32 v[192:207],v[220:223],v[28:31],v[192:207]
TR v[220:221],v225 offset:2048
TR v[222:223],v225 offset:2560
WT lgkmcnt(4)
M32 v[144:159],v[208:211],v[32:35],v[144:159]
TR v[208:209],v224 offset:8192
TR v[210:211],v224 offset:8704
ds_write_b128 v238,v[128:131] offset:0
ds_write_b128 v238,v[132:135] offset:1024
ds_write_b128 v238,v[136:139] offset:2048
M32 v[160:175],v[212:215],v[32:35],v[160:175]
TR v[212:213],v224 offset:10240
TR v[214:215],v224 offset:10752
SADD m0,s47,32768
ds_write_b128 v238,v[140:143] offset:3072
AND v242,1,v240
v_lshl_add_u32 v241,v242,4,v241
WT lgkmcnt(8)
M32 v[176:191],v[216:219],v[32:35],v[176:191]
TR v[216:217],v225 offset:8192
TR v[218:219],v225 offset:8704
v_add_u32 v241,10240,v241
v_cmp_gt_u32 vcc,8,v240
M32 v[192:207],v[220:223],v[32:35],v[192:207]
TR v[220:221],v225 offset:10240
TR v[222:223],v225 offset:10752
BL4 v228,s[16:19],s41 offen lds
v_mov_b32 v243,0x80000000
v_cndmask_b32 v241,v243,v241,vcc
WT lgkmcnt(5)
M32 v[144:159],v[208:211],v[36:39],v[144:159]
TR v[208:209],v224 offset:16384
TR v[210:211],v224 offset:16896
v_cmp_eq_u32 vcc,0,v242
v_mov_b32 v244,0
M32 v[160:175],v[212:215],v[36:39],v[160:175]
TR v[212:213],v224 offset:18432
TR v[214:215],v224 offset:18944
BL4 v229,s[16:19],s41 offen offset:1024 lds
v_mov_b32 v245,0x3f803f80
v_cndmask_b32 v244,v244,v245,vcc
WT lgkmcnt(4)
M32 v[176:191],v[216:219],v[36:39],v[176:191]
TR v[216:217],v225 offset:16384
TR v[218:219],v225 offset:16896
v_mov_b32 v245,v244
v_mov_b32 v246,v244
M32 v[192:207],v[220:223],v[36:39],v[192:207]
TR v[220:221],v225 offset:18432
TR v[222:223],v225 offset:18944
BL4 v230,s[20:23],s41 offen offset:2048 lds
v_mov_b32 v247,v244
BS4 v[244:247],v241,s[24:27],s56 offen sc1
WT lgkmcnt(4)
M32 v[144:159],v[208:211],v[40:43],v[144:159]
TR v[208:209],v224 offset:24576
TR v[210:211],v224 offset:25088
CV v248,v80,v81
CV v249,v82,v83
M32 v[160:175],v[212:215],v[40:43],v[160:175]
TR v[212:213],v224 offset:26624
TR v[214:215],v224 offset:27136
BL4 v231,s[20:23],s41 offen offset:3072 lds
CV v250,v84,v85
CV v251,v86,v87
WT lgkmcnt(4)
M32 v[176:191],v[216:219],v[40:43],v[176:191]
TR v[216:217],v225 offset:24576
TR v[218:219],v225 offset:25088
CV v252,v88,v89
CV v253,v90,v91
M32 v[192:207],v[220:223],v[40:43],v[192:207]
TR v[220:221],v225 offset:26624
TR v[222:223],v225 offset:27136
CV v254,v92,v93
CV v255,v94,v95
WT lgkmcnt(4)
M32 v[144:159],v[208:211],v[44:47],v[144:159]
BS4 v[248:251],v236,s[24:27],s55 offen sc1
BS4 v[252:255],v237,s[24:27],s55 offen sc1
WT vmcnt(7)
WT lgkmcnt(15)
s_barrier
v_mov_b32 v224,v226
v_mov_b32 v225,v227
TR v[208:209],v224 offset:0
TR v[210:211],v224 offset:512
M32 v[160:175],v[212:215],v[44:47],v[160:175]
TR v[212:213],v224 offset:2048
TR v[214:215],v224 offset:2560
WT lgkmcnt(4)
M32 v[176:191],v[216:219],v[44:47],v[176:191]
TR v[216:217],v225 offset:0
TR v[218:219],v225 offset:512
M32 v[192:207],v[220:223],v[44:47],v[192:207]
TR v[220:221],v225 offset:2048
TR v[222:223],v225 offset:2560
WT lgkmcnt(4)
M32 v[144:159],v[208:211],v[48:51],v[144:159]
TR v[208:209],v224 offset:8192
TR v[210:211],v224 offset:8704
R128 v[240:243],v239 offset:0
R128 v[244:247],v239 offset:1024
M32 v[160:175],v[212:215],v[48:51],v[160:175]
TR v[212:213],v224 offset:10240
TR v[214:215],v224 offset:10752
SADD m0,s47,65536
WT lgkmcnt(6)
M32 v[176:191],v[216:219],v[48:51],v[176:191]
TR v[216:217],v225 offset:8192
TR v[218:219],v225 offset:8704
M32 v[192:207],v[220:223],v[48:51],v[192:207]
TR v[220:221],v225 offset:10240
TR v[222:223],v225 offset:10752
BL4 v228,s[16:19],s42 offen lds
WT lgkmcnt(6)
ADD v96,v96,v240
WT lgkmcnt(4)
M32 v[144:159],v[208:211],v[52:55],v[144:159]
TR v[208:209],v224 offset:16384
TR v[210:211],v224 offset:16896
ADD v97,v97,v241
ADD v98,v98,v242
M32 v[160:175],v[212:215],v[52:55],v[160:175]
TR v[212:213],v224 offset:18432
TR v[214:215],v224 offset:18944
BL4 v229,s[16:19],s42 offen offset:1024 lds
ADD v99,v99,v243
ADD v100,v100,v244
WT lgkmcnt(4)
M32 v[176:191],v[216:219],v[52:55],v[176:191]
TR v[216:217],v225 offset:16384
TR v[218:219],v225 offset:16896
ADD v101,v101,v245
ADD v102,v102,v246
M32 v[192:207],v[220:223],v[52:55],v[192:207]
TR v[220:221],v225 offset:18432
TR v[222:223],v225 offset:18944
BL4 v230,s[20:23],s42 offen offset:2048 lds
ADD v103,v103,v247
R128 v[240:243],v239 offset:2048
WT lgkmcnt(5)
M32 v[144:159],v[208:211],v[56:59],v[144:159]
TR v[208:209],v224 offset:24576
TR v[210:211],v224 offset:25088
R128 v[244:247],v239 offset:3072
M32 v[160:175],v[212:215],v[56:59],v[160:175]
TR v[212:213],v224 offset:26624
TR v[214:215],v224 offset:27136
BL4 v231,s[20:23],s42 offen offset:3072 lds
WT lgkmcnt(6)
M32 v[176:191],v[216:219],v[56:59],v[176:191]
TR v[216:217],v225 offset:24576
TR v[218:219],v225 offset:25088
WT lgkmcnt(4)
ADD v104,v104,v240
M32 v[192:207],v[220:223],v[56:59],v[192:207]
TR v[220:221],v225 offset:26624
TR v[222:223],v225 offset:27136
ADD v105,v105,v241
ADD v106,v106,v242
WT lgkmcnt(4)
M32 v[144:159],v[208:211],v[60:63],v[144:159]
ADD v107,v107,v243
ADD v108,v108,v244
ADD v109,v109,v245
ADD v110,v110,v246
ADD v111,v111,v247
CV v248,v96,v97
CV v249,v98,v99
CV v250,v100,v101
WT vmcnt(6)
s_barrier
v_add_u32 v224,32768,v226
v_add_u32 v225,32768,v227
TR v[208:209],v224 offset:0
TR v[210:211],v224 offset:512
M32 v[160:175],v[212:215],v[60:63],v[160:175]
TR v[212:213],v224 offset:2048
TR v[214:215],v224 offset:2560
WT lgkmcnt(4)
M32 v[176:191],v[216:219],v[60:63],v[176:191]
TR v[216:217],v225 offset:0
TR v[218:219],v225 offset:512
M32 v[192:207],v[220:223],v[60:63],v[192:207]
TR v[220:221],v225 offset:2048
TR v[222:223],v225 offset:2560
WT lgkmcnt(4)
M32 v[144:159],v[208:211],v[64:67],v[144:159]
TR v[208:209],v224 offset:8192
TR v[210:211],v224 offset:8704
CV v251,v102,v103
M32 v[160:175],v[212:215],v[64:67],v[160:175]
TR v[212:213],v224 offset:10240
TR v[214:215],v224 offset:10752
SADD m0,s47,98304
CV v252,v104,v105
WT lgkmcnt(4)
M32 v[176:191],v[216:219],v[64:67],v[176:191]
TR v[216:217],v225 offset:8192
TR v[218:219],v225 offset:8704
CV v253,v106,v107
M32 v[192:207],v[220:223],v[64:67],v[192:207]
TR v[220:221],v225 offset:10240
TR v[222:223],v225 offset:10752
BL4 v228,s[16:19],s43 offen lds
CV v254,v108,v109
WT lgkmcnt(4)
M32 v[144:159],v[208:211],v[68:71],v[144:159]
TR v[208:209],v224 offset:16384
TR v[210:211],v224 offset:16896
CV v255,v110,v111
M32 v[160:175],v[212:215],v[68:71],v[160:175]
TR v[212:213],v224 offset:18432
TR v[214:215],v224 offset:18944
BL4 v229,s[16:19],s43 offen offset:1024 lds
BS4 v[248:251],v236,s[24:27],s55 offen offset:1024 sc1
WT lgkmcnt(4)
M32 v[176:191],v[216:219],v[68:71],v[176:191]
TR v[216:217],v225 offset:16384
TR v[218:219],v225 offset:16896
BS4 v[252:255],v237,s[24:27],s55 offen offset:1024 sc1
M32 v[192:207],v[220:223],v[68:71],v[192:207]
TR v[220:221],v225 offset:18432
TR v[222:223],v225 offset:18944
BL4 v230,s[20:23],s43 offen offset:2048 lds
WT lgkmcnt(4)
M32 v[144:159],v[208:211],v[72:75],v[144:159]
TR v[208:209],v224 offset:24576
TR v[210:211],v224 offset:25088
M32 v[160:175],v[212:215],v[72:75],v[160:175]
TR v[212:213],v224 offset:26624
TR v[214:215],v224 offset:27136
BL4 v231,s[20:23],s43 offen offset:3072 lds
WT lgkmcnt(4)
M32 v[176:191],v[216:219],v[72:75],v[176:191]
TR v[216:217],v225 offset:24576
TR v[218:219],v225 offset:25088
M32 v[192:207],v[220:223],v[72:75],v[192:207]
TR v[220:221],v225 offset:26624
TR v[222:223],v225 offset:27136
WT lgkmcnt(4)
M32 v[144:159],v[208:211],v[76:79],v[144:159]
M32 v[160:175],v[212:215],v[76:79],v[160:175]
WT lgkmcnt(0)
M32 v[176:191],v[216:219],v[76:79],v[176:191]
M32 v[192:207],v[220:223],v[76:79],v[192:207]
WT vmcnt(2)
s_barrier
s_cmp_lg_u32 s30,0
s_cbranch_scc1 SQ_w9
v_mov_b32 v236,0
s_mov_b32 s52,0
SQ_clr9:
buffer_load_dword v232,v236,s[64:67],0 offen sc1
WT vmcnt(0)
s_mov_b64 s[94:95],0
v_cmp_ne_u32 vcc,0x1,v232
s_nop 3
s_and_b32 vcc_lo,vcc_lo,0x1
s_and_b32 vcc_hi,vcc_hi,0x0
s_or_b64 s[94:95],s[94:95],vcc
s_cmp_eq_u64 s[94:95],0
s_cbranch_scc1 SQ_clr9_ok
SADD s52,s52,1
s_cmp_lt_u32 s52,200000
s_cbranch_scc0 SQ_clr9_ok
s_sleep 2
s_branch SQ_clr9
SQ_clr9_ok:
s_lshl_b32 s89,s29,7
s_lshl_b32 s90,s28,2
SADD s89,s89,s90
SADD s89,s89,23461888
v_mov_b32 v235,0x5ca1ab1e
v_mov_b32 v236,s89
s_mov_b64 exec,1
buffer_store_dword v235,v236,s[24:27],0 offen sc1
s_mov_b64 exec,-1
SQ_w9:
s_nop 11
s_barrier
s_lshl_b32 s53,s30,13
SADD s53,s53,65536
v_add_u32 v238,s53,v234
s_xor_b32 s53,s30,4
s_lshl_b32 s53,s53,13
SADD s53,s53,65536
v_add_u32 v239,s53,v234
ds_write_b128 v238,v[176:179] offset:0
ds_write_b128 v238,v[180:183] offset:1024
ds_write_b128 v238,v[184:187] offset:2048
ds_write_b128 v238,v[188:191] offset:3072
ds_write_b128 v238,v[192:195] offset:4096
ds_write_b128 v238,v[196:199] offset:5120
ds_write_b128 v238,v[200:203] offset:6144
ds_write_b128 v238,v[204:207] offset:7168
s_lshl_b32 s91,s28,9
s_lshl_b32 s89,s29,5
SADD s91,s91,s89
s_lshl_b32 s89,s30,2
SADD s91,s91,s89
SADD s91,s91,23463936
s_and_b32 s31,s30,3
s_lshr_b32 s43,s30,2
s_and_b32 s9,s2,7
s_lshr_b32 s10,s2,3
s_lshl_b32 s41,s9,3
s_lshr_b32 s42,s10,2
SADD s41,s41,s42
s_and_b32 s42,s10,3
s_and_b32 s5,s10,7
s_lshr_b32 s10,s10,3
s_lshl_b32 s4,s9,2
SADD s4,s4,s10
s_lshr_b32 s6,s5,1
s_lshr_b32 s9,s4,1
s_mul_i32 s9,s9,5
s_and_b32 s10,s4,1
s_lshl_b32 s10,s10,1
SADD s9,s9,s10
s_lshl_b32 s18,s9,9
s_mul_i32 s11,s31,163840
SADD s11,s11,s18
SADD s11,s11,2621440
s_mul_i32 s22,s31,6144
s_mul_i32 s23,s31,5632
s_mul_i32 s12,s31,165888
SADD s12,s12,5242880
SADD s23,s23,24576
s_mov_b32 s16,0
s_lshl_b32 s9,s6,2
s_lshl_b32 s92,15,s9
s_lshl_b32 s9,s92,16
s_or_b32 s92,s92,s9
v_lshrrev_b32 v9,4,v234
s_mul_i32 s9,s4,20
SADD s10,s9,19
s_lshr_b32 s9,s9,7
s_lshr_b32 s10,s10,7
v_lshrrev_b32 v10,4,v9
AND v11,15,v9
AND v12,1,v10
v_mov_b32 v13,s9
v_mov_b32 v14,s10
v_cmp_eq_u32 vcc,1,v12
s_nop 1
v_cndmask_b32 v13,v13,v14,vcc
v_lshrrev_b32 v12,1,v10
v_mul_u32_u24 v14,5,v12
v_add_u32 v14,v14,v13
SHL v14,7,v14
v_lshl_add_u32 v14,v11,2,v14
v_add_u32 v15,23461888,v14
v_add_u32 v14,10,v13
SHL v14,7,v14
v_lshl_add_u32 v14,v11,2,v14
v_add_u32 v16,23461888,v14
SHL v14,2,v11
v_add_u32 v14,23472128,v14
v_cmp_le_u32 vcc,2,v10
s_nop 1
v_cndmask_b32 v16,v16,v14,vcc
v_mov_b32 v235,v15
v_mov_b32 v236,v16
buffer_load_dword v237,v235,s[24:27],0 offen sc1
buffer_load_dword v232,v236,s[24:27],0 offen sc1
v_mov_b32 v204,v234
v_lshrrev_b32 v205,4,v234
v_add_u32 v40,0,v205
v_cmp_le_u32 vcc,96,v40
SHL v41,4,v40
v_add_u32 v42,39424,v41
v_cndmask_b32 v192,v41,v42,vcc
v_add_u32 v40,64,v205
v_cmp_le_u32 vcc,96,v40
SHL v41,4,v40
v_add_u32 v42,39424,v41
v_cndmask_b32 v193,v41,v42,vcc
v_add_u32 v40,128,v205
v_cmp_le_u32 vcc,96,v40
SHL v41,4,v40
v_add_u32 v42,39424,v41
v_cndmask_b32 v194,v41,v42,vcc
s_mul_i32 s9,s4,20
v_add_u32 v40,0,v205
v_mul_u32_u24 v41,745,v40
v_lshrrev_b32 v41,16,v41
v_mul_u32_u24 v42,88,v41
v_sub_u32 v40,v40,v42
v_mul_u32_u24 v41,41472,v41
v_mul_u32_u24 v42,2979,v40
v_lshrrev_b32 v42,16,v42
v_mul_u32_u24 v43,22,v42
v_sub_u32 v40,v40,v43
v_mul_u32_u24 v42,10368,v42
v_add_u32 v41,v41,v42
v_add_u32 v42,s9,v40
v_add_u32 v43,620,v40
v_cmp_gt_u32 vcc,20,v40
s_nop 1
v_cndmask_b32 v42,v43,v42,vcc
v_lshl_add_u32 v41,v42,4,v41
v_mov_b32 v195,v41
v_add_u32 v40,64,v205
v_mul_u32_u24 v41,745,v40
v_lshrrev_b32 v41,16,v41
v_mul_u32_u24 v42,88,v41
v_sub_u32 v40,v40,v42
v_mul_u32_u24 v41,41472,v41
v_mul_u32_u24 v42,2979,v40
v_lshrrev_b32 v42,16,v42
v_mul_u32_u24 v43,22,v42
v_sub_u32 v40,v40,v43
v_mul_u32_u24 v42,10368,v42
v_add_u32 v41,v41,v42
v_add_u32 v42,s9,v40
v_add_u32 v43,620,v40
v_cmp_gt_u32 vcc,20,v40
s_nop 1
v_cndmask_b32 v42,v43,v42,vcc
v_lshl_add_u32 v41,v42,4,v41
v_subrev_u32 v196,1024,v41
v_add_u32 v40,128,v205
v_mul_u32_u24 v41,745,v40
v_lshrrev_b32 v41,16,v41
v_mul_u32_u24 v42,88,v41
v_sub_u32 v40,v40,v42
v_mul_u32_u24 v41,41472,v41
v_mul_u32_u24 v42,2979,v40
v_lshrrev_b32 v42,16,v42
v_mul_u32_u24 v43,22,v42
v_sub_u32 v40,v40,v43
v_mul_u32_u24 v42,10368,v42
v_add_u32 v41,v41,v42
v_add_u32 v42,s9,v40
v_add_u32 v43,620,v40
v_cmp_gt_u32 vcc,20,v40
s_nop 1
v_cndmask_b32 v42,v43,v42,vcc
v_lshl_add_u32 v41,v42,4,v41
v_subrev_u32 v197,2048,v41
v_add_u32 v40,192,v205
v_mul_u32_u24 v41,745,v40
v_lshrrev_b32 v41,16,v41
v_mul_u32_u24 v42,88,v41
v_sub_u32 v40,v40,v42
v_mul_u32_u24 v41,41472,v41
v_mul_u32_u24 v42,2979,v40
v_lshrrev_b32 v42,16,v42
v_mul_u32_u24 v43,22,v42
v_sub_u32 v40,v40,v43
v_mul_u32_u24 v42,10368,v42
v_add_u32 v41,v41,v42
v_add_u32 v42,s9,v40
v_add_u32 v43,620,v40
v_cmp_gt_u32 vcc,20,v40
s_nop 1
v_cndmask_b32 v42,v43,v42,vcc
v_lshl_add_u32 v41,v42,4,v41
v_subrev_u32 v198,3072,v41
v_add_u32 v40,256,v205
v_mul_u32_u24 v41,745,v40
v_lshrrev_b32 v41,16,v41
v_mul_u32_u24 v42,88,v41
v_sub_u32 v40,v40,v42
v_mul_u32_u24 v41,41472,v41
v_mul_u32_u24 v42,2979,v40
v_lshrrev_b32 v42,16,v42
v_mul_u32_u24 v43,22,v42
v_sub_u32 v40,v40,v43
v_mul_u32_u24 v42,10368,v42
v_add_u32 v41,v41,v42
v_add_u32 v42,s9,v40
v_add_u32 v43,620,v40
v_cmp_gt_u32 vcc,20,v40
s_nop 1
v_cndmask_b32 v42,v43,v42,vcc
v_lshl_add_u32 v41,v42,4,v41
v_mov_b32 v199,v41
v_add_u32 v40,320,v205
v_mul_u32_u24 v41,745,v40
v_lshrrev_b32 v41,16,v41
v_mul_u32_u24 v42,88,v41
v_sub_u32 v40,v40,v42
v_mul_u32_u24 v41,41472,v41
v_mul_u32_u24 v42,2979,v40
v_lshrrev_b32 v42,16,v42
v_mul_u32_u24 v43,22,v42
v_sub_u32 v40,v40,v43
v_mul_u32_u24 v42,10368,v42
v_add_u32 v41,v41,v42
v_add_u32 v42,s9,v40
v_add_u32 v43,620,v40
v_cmp_gt_u32 vcc,20,v40
s_nop 1
v_cndmask_b32 v42,v43,v42,vcc
v_lshl_add_u32 v41,v42,4,v41
v_subrev_u32 v200,1024,v41
WT vmcnt(0)
s_mov_b64 s[94:95],0
v_cmp_ne_u32 vcc,0x5ca1ab1e,v237
s_nop 3
s_and_b32 vcc_lo,vcc_lo,s92
s_and_b32 vcc_hi,vcc_hi,s92
s_or_b64 s[94:95],s[94:95],vcc
v_cmp_ne_u32 vcc,0x5ca1ab1e,v232
s_nop 3
s_and_b32 vcc_lo,vcc_lo,s92
s_and_b32 vcc_hi,vcc_hi,0x0
s_or_b64 s[94:95],s[94:95],vcc
s_cmp_eq_u64 s[94:95],0
s_cbranch_scc1 T1_go10
s_mov_b32 s52,0
T1_spin10:
buffer_load_dword v20,v235,s[24:27],0 offen sc1
buffer_load_dword v21,v236,s[24:27],0 offen sc1
WT vmcnt(0)
s_mov_b64 s[94:95],0
v_cmp_ne_u32 vcc,0x5ca1ab1e,v20
s_nop 3
s_and_b32 vcc_lo,vcc_lo,s92
s_and_b32 vcc_hi,vcc_hi,s92
s_or_b64 s[94:95],s[94:95],vcc
v_cmp_ne_u32 vcc,0x5ca1ab1e,v21
s_nop 3
s_and_b32 vcc_lo,vcc_lo,s92
s_and_b32 vcc_hi,vcc_hi,0x0
s_or_b64 s[94:95],s[94:95],vcc
s_cmp_eq_u64 s[94:95],0
s_cbranch_scc1 T1_spin10_ok
SADD s52,s52,1
s_cmp_lt_u32 s52,200000
s_cbranch_scc0 T1_spin10_ok
s_sleep 2
s_branch T1_spin10
T1_spin10_ok:
T1_go10:
s_cmp_eq_u32 s43,1
s_cbranch_scc1 T1_h11
s_lshl_b32 s9,s31,1
s_lshl_b32 s10,s5,3
SADD s9,s9,s10
s_mul_i32 s7,s9,40960
SADD s7,s7,s18
s_and_b32 s10,s4,1
s_lshl_b32 s9,s10,9
SADD s8,s7,s9
s_cmp_eq_u32 s10,0
s_cselect_b32 s9,1024,8
SADD s7,s7,s9
AND v41,31,v205
SHL v42,4,v41
BL4 v[176:179],v204,s[24:27],s8 offen sc1
buffer_load_dwordx2 v[184:185],v42,s[24:27],s7 offen sc1
SADD s8,s8,40960
SADD s7,s7,40960
BL4 v[180:183],v204,s[24:27],s8 offen sc1
buffer_load_dwordx2 v[186:187],v42,s[24:27],s7 offen sc1
s_branch T1_j11
T1_h11:
s_mov_b32 s13,s6
s_mov_b32 s14,0
s_mov_b32 s15,4
s_mul_i32 s7,s13,655360
SADD s7,s7,s11
s_mul_i32 s33,s13,663552
SADD s33,s33,s12
s_cmp_eq_u32 s15,0
s_cselect_b32 s7,0x7ff00000,s7
s_cselect_b32 s33,0x7ff00000,s33
SADD s34,s7,81920
SADD s8,s14,s22
SADD s21,s14,s23
SADD s13,s13,1
s_and_b32 s13,s13,3
SADD s14,s14,47104
s_cmp_eq_u32 s14,141312
s_cselect_b32 s14,0,s14
s_cmp_lg_u32 s15,0
s_subb_u32 s15,s15,0
SADD m0,s8,0
s_nop 0
BL4 v192,s[24:27],s7 offen sc1 lds
SADD m0,s8,1024
s_nop 0
BL4 v193,s[24:27],s7 offen sc1 lds
SADD m0,s8,2048
s_nop 0
BL4 v194,s[24:27],s7 offen sc1 lds
SADD m0,s8,3072
s_nop 0
BL4 v192,s[24:27],s34 offen sc1 lds
SADD m0,s8,4096
s_nop 0
BL4 v193,s[24:27],s34 offen sc1 lds
SADD m0,s8,5120
s_nop 0
BL4 v194,s[24:27],s34 offen sc1 lds
s_mov_b32 m0,s21
s_nop 0
BL4 v195,s[24:27],s33 offen sc1 lds
s_mov_b32 m0,s21
s_nop 0
BL4 v196,s[24:27],s33 offen offset:1024 sc1 lds
s_mov_b32 m0,s21
s_nop 0
BL4 v197,s[24:27],s33 offen offset:2048 sc1 lds
s_mov_b32 m0,s21
s_nop 0
BL4 v198,s[24:27],s33 offen offset:3072 sc1 lds
SADD m0,s21,4096
s_nop 0
BL4 v199,s[24:27],s33 offen sc1 lds
SADD m0,s21,4096
s_mov_b32 exec_hi,0
BL4 v200,s[24:27],s33 offen offset:1024 sc1 lds
s_mov_b32 exec_hi,-1
T1_j11:
WT lgkmcnt(0)
s_barrier
R128 v[44:47],v239 offset:0
R128 v[48:51],v239 offset:1024
R128 v[52:55],v239 offset:2048
R128 v[56:59],v239 offset:3072
R128 v[0:3],v239 offset:4096
R128 v[4:7],v239 offset:5120
R128 v[8:11],v239 offset:6144
R128 v[12:15],v239 offset:7168
WT lgkmcnt(4)
ADD v144,v144,v44
ADD v145,v145,v45
ADD v146,v146,v46
ADD v147,v147,v47
ADD v148,v148,v48
ADD v149,v149,v49
ADD v150,v150,v50
ADD v151,v151,v51
ADD v152,v152,v52
ADD v153,v153,v53
ADD v154,v154,v54
ADD v155,v155,v55
ADD v156,v156,v56
ADD v157,v157,v57
ADD v158,v158,v58
ADD v159,v159,v59
WT lgkmcnt(0)
ADD v160,v160,v0
ADD v161,v161,v1
ADD v162,v162,v2
ADD v163,v163,v3
ADD v164,v164,v4
ADD v165,v165,v5
ADD v166,v166,v6
ADD v167,v167,v7
ADD v168,v168,v8
ADD v169,v169,v9
ADD v170,v170,v10
ADD v171,v171,v11
ADD v172,v172,v12
ADD v173,v173,v13
ADD v174,v174,v14
ADD v175,v175,v15
s_mul_i32 s55,s57,110592
s_lshl_b32 s53,s60,12
SADD s55,s55,s53
s_lshl_b32 s53,s48,11
SADD s55,s55,s53
SADD s55,s55,8126464
MUL v144,0xbfb8aa3b,v144
MUL v145,0xbfb8aa3b,v145
MUL v146,0xbfb8aa3b,v146
MUL v147,0xbfb8aa3b,v147
EX v144,v144
EX v145,v145
EX v146,v146
EX v147,v147
MUL v148,0xbfb8aa3b,v148
MUL v149,0xbfb8aa3b,v149
MUL v150,0xbfb8aa3b,v150
MUL v151,0xbfb8aa3b,v151
EX v148,v148
EX v149,v149
EX v150,v150
EX v151,v151
MUL v152,0xbfb8aa3b,v152
MUL v153,0xbfb8aa3b,v153
MUL v154,0xbfb8aa3b,v154
MUL v155,0xbfb8aa3b,v155
EX v152,v152
EX v153,v153
EX v154,v154
EX v155,v155
MUL v156,0xbfb8aa3b,v156
MUL v157,0xbfb8aa3b,v157
MUL v158,0xbfb8aa3b,v158
MUL v159,0xbfb8aa3b,v159
EX v156,v156
EX v157,v157
EX v158,v158
EX v159,v159
ADD v144,1.0,v144
ADD v145,1.0,v145
ADD v146,1.0,v146
ADD v147,1.0,v147
RCP v144,v144
RCP v145,v145
RCP v146,v146
RCP v147,v147
ADD v148,1.0,v148
ADD v149,1.0,v149
ADD v150,1.0,v150
ADD v151,1.0,v151
RCP v148,v148
RCP v149,v149
RCP v150,v150
RCP v151,v151
ADD v152,1.0,v152
ADD v153,1.0,v153
ADD v154,1.0,v154
ADD v155,1.0,v155
RCP v152,v152
RCP v153,v153
RCP v154,v154
RCP v155,v155
ADD v156,1.0,v156
ADD v157,1.0,v157
ADD v158,1.0,v158
ADD v159,1.0,v159
RCP v156,v156
RCP v157,v157
RCP v158,v158
RCP v159,v159
MUL v160,v160,v144
MUL v161,v161,v145
MUL v162,v162,v146
MUL v163,v163,v147
CV v248,v160,v161
CV v249,v162,v163
MUL v164,v164,v148
MUL v165,v165,v149
MUL v166,v166,v150
MUL v167,v167,v151
CV v250,v164,v165
CV v251,v166,v167
MUL v168,v168,v152
MUL v169,v169,v153
MUL v170,v170,v154
MUL v171,v171,v155
CV v252,v168,v169
CV v253,v170,v171
MUL v172,v172,v156
MUL v173,v173,v157
MUL v174,v174,v158
MUL v175,v175,v159
CV v254,v172,v173
CV v255,v174,v175
v_permlane32_swap_b32 v248,v250
v_permlane32_swap_b32 v249,v251
v_permlane32_swap_b32 v252,v254
v_permlane32_swap_b32 v253,v255
BS4 v[248:251],v234,s[24:27],s55 offen sc1
BS4 v[252:255],v234,s[24:27],s55 offen offset:1024 sc1
s_branch T1_common
K1_retile:
s_load_dwordx2 s[8:9],s[0:1],48
s_load_dwordx2 s[12:13],s[0:1],16
s_mov_b32 s51,s28
s_mov_b32 s63,s51
WT lgkmcnt(0)
s_mov_b32 s26,23527424
s_mov_b32 s27,131072
s_load_dwordx2 s[64:65],s[0:1],64
WT lgkmcnt(0)
s_mov_b32 s66,256
s_mov_b32 s67,131072
s_cmp_lg_u32 s2,198
s_cbranch_scc1 CLR_done
v_mov_b32 v20,0
v_mov_b32 v21,0
v_mov_b32 v22,0
v_mov_b32 v23,0
s_lshl_b32 s52,s30,11
SADD s52,s52,23461888
BS4 v[20:23],v234,s[24:27],s52 offen sc1
BS4 v[20:23],v234,s[24:27],s52 offen offset:1024 sc1
WT vmcnt(0)
s_barrier
s_mov_b32 s52,0
s_cmp_lg_u32 s30,0
s_cbranch_scc1 CLR_w
v_mov_b32 v20,0x1
v_mov_b32 v21,s52
s_mov_b64 exec,1
buffer_store_dword v20,v21,s[64:67],0 offen sc1
s_mov_b64 exec,-1
WT vmcnt(0)
CLR_w:
CLR_done:
s_lshl_b32 s51,s51,3
SADD s28,s51,s30
v_lshrrev_b32 v242,5,v241
SHL v242,3,v242
v_bfe_u32 v243,v241,2,2
v_add_u32 v242,v242,v243
v_mul_u32_u24 v242,1280,v242
v_bfe_u32 v244,v241,4,1
v_lshl_add_u32 v242,v244,5,v242
AND v244,3,v241
v_lshl_add_u32 v242,v244,3,v242
s_mul_i32 s47,s30,20480
v_add_u32 v242,s47,v242
WT lgkmcnt(0)
s_mov_b32 s10,2211840
s_mov_b32 s11,131072
s_mov_b32 s14,819200
s_mov_b32 s15,131072
s_mov_b32 s26,23527424
s_mov_b32 s27,131072
K1_rt_loop:
s_cmp_ge_u32 s28,108
s_cbranch_scc1 K1_rt_wo
s_mov_b32 s29,s28
s_mul_i32 s50,s29,20480
SADD m0,s47,0
SADD s52,s50,0
BL4 v234,s[8:11],s52 offen lds
BL4 v234,s[8:11],s52 offen offset:1024 lds
BL4 v234,s[8:11],s52 offen offset:2048 lds
BL4 v234,s[8:11],s52 offen offset:3072 lds
SADD m0,s47,4096
SADD s52,s50,4096
BL4 v234,s[8:11],s52 offen lds
BL4 v234,s[8:11],s52 offen offset:1024 lds
BL4 v234,s[8:11],s52 offen offset:2048 lds
BL4 v234,s[8:11],s52 offen offset:3072 lds
SADD m0,s47,8192
SADD s52,s50,8192
BL4 v234,s[8:11],s52 offen lds
BL4 v234,s[8:11],s52 offen offset:1024 lds
BL4 v234,s[8:11],s52 offen offset:2048 lds
BL4 v234,s[8:11],s52 offen offset:3072 lds
SADD m0,s47,12288
SADD s52,s50,12288
BL4 v234,s[8:11],s52 offen lds
BL4 v234,s[8:11],s52 offen offset:1024 lds
BL4 v234,s[8:11],s52 offen offset:2048 lds
BL4 v234,s[8:11],s52 offen offset:3072 lds
SADD m0,s47,16384
SADD s52,s50,16384
BL4 v234,s[8:11],s52 offen lds
BL4 v234,s[8:11],s52 offen offset:1024 lds
BL4 v234,s[8:11],s52 offen offset:2048 lds
BL4 v234,s[8:11],s52 offen offset:3072 lds
s_mul_i32 s50,s29,5120
SADD s50,s50,17825792
WT vmcnt(0)
TR v[8:9],v242 offset:0
TR v[10:11],v242 offset:5120
WT lgkmcnt(0)
BS4 v[8:11],v234,s[24:27],s50 offen sc1
SADD s50,s50,1024
TR v[12:13],v242 offset:64
TR v[14:15],v242 offset:5184
WT lgkmcnt(0)
BS4 v[12:15],v234,s[24:27],s50 offen sc1
SADD s50,s50,1024
TR v[16:17],v242 offset:128
TR v[18:19],v242 offset:5248
WT lgkmcnt(0)
BS4 v[16:19],v234,s[24:27],s50 offen sc1
SADD s50,s50,1024
TR v[20:21],v242 offset:192
TR v[22:23],v242 offset:5312
WT lgkmcnt(0)
BS4 v[20:23],v234,s[24:27],s50 offen sc1
SADD s50,s50,1024
TR v[24:25],v242 offset:256
TR v[26:27],v242 offset:5376
WT lgkmcnt(0)
BS4 v[24:27],v234,s[24:27],s50 offen sc1
SADD s50,s50,548864
TR v[28:29],v242 offset:320
TR v[30:31],v242 offset:5440
WT lgkmcnt(0)
BS4 v[28:31],v234,s[24:27],s50 offen sc1
SADD s50,s50,1024
TR v[32:33],v242 offset:384
TR v[34:35],v242 offset:5504
WT lgkmcnt(0)
BS4 v[32:35],v234,s[24:27],s50 offen sc1
SADD s50,s50,1024
TR v[36:37],v242 offset:448
TR v[38:39],v242 offset:5568
WT lgkmcnt(0)
BS4 v[36:39],v234,s[24:27],s50 offen sc1
SADD s50,s50,1024
WT vmcnt(0)
TR v[8:9],v242 offset:512
TR v[10:11],v242 offset:5632
WT lgkmcnt(0)
BS4 v[8:11],v234,s[24:27],s50 offen sc1
SADD s50,s50,1024
TR v[12:13],v242 offset:576
TR v[14:15],v242 offset:5696
WT lgkmcnt(0)
BS4 v[12:15],v234,s[24:27],s50 offen sc1
SADD s50,s50,548864
TR v[16:17],v242 offset:640
TR v[18:19],v242 offset:5760
WT lgkmcnt(0)
BS4 v[16:19],v234,s[24:27],s50 offen sc1
SADD s50,s50,1024
TR v[20:21],v242 offset:704
TR v[22:23],v242 offset:5824
WT lgkmcnt(0)
BS4 v[20:23],v234,s[24:27],s50 offen sc1
SADD s50,s50,1024
TR v[24:25],v242 offset:768
TR v[26:27],v242 offset:5888
WT lgkmcnt(0)
BS4 v[24:27],v234,s[24:27],s50 offen sc1
SADD s50,s50,1024
TR v[28:29],v242 offset:832
TR v[30:31],v242 offset:5952
WT lgkmcnt(0)
BS4 v[28:31],v234,s[24:27],s50 offen sc1
SADD s50,s50,1024
TR v[32:33],v242 offset:896
TR v[34:35],v242 offset:6016
WT lgkmcnt(0)
BS4 v[32:35],v234,s[24:27],s50 offen sc1
SADD s50,s50,548864
TR v[36:37],v242 offset:960
TR v[38:39],v242 offset:6080
WT lgkmcnt(0)
BS4 v[36:39],v234,s[24:27],s50 offen sc1
SADD s50,s50,1024
WT vmcnt(0)
TR v[8:9],v242 offset:1024
TR v[10:11],v242 offset:6144
WT lgkmcnt(0)
BS4 v[8:11],v234,s[24:27],s50 offen sc1
SADD s50,s50,1024
TR v[12:13],v242 offset:1088
TR v[14:15],v242 offset:6208
WT lgkmcnt(0)
BS4 v[12:15],v234,s[24:27],s50 offen sc1
SADD s50,s50,1024
TR v[16:17],v242 offset:1152
TR v[18:19],v242 offset:6272
WT lgkmcnt(0)
BS4 v[16:19],v234,s[24:27],s50 offen sc1
SADD s50,s50,1024
TR v[20:21],v242 offset:1216
TR v[22:23],v242 offset:6336
WT lgkmcnt(0)
BS4 v[20:23],v234,s[24:27],s50 offen sc1
SADD s50,s50,548864
WT vmcnt(0)
s_branch K1_rt_next
K1_rt_wo:
s_sub_u32 s29,s28,108
s_mul_i32 s50,s29,20480
SADD m0,s47,0
SADD s52,s50,0
BL4 v234,s[12:15],s52 offen lds
BL4 v234,s[12:15],s52 offen offset:1024 lds
BL4 v234,s[12:15],s52 offen offset:2048 lds
BL4 v234,s[12:15],s52 offen offset:3072 lds
SADD m0,s47,4096
SADD s52,s50,4096
BL4 v234,s[12:15],s52 offen lds
BL4 v234,s[12:15],s52 offen offset:1024 lds
BL4 v234,s[12:15],s52 offen offset:2048 lds
BL4 v234,s[12:15],s52 offen offset:3072 lds
SADD m0,s47,8192
SADD s52,s50,8192
BL4 v234,s[12:15],s52 offen lds
BL4 v234,s[12:15],s52 offen offset:1024 lds
BL4 v234,s[12:15],s52 offen offset:2048 lds
BL4 v234,s[12:15],s52 offen offset:3072 lds
SADD m0,s47,12288
SADD s52,s50,12288
BL4 v234,s[12:15],s52 offen lds
BL4 v234,s[12:15],s52 offen offset:1024 lds
BL4 v234,s[12:15],s52 offen offset:2048 lds
BL4 v234,s[12:15],s52 offen offset:3072 lds
SADD m0,s47,16384
SADD s52,s50,16384
BL4 v234,s[12:15],s52 offen lds
BL4 v234,s[12:15],s52 offen offset:1024 lds
BL4 v234,s[12:15],s52 offen offset:2048 lds
BL4 v234,s[12:15],s52 offen offset:3072 lds
s_mul_i32 s50,s29,5120
SADD s50,s50,20037632
WT vmcnt(0)
TR v[8:9],v242 offset:0
TR v[10:11],v242 offset:5120
WT lgkmcnt(0)
BS4 v[8:11],v234,s[24:27],s50 offen sc1
SADD s50,s50,1024
TR v[12:13],v242 offset:64
TR v[14:15],v242 offset:5184
WT lgkmcnt(0)
BS4 v[12:15],v234,s[24:27],s50 offen sc1
SADD s50,s50,1024
TR v[16:17],v242 offset:128
TR v[18:19],v242 offset:5248
WT lgkmcnt(0)
BS4 v[16:19],v234,s[24:27],s50 offen sc1
SADD s50,s50,1024
TR v[20:21],v242 offset:192
TR v[22:23],v242 offset:5312
WT lgkmcnt(0)
BS4 v[20:23],v234,s[24:27],s50 offen sc1
SADD s50,s50,1024
TR v[24:25],v242 offset:256
TR v[26:27],v242 offset:5376
WT lgkmcnt(0)
BS4 v[24:27],v234,s[24:27],s50 offen sc1
SADD s50,s50,200704
TR v[28:29],v242 offset:320
TR v[30:31],v242 offset:5440
WT lgkmcnt(0)
BS4 v[28:31],v234,s[24:27],s50 offen sc1
SADD s50,s50,1024
TR v[32:33],v242 offset:384
TR v[34:35],v242 offset:5504
WT lgkmcnt(0)
BS4 v[32:35],v234,s[24:27],s50 offen sc1
SADD s50,s50,1024
TR v[36:37],v242 offset:448
TR v[38:39],v242 offset:5568
WT lgkmcnt(0)
BS4 v[36:39],v234,s[24:27],s50 offen sc1
SADD s50,s50,1024
WT vmcnt(0)
TR v[8:9],v242 offset:512
TR v[10:11],v242 offset:5632
WT lgkmcnt(0)
BS4 v[8:11],v234,s[24:27],s50 offen sc1
SADD s50,s50,1024
TR v[12:13],v242 offset:576
TR v[14:15],v242 offset:5696
WT lgkmcnt(0)
BS4 v[12:15],v234,s[24:27],s50 offen sc1
SADD s50,s50,200704
TR v[16:17],v242 offset:640
TR v[18:19],v242 offset:5760
WT lgkmcnt(0)
BS4 v[16:19],v234,s[24:27],s50 offen sc1
SADD s50,s50,1024
TR v[20:21],v242 offset:704
TR v[22:23],v242 offset:5824
WT lgkmcnt(0)
BS4 v[20:23],v234,s[24:27],s50 offen sc1
SADD s50,s50,1024
TR v[24:25],v242 offset:768
TR v[26:27],v242 offset:5888
WT lgkmcnt(0)
BS4 v[24:27],v234,s[24:27],s50 offen sc1
SADD s50,s50,1024
TR v[28:29],v242 offset:832
TR v[30:31],v242 offset:5952
WT lgkmcnt(0)
BS4 v[28:31],v234,s[24:27],s50 offen sc1
SADD s50,s50,1024
TR v[32:33],v242 offset:896
TR v[34:35],v242 offset:6016
WT lgkmcnt(0)
BS4 v[32:35],v234,s[24:27],s50 offen sc1
SADD s50,s50,200704
TR v[36:37],v242 offset:960
TR v[38:39],v242 offset:6080
WT lgkmcnt(0)
BS4 v[36:39],v234,s[24:27],s50 offen sc1
SADD s50,s50,1024
WT vmcnt(0)
TR v[8:9],v242 offset:1024
TR v[10:11],v242 offset:6144
WT lgkmcnt(0)
BS4 v[8:11],v234,s[24:27],s50 offen sc1
SADD s50,s50,1024
TR v[12:13],v242 offset:1088
TR v[14:15],v242 offset:6208
WT lgkmcnt(0)
BS4 v[12:15],v234,s[24:27],s50 offen sc1
SADD s50,s50,1024
TR v[16:17],v242 offset:1152
TR v[18:19],v242 offset:6272
WT lgkmcnt(0)
BS4 v[16:19],v234,s[24:27],s50 offen sc1
SADD s50,s50,1024
TR v[20:21],v242 offset:1216
TR v[22:23],v242 offset:6336
WT lgkmcnt(0)
BS4 v[20:23],v234,s[24:27],s50 offen sc1
SADD s50,s50,200704
WT vmcnt(0)
s_branch K1_rt_next
K1_rt_next:
SADD s28,s28,128
s_cmp_lt_u32 s28,148
s_cbranch_scc1 K1_rt_loop
WT vmcnt(0)
s_barrier
s_lshl_b32 s89,s63,2
SADD s89,s89,23472128
s_cmp_lg_u32 s30,0
s_cbranch_scc1 RT_w
v_mov_b32 v30,0
s_mov_b32 s52,0
RT_clr:
buffer_load_dword v31,v30,s[64:67],0 offen sc1
WT vmcnt(0)
s_mov_b64 s[94:95],0
v_cmp_ne_u32 vcc,0x1,v31
s_nop 3
s_and_b32 vcc_lo,vcc_lo,0x1
s_and_b32 vcc_hi,vcc_hi,0x0
s_or_b64 s[94:95],s[94:95],vcc
s_cmp_eq_u64 s[94:95],0
s_cbranch_scc1 RT_clr_ok
SADD s52,s52,1
s_cmp_lt_u32 s52,200000
s_cbranch_scc0 RT_clr_ok
s_sleep 2
s_branch RT_clr
RT_clr_ok:
v_mov_b32 v32,0x5ca1ab1e
v_mov_b32 v33,s89
s_mov_b64 exec,1
buffer_store_dword v32,v33,s[24:27],0 offen sc1
s_mov_b64 exec,-1
RT_w:
s_barrier
s_mov_b32 s91,0x7ff00000
s_and_b32 s31,s30,3
s_lshr_b32 s43,s30,2
s_and_b32 s9,s2,7
s_lshr_b32 s10,s2,3
s_lshl_b32 s41,s9,3
s_lshr_b32 s42,s10,2
SADD s41,s41,s42
s_and_b32 s42,s10,3
s_and_b32 s5,s10,7
s_lshr_b32 s10,s10,3
s_lshl_b32 s4,s9,2
SADD s4,s4,s10
s_lshr_b32 s6,s5,1
s_lshr_b32 s9,s4,1
s_mul_i32 s9,s9,5
s_and_b32 s10,s4,1
s_lshl_b32 s10,s10,1
SADD s9,s9,s10
s_lshl_b32 s18,s9,9
s_mul_i32 s11,s31,163840
SADD s11,s11,s18
SADD s11,s11,2621440
s_mul_i32 s22,s31,6144
s_mul_i32 s23,s31,5632
s_mul_i32 s12,s31,165888
SADD s12,s12,5242880
SADD s23,s23,24576
s_mov_b32 s16,0
s_lshl_b32 s9,s6,2
s_lshl_b32 s92,15,s9
s_lshl_b32 s9,s92,16
s_or_b32 s92,s92,s9
v_lshrrev_b32 v9,4,v234
s_mul_i32 s9,s4,20
SADD s10,s9,19
s_lshr_b32 s9,s9,7
s_lshr_b32 s10,s10,7
v_lshrrev_b32 v10,4,v9
AND v11,15,v9
AND v12,1,v10
v_mov_b32 v13,s9
v_mov_b32 v14,s10
v_cmp_eq_u32 vcc,1,v12
s_nop 1
v_cndmask_b32 v13,v13,v14,vcc
v_lshrrev_b32 v12,1,v10
v_mul_u32_u24 v14,5,v12
v_add_u32 v14,v14,v13
SHL v14,7,v14
v_lshl_add_u32 v14,v11,2,v14
v_add_u32 v15,23461888,v14
v_add_u32 v14,10,v13
SHL v14,7,v14
v_lshl_add_u32 v14,v11,2,v14
v_add_u32 v16,23461888,v14
SHL v14,2,v11
v_add_u32 v14,23472128,v14
v_cmp_le_u32 vcc,2,v10
s_nop 1
v_cndmask_b32 v16,v16,v14,vcc
v_mov_b32 v235,v15
v_mov_b32 v236,v16
buffer_load_dword v237,v235,s[24:27],0 offen sc1
buffer_load_dword v232,v236,s[24:27],0 offen sc1
v_mov_b32 v204,v234
v_lshrrev_b32 v205,4,v234
v_add_u32 v40,0,v205
v_cmp_le_u32 vcc,96,v40
SHL v41,4,v40
v_add_u32 v42,39424,v41
v_cndmask_b32 v192,v41,v42,vcc
v_add_u32 v40,64,v205
v_cmp_le_u32 vcc,96,v40
SHL v41,4,v40
v_add_u32 v42,39424,v41
v_cndmask_b32 v193,v41,v42,vcc
v_add_u32 v40,128,v205
v_cmp_le_u32 vcc,96,v40
SHL v41,4,v40
v_add_u32 v42,39424,v41
v_cndmask_b32 v194,v41,v42,vcc
s_mul_i32 s9,s4,20
v_add_u32 v40,0,v205
v_mul_u32_u24 v41,745,v40
v_lshrrev_b32 v41,16,v41
v_mul_u32_u24 v42,88,v41
v_sub_u32 v40,v40,v42
v_mul_u32_u24 v41,41472,v41
v_mul_u32_u24 v42,2979,v40
v_lshrrev_b32 v42,16,v42
v_mul_u32_u24 v43,22,v42
v_sub_u32 v40,v40,v43
v_mul_u32_u24 v42,10368,v42
v_add_u32 v41,v41,v42
v_add_u32 v42,s9,v40
v_add_u32 v43,620,v40
v_cmp_gt_u32 vcc,20,v40
s_nop 1
v_cndmask_b32 v42,v43,v42,vcc
v_lshl_add_u32 v41,v42,4,v41
v_mov_b32 v195,v41
v_add_u32 v40,64,v205
v_mul_u32_u24 v41,745,v40
v_lshrrev_b32 v41,16,v41
v_mul_u32_u24 v42,88,v41
v_sub_u32 v40,v40,v42
v_mul_u32_u24 v41,41472,v41
v_mul_u32_u24 v42,2979,v40
v_lshrrev_b32 v42,16,v42
v_mul_u32_u24 v43,22,v42
v_sub_u32 v40,v40,v43
v_mul_u32_u24 v42,10368,v42
v_add_u32 v41,v41,v42
v_add_u32 v42,s9,v40
v_add_u32 v43,620,v40
v_cmp_gt_u32 vcc,20,v40
s_nop 1
v_cndmask_b32 v42,v43,v42,vcc
v_lshl_add_u32 v41,v42,4,v41
v_subrev_u32 v196,1024,v41
v_add_u32 v40,128,v205
v_mul_u32_u24 v41,745,v40
v_lshrrev_b32 v41,16,v41
v_mul_u32_u24 v42,88,v41
v_sub_u32 v40,v40,v42
v_mul_u32_u24 v41,41472,v41
v_mul_u32_u24 v42,2979,v40
v_lshrrev_b32 v42,16,v42
v_mul_u32_u24 v43,22,v42
v_sub_u32 v40,v40,v43
v_mul_u32_u24 v42,10368,v42
v_add_u32 v41,v41,v42
v_add_u32 v42,s9,v40
v_add_u32 v43,620,v40
v_cmp_gt_u32 vcc,20,v40
s_nop 1
v_cndmask_b32 v42,v43,v42,vcc
v_lshl_add_u32 v41,v42,4,v41
v_subrev_u32 v197,2048,v41
v_add_u32 v40,192,v205
v_mul_u32_u24 v41,745,v40
v_lshrrev_b32 v41,16,v41
v_mul_u32_u24 v42,88,v41
v_sub_u32 v40,v40,v42
v_mul_u32_u24 v41,41472,v41
v_mul_u32_u24 v42,2979,v40
v_lshrrev_b32 v42,16,v42
v_mul_u32_u24 v43,22,v42
v_sub_u32 v40,v40,v43
v_mul_u32_u24 v42,10368,v42
v_add_u32 v41,v41,v42
v_add_u32 v42,s9,v40
v_add_u32 v43,620,v40
v_cmp_gt_u32 vcc,20,v40
s_nop 1
v_cndmask_b32 v42,v43,v42,vcc
v_lshl_add_u32 v41,v42,4,v41
v_subrev_u32 v198,3072,v41
v_add_u32 v40,256,v205
v_mul_u32_u24 v41,745,v40
v_lshrrev_b32 v41,16,v41
v_mul_u32_u24 v42,88,v41
v_sub_u32 v40,v40,v42
v_mul_u32_u24 v41,41472,v41
v_mul_u32_u24 v42,2979,v40
v_lshrrev_b32 v42,16,v42
v_mul_u32_u24 v43,22,v42
v_sub_u32 v40,v40,v43
v_mul_u32_u24 v42,10368,v42
v_add_u32 v41,v41,v42
v_add_u32 v42,s9,v40
v_add_u32 v43,620,v40
v_cmp_gt_u32 vcc,20,v40
s_nop 1
v_cndmask_b32 v42,v43,v42,vcc
v_lshl_add_u32 v41,v42,4,v41
v_mov_b32 v199,v41
v_add_u32 v40,320,v205
v_mul_u32_u24 v41,745,v40
v_lshrrev_b32 v41,16,v41
v_mul_u32_u24 v42,88,v41
v_sub_u32 v40,v40,v42
v_mul_u32_u24 v41,41472,v41
v_mul_u32_u24 v42,2979,v40
v_lshrrev_b32 v42,16,v42
v_mul_u32_u24 v43,22,v42
v_sub_u32 v40,v40,v43
v_mul_u32_u24 v42,10368,v42
v_add_u32 v41,v41,v42
v_add_u32 v42,s9,v40
v_add_u32 v43,620,v40
v_cmp_gt_u32 vcc,20,v40
s_nop 1
v_cndmask_b32 v42,v43,v42,vcc
v_lshl_add_u32 v41,v42,4,v41
v_subrev_u32 v200,1024,v41
WT vmcnt(0)
s_mov_b64 s[94:95],0
v_cmp_ne_u32 vcc,0x5ca1ab1e,v237
s_nop 3
s_and_b32 vcc_lo,vcc_lo,s92
s_and_b32 vcc_hi,vcc_hi,s92
s_or_b64 s[94:95],s[94:95],vcc
v_cmp_ne_u32 vcc,0x5ca1ab1e,v232
s_nop 3
s_and_b32 vcc_lo,vcc_lo,s92
s_and_b32 vcc_hi,vcc_hi,0x0
s_or_b64 s[94:95],s[94:95],vcc
s_cmp_eq_u64 s[94:95],0
s_cbranch_scc1 T1_go12
s_mov_b32 s52,0
T1_spin12:
buffer_load_dword v20,v235,s[24:27],0 offen sc1
buffer_load_dword v21,v236,s[24:27],0 offen sc1
WT vmcnt(0)
s_mov_b64 s[94:95],0
v_cmp_ne_u32 vcc,0x5ca1ab1e,v20
s_nop 3
s_and_b32 vcc_lo,vcc_lo,s92
s_and_b32 vcc_hi,vcc_hi,s92
s_or_b64 s[94:95],s[94:95],vcc
v_cmp_ne_u32 vcc,0x5ca1ab1e,v21
s_nop 3
s_and_b32 vcc_lo,vcc_lo,s92
s_and_b32 vcc_hi,vcc_hi,0x0
s_or_b64 s[94:95],s[94:95],vcc
s_cmp_eq_u64 s[94:95],0
s_cbranch_scc1 T1_spin12_ok
SADD s52,s52,1
s_cmp_lt_u32 s52,200000
s_cbranch_scc0 T1_spin12_ok
s_sleep 2
s_branch T1_spin12
T1_spin12_ok:
T1_go12:
s_cmp_eq_u32 s43,1
s_cbranch_scc1 T1_h13
s_lshl_b32 s9,s31,1
s_lshl_b32 s10,s5,3
SADD s9,s9,s10
s_mul_i32 s7,s9,40960
SADD s7,s7,s18
s_and_b32 s10,s4,1
s_lshl_b32 s9,s10,9
SADD s8,s7,s9
s_cmp_eq_u32 s10,0
s_cselect_b32 s9,1024,8
SADD s7,s7,s9
AND v41,31,v205
SHL v42,4,v41
BL4 v[176:179],v204,s[24:27],s8 offen sc1
buffer_load_dwordx2 v[184:185],v42,s[24:27],s7 offen sc1
SADD s8,s8,40960
SADD s7,s7,40960
BL4 v[180:183],v204,s[24:27],s8 offen sc1
buffer_load_dwordx2 v[186:187],v42,s[24:27],s7 offen sc1
s_branch T1_j13
T1_h13:
s_mov_b32 s13,s6
s_mov_b32 s14,0
s_mov_b32 s15,4
s_mul_i32 s7,s13,655360
SADD s7,s7,s11
s_mul_i32 s33,s13,663552
SADD s33,s33,s12
s_cmp_eq_u32 s15,0
s_cselect_b32 s7,0x7ff00000,s7
s_cselect_b32 s33,0x7ff00000,s33
SADD s34,s7,81920
SADD s8,s14,s22
SADD s21,s14,s23
SADD s13,s13,1
s_and_b32 s13,s13,3
SADD s14,s14,47104
s_cmp_eq_u32 s14,141312
s_cselect_b32 s14,0,s14
s_cmp_lg_u32 s15,0
s_subb_u32 s15,s15,0
SADD m0,s8,0
s_nop 0
BL4 v192,s[24:27],s7 offen sc1 lds
SADD m0,s8,1024
s_nop 0
BL4 v193,s[24:27],s7 offen sc1 lds
SADD m0,s8,2048
s_nop 0
BL4 v194,s[24:27],s7 offen sc1 lds
SADD m0,s8,3072
s_nop 0
BL4 v192,s[24:27],s34 offen sc1 lds
SADD m0,s8,4096
s_nop 0
BL4 v193,s[24:27],s34 offen sc1 lds
SADD m0,s8,5120
s_nop 0
BL4 v194,s[24:27],s34 offen sc1 lds
s_mov_b32 m0,s21
s_nop 0
BL4 v195,s[24:27],s33 offen sc1 lds
s_mov_b32 m0,s21
s_nop 0
BL4 v196,s[24:27],s33 offen offset:1024 sc1 lds
s_mov_b32 m0,s21
s_nop 0
BL4 v197,s[24:27],s33 offen offset:2048 sc1 lds
s_mov_b32 m0,s21
s_nop 0
BL4 v198,s[24:27],s33 offen offset:3072 sc1 lds
SADD m0,s21,4096
s_nop 0
BL4 v199,s[24:27],s33 offen sc1 lds
SADD m0,s21,4096
s_mov_b32 exec_hi,0
BL4 v200,s[24:27],s33 offen offset:1024 sc1 lds
s_mov_b32 exec_hi,-1
T1_j13:
s_mov_b32 s89,0x7ff00000
BS4 v[0:3],v204,s[24:27],s89 offen sc1
BS4 v[0:3],v204,s[24:27],s89 offen sc1
s_branch T1_common
T1_common:
s_cmp_eq_u32 s43,1
s_cbranch_scc1 HELP
s_setprio 2
SHL v160,4,v205
s_and_b32 s10,s4,1
s_lshl_b32 s20,s10,9
v_add_u32 v152,s20,v160
v_lshrrev_b32 v161,5,v205
v_mul_u32_u24 v161,1536,v161
AND v162,31,v205
v_lshl_add_u32 v161,v162,4,v161
s_cmp_eq_u32 s10,0
s_cselect_b32 s20,1024,8
v_add_u32 v153,s20,v161
v_min_u32 v162,21,v162
SHL v162,4,v162
v_lshrrev_b32 v161,5,v205
v_mul_u32_u24 v161,352,v161
v_add_u32 v162,v162,v161
v_add_u32 v154,24576,v162
v_mov_b32 v80,0
v_mov_b32 v81,0
v_mov_b32 v82,0
v_mov_b32 v83,0
v_mov_b32 v84,0
v_mov_b32 v85,0
v_mov_b32 v86,0
v_mov_b32 v87,0
v_mov_b32 v88,0
v_mov_b32 v89,0
v_mov_b32 v90,0
v_mov_b32 v91,0
v_mov_b32 v92,0
v_mov_b32 v93,0
v_mov_b32 v94,0
v_mov_b32 v95,0
v_mov_b32 v96,0
v_mov_b32 v97,0
v_mov_b32 v98,0
v_mov_b32 v99,0
v_mov_b32 v100,0
v_mov_b32 v101,0
v_mov_b32 v102,0
v_mov_b32 v103,0
v_mov_b32 v104,0
v_mov_b32 v105,0
v_mov_b32 v106,0
v_mov_b32 v107,0
v_mov_b32 v108,0
v_mov_b32 v109,0
v_mov_b32 v110,0
v_mov_b32 v111,0
v_mov_b32 v132,0
v_mov_b32 v133,0
v_mov_b32 v134,0
v_mov_b32 v135,0
v_mov_b32 v200,0
v_mov_b32 v201,0
v_mov_b32 v202,0
v_mov_b32 v203,0
s_mov_b32 s32,0
s_mov_b32 s17,4
WT vmcnt(2)
v_mov_b32 v64,v176
v_mov_b32 v65,v177
v_mov_b32 v66,v178
v_mov_b32 v67,v179
v_mov_b32 v68,v180
v_mov_b32 v69,v181
v_mov_b32 v70,v182
v_mov_b32 v71,v183
v_mov_b32 v72,v184
v_mov_b32 v73,v185
v_mov_b32 v74,v186
v_mov_b32 v75,v187
v_mov_b32 v4,0
v_mov_b32 v5,0
DOT v4,v64,v64,v4
DOT v4,v65,v65,v4
DOT v4,v66,v66,v4
DOT v4,v67,v67,v4
DOT v5,v72,v72,v5
DOT v5,v73,v73,v5
s_nop 0
v_mov_b32 v8,v4
s_nop 1
v_permlane32_swap_b32 v8,v4
ADD v4,v4,v8
ADD v4,v4,v5
v_mov_b32 v6,0
v_mov_b32 v7,0
DOT v6,v68,v68,v6
DOT v6,v69,v69,v6
DOT v6,v70,v70,v6
DOT v6,v71,v71,v6
DOT v7,v74,v74,v7
DOT v7,v75,v75,v7
s_nop 0
v_mov_b32 v8,v6
s_nop 1
v_permlane32_swap_b32 v8,v6
ADD v6,v6,v8
ADD v6,v6,v7
v_max_f32 v164,v4,v6
s_nop 1
v_max_f32_dpp v164,v164,v164 row_shr:1 row_mask:0xf bank_mask:0xf bound_ctrl:0
s_nop 1
v_max_f32_dpp v164,v164,v164 row_shr:2 row_mask:0xf bank_mask:0xf bound_ctrl:0
s_nop 1
v_max_f32_dpp v164,v164,v164 row_shr:4 row_mask:0xf bank_mask:0xf bound_ctrl:0
s_nop 1
v_max_f32_dpp v164,v164,v164 row_shr:8 row_mask:0xf bank_mask:0xf bound_ctrl:0
s_nop 1
v_max_f32_dpp v164,v164,v164 row_bcast:15 row_mask:0xa bank_mask:0xf
s_nop 1
v_max_f32_dpp v164,v164,v164 row_bcast:31 row_mask:0xc bank_mask:0xf
s_nop 0
v_readlane_b32 s19,v164,63
s_lshl_b32 s10,s31,2
SADD s10,s10,141312
v_mov_b32 v160,s19
v_mov_b32 v161,s10
ds_write_b32 v161,v160
WT lgkmcnt(0)
s_barrier
R128 v[112:115],v152 offset:0
R128 v[116:119],v152 offset:1536
ds_read_b64 v[78:79],v153 offset:0
R128 v[136:139],v154 offset:0
R128 v[140:143],v154 offset:704
R128 v[144:147],v154 offset:1408
R128 v[148:151],v154 offset:2112
WT lgkmcnt(4)
M32 v[0:15],v[112:115],v[64:67],0
M32 v[16:31],v[116:119],v[64:67],0
s_nop 9
M2B v[0:31],v[78:79],v[72:73],v[0:31]
s_nop 15
s_nop 1
WT lgkmcnt(0)
.p2align 6
ATf_loop:
s_nop 0
EX v0,v0
EX v1,v1
M32 v[96:111],v[200:203],v[132:135],v[96:111]
R128 v[176:179],v152 offset:3072
EX v2,v2
EX v3,v3
EX v4,v4
EX v5,v5
M32 v[32:47],v[112:115],v[68:71],0
R128 v[180:183],v152 offset:4608
EX v6,v6
EX v7,v7
CV v120,v0,v1
CV v121,v2,v3
CV v122,v4,v5
CV v123,v6,v7
M32 v[48:63],v[116:119],v[68:71],0
ds_read_b64 v[184:185],v153 offset:3072
EX v8,v8
EX v9,v9
EX v10,v10
EX v11,v11
M32 v[80:95],v[136:139],v[120:123],v[80:95]
R128 v[188:191],v154 offset:2816
EX v12,v12
EX v13,v13
EX v14,v14
EX v15,v15
M2B v[32:63],v[78:79],v[74:75],v[32:63]
R128 v[192:195],v154 offset:3520
CV v124,v8,v9
CV v125,v10,v11
CV v126,v12,v13
CV v127,v14,v15
EX v16,v16
EX v17,v17
EX v18,v18
EX v19,v19
EX v20,v20
EX v21,v21
M32 v[80:95],v[140:143],v[124:127],v[80:95]
R128 v[196:199],v154 offset:4224
EX v22,v22
EX v23,v23
CV v128,v16,v17
CV v129,v18,v19
CV v130,v20,v21
CV v131,v22,v23
EX v24,v24
EX v25,v25
M32 v[80:95],v[144:147],v[128:131],v[80:95]
WT lgkmcnt(3)
EX v26,v26
EX v27,v27
EX v28,v28
EX v29,v29
EX v30,v30
EX v31,v31
CV v132,v24,v25
CV v133,v26,v27
CV v134,v28,v29
CV v135,v30,v31
EX v32,v32
EX v33,v33
M32 v[80:95],v[148:151],v[132:135],v[80:95]
R128 v[200:203],v154 offset:4928
EX v34,v34
EX v35,v35
EX v36,v36
EX v37,v37
M32 v[0:15],v[176:179],v[64:67],0
EX v38,v38
EX v39,v39
CV v120,v32,v33
CV v121,v34,v35
CV v122,v36,v37
CV v123,v38,v39
M32 v[16:31],v[180:183],v[64:67],0
EX v40,v40
EX v41,v41
EX v42,v42
EX v43,v43
M32 v[96:111],v[136:139],v[120:123],v[96:111]
EX v44,v44
EX v45,v45
EX v46,v46
EX v47,v47
s_nop 0
M2B v[0:31],v[184:185],v[72:73],v[0:31]
CV v124,v40,v41
CV v125,v42,v43
CV v126,v44,v45
CV v127,v46,v47
EX v48,v48
EX v49,v49
EX v50,v50
EX v51,v51
EX v52,v52
EX v53,v53
M32 v[96:111],v[140:143],v[124:127],v[96:111]
EX v54,v54
EX v55,v55
CV v128,v48,v49
CV v129,v50,v51
CV v130,v52,v53
CV v131,v54,v55
EX v56,v56
EX v57,v57
M32 v[96:111],v[144:147],v[128:131],v[96:111]
WT lgkmcnt(0)
EX v58,v58
EX v59,v59
EX v60,v60
EX v61,v61
EX v62,v62
EX v63,v63
CV v132,v56,v57
CV v133,v58,v59
CV v134,v60,v61
CV v135,v62,v63
EX v0,v0
EX v1,v1
M32 v[96:111],v[148:151],v[132:135],v[96:111]
R128 v[112:115],v152 offset:6144
EX v2,v2
EX v3,v3
EX v4,v4
EX v5,v5
M32 v[32:47],v[176:179],v[68:71],0
R128 v[116:119],v152 offset:7680
EX v6,v6
EX v7,v7
CV v120,v0,v1
CV v121,v2,v3
CV v122,v4,v5
CV v123,v6,v7
M32 v[48:63],v[180:183],v[68:71],0
ds_read_b64 v[78:79],v153 offset:6144
EX v8,v8
EX v9,v9
EX v10,v10
EX v11,v11
M32 v[80:95],v[188:191],v[120:123],v[80:95]
R128 v[136:139],v154 offset:5632
EX v12,v12
EX v13,v13
EX v14,v14
EX v15,v15
M2B v[32:63],v[184:185],v[74:75],v[32:63]
R128 v[140:143],v154 offset:6336
CV v124,v8,v9
CV v125,v10,v11
CV v126,v12,v13
CV v127,v14,v15
EX v16,v16
EX v17,v17
EX v18,v18
EX v19,v19
EX v20,v20
EX v21,v21
M32 v[80:95],v[192:195],v[124:127],v[80:95]
R128 v[144:147],v154 offset:7040
EX v22,v22
EX v23,v23
CV v128,v16,v17
CV v129,v18,v19
CV v130,v20,v21
CV v131,v22,v23
EX v24,v24
EX v25,v25
M32 v[80:95],v[196:199],v[128:131],v[80:95]
WT lgkmcnt(3)
EX v26,v26
EX v27,v27
EX v28,v28
EX v29,v29
EX v30,v30
EX v31,v31
CV v132,v24,v25
CV v133,v26,v27
CV v134,v28,v29
CV v135,v30,v31
EX v32,v32
EX v33,v33
M32 v[80:95],v[200:203],v[132:135],v[80:95]
R128 v[148:151],v154 offset:7744
EX v34,v34
EX v35,v35
EX v36,v36
EX v37,v37
M32 v[0:15],v[112:115],v[64:67],0
EX v38,v38
EX v39,v39
CV v120,v32,v33
CV v121,v34,v35
CV v122,v36,v37
CV v123,v38,v39
M32 v[16:31],v[116:119],v[64:67],0
EX v40,v40
EX v41,v41
EX v42,v42
EX v43,v43
M32 v[96:111],v[188:191],v[120:123],v[96:111]
EX v44,v44
EX v45,v45
EX v46,v46
EX v47,v47
s_nop 0
M2B v[0:31],v[78:79],v[72:73],v[0:31]
CV v124,v40,v41
CV v125,v42,v43
CV v126,v44,v45
CV v127,v46,v47
EX v48,v48
EX v49,v49
EX v50,v50
EX v51,v51
EX v52,v52
EX v53,v53
M32 v[96:111],v[192:195],v[124:127],v[96:111]
EX v54,v54
EX v55,v55
CV v128,v48,v49
CV v129,v50,v51
CV v130,v52,v53
CV v131,v54,v55
EX v56,v56
EX v57,v57
M32 v[96:111],v[196:199],v[128:131],v[96:111]
WT lgkmcnt(0)
EX v58,v58
EX v59,v59
EX v60,v60
EX v61,v61
EX v62,v62
EX v63,v63
CV v132,v56,v57
CV v133,v58,v59
CV v134,v60,v61
CV v135,v62,v63
WT vmcnt(0)
v_mov_b32 v172,0x5ca1ab1e
v_mov_b32 v173,s91
s_mov_b64 exec,1
buffer_store_dword v172,v173,s[24:27],0 offen sc1
s_mov_b64 exec,-1
EX v0,v0
EX v1,v1
s_nop 1
M32 v[96:111],v[200:203],v[132:135],v[96:111]
R128 v[176:179],v152 offset:9216
EX v2,v2
EX v3,v3
EX v4,v4
EX v5,v5
M32 v[32:47],v[112:115],v[68:71],0
R128 v[180:183],v152 offset:10752
EX v6,v6
EX v7,v7
CV v120,v0,v1
CV v121,v2,v3
CV v122,v4,v5
CV v123,v6,v7
M32 v[48:63],v[116:119],v[68:71],0
ds_read_b64 v[184:185],v153 offset:9216
EX v8,v8
EX v9,v9
EX v10,v10
EX v11,v11
M32 v[80:95],v[136:139],v[120:123],v[80:95]
R128 v[188:191],v154 offset:8448
EX v12,v12
EX v13,v13
EX v14,v14
EX v15,v15
M2B v[32:63],v[78:79],v[74:75],v[32:63]
R128 v[192:195],v154 offset:9152
CV v124,v8,v9
CV v125,v10,v11
CV v126,v12,v13
CV v127,v14,v15
EX v16,v16
EX v17,v17
EX v18,v18
EX v19,v19
EX v20,v20
EX v21,v21
M32 v[80:95],v[140:143],v[124:127],v[80:95]
R128 v[196:199],v154 offset:9856
EX v22,v22
EX v23,v23
CV v128,v16,v17
CV v129,v18,v19
CV v130,v20,v21
CV v131,v22,v23
EX v24,v24
EX v25,v25
M32 v[80:95],v[144:147],v[128:131],v[80:95]
WT lgkmcnt(3)
EX v26,v26
EX v27,v27
EX v28,v28
EX v29,v29
EX v30,v30
EX v31,v31
CV v132,v24,v25
CV v133,v26,v27
CV v134,v28,v29
CV v135,v30,v31
EX v32,v32
EX v33,v33
M32 v[80:95],v[148:151],v[132:135],v[80:95]
R128 v[200:203],v154 offset:10560
EX v34,v34
EX v35,v35
EX v36,v36
EX v37,v37
M32 v[0:15],v[176:179],v[64:67],0
EX v38,v38
EX v39,v39
CV v120,v32,v33
CV v121,v34,v35
CV v122,v36,v37
CV v123,v38,v39
M32 v[16:31],v[180:183],v[64:67],0
EX v40,v40
EX v41,v41
EX v42,v42
EX v43,v43
M32 v[96:111],v[136:139],v[120:123],v[96:111]
EX v44,v44
EX v45,v45
EX v46,v46
EX v47,v47
s_nop 0
M2B v[0:31],v[184:185],v[72:73],v[0:31]
CV v124,v40,v41
CV v125,v42,v43
CV v126,v44,v45
CV v127,v46,v47
EX v48,v48
EX v49,v49
EX v50,v50
EX v51,v51
EX v52,v52
EX v53,v53
M32 v[96:111],v[140:143],v[124:127],v[96:111]
EX v54,v54
EX v55,v55
CV v128,v48,v49
CV v129,v50,v51
CV v130,v52,v53
CV v131,v54,v55
EX v56,v56
EX v57,v57
M32 v[96:111],v[144:147],v[128:131],v[96:111]
WT lgkmcnt(0)
EX v58,v58
EX v59,v59
EX v60,v60
EX v61,v61
EX v62,v62
EX v63,v63
CV v132,v56,v57
CV v133,v58,v59
CV v134,v60,v61
CV v135,v62,v63
EX v0,v0
EX v1,v1
M32 v[96:111],v[148:151],v[132:135],v[96:111]
R128 v[112:115],v152 offset:12288
EX v2,v2
EX v3,v3
EX v4,v4
EX v5,v5
M32 v[32:47],v[176:179],v[68:71],0
R128 v[116:119],v152 offset:13824
EX v6,v6
EX v7,v7
CV v120,v0,v1
CV v121,v2,v3
CV v122,v4,v5
CV v123,v6,v7
M32 v[48:63],v[180:183],v[68:71],0
ds_read_b64 v[78:79],v153 offset:12288
EX v8,v8
EX v9,v9
EX v10,v10
EX v11,v11
M32 v[80:95],v[188:191],v[120:123],v[80:95]
R128 v[136:139],v154 offset:11264
EX v12,v12
EX v13,v13
EX v14,v14
EX v15,v15
M2B v[32:63],v[184:185],v[74:75],v[32:63]
R128 v[140:143],v154 offset:11968
CV v124,v8,v9
CV v125,v10,v11
CV v126,v12,v13
CV v127,v14,v15
EX v16,v16
EX v17,v17
EX v18,v18
EX v19,v19
EX v20,v20
EX v21,v21
M32 v[80:95],v[192:195],v[124:127],v[80:95]
R128 v[144:147],v154 offset:12672
EX v22,v22
EX v23,v23
CV v128,v16,v17
CV v129,v18,v19
CV v130,v20,v21
CV v131,v22,v23
EX v24,v24
EX v25,v25
M32 v[80:95],v[196:199],v[128:131],v[80:95]
WT lgkmcnt(3)
EX v26,v26
EX v27,v27
EX v28,v28
EX v29,v29
EX v30,v30
EX v31,v31
CV v132,v24,v25
CV v133,v26,v27
CV v134,v28,v29
CV v135,v30,v31
EX v32,v32
EX v33,v33
M32 v[80:95],v[200:203],v[132:135],v[80:95]
R128 v[148:151],v154 offset:13376
EX v34,v34
EX v35,v35
EX v36,v36
EX v37,v37
M32 v[0:15],v[112:115],v[64:67],0
EX v38,v38
EX v39,v39
CV v120,v32,v33
CV v121,v34,v35
CV v122,v36,v37
CV v123,v38,v39
M32 v[16:31],v[116:119],v[64:67],0
EX v40,v40
EX v41,v41
EX v42,v42
EX v43,v43
M32 v[96:111],v[188:191],v[120:123],v[96:111]
EX v44,v44
EX v45,v45
EX v46,v46
EX v47,v47
s_nop 0
M2B v[0:31],v[78:79],v[72:73],v[0:31]
CV v124,v40,v41
CV v125,v42,v43
CV v126,v44,v45
CV v127,v46,v47
EX v48,v48
EX v49,v49
EX v50,v50
EX v51,v51
EX v52,v52
EX v53,v53
M32 v[96:111],v[192:195],v[124:127],v[96:111]
EX v54,v54
EX v55,v55
CV v128,v48,v49
CV v129,v50,v51
CV v130,v52,v53
CV v131,v54,v55
EX v56,v56
EX v57,v57
M32 v[96:111],v[196:199],v[128:131],v[96:111]
WT lgkmcnt(0)
EX v58,v58
EX v59,v59
EX v60,v60
EX v61,v61
EX v62,v62
EX v63,v63
CV v132,v56,v57
CV v133,v58,v59
CV v134,v60,v61
CV v135,v62,v63
EX v0,v0
EX v1,v1
M32 v[96:111],v[200:203],v[132:135],v[96:111]
R128 v[176:179],v152 offset:15360
EX v2,v2
EX v3,v3
EX v4,v4
EX v5,v5
M32 v[32:47],v[112:115],v[68:71],0
R128 v[180:183],v152 offset:16896
EX v6,v6
EX v7,v7
CV v120,v0,v1
CV v121,v2,v3
CV v122,v4,v5
CV v123,v6,v7
M32 v[48:63],v[116:119],v[68:71],0
ds_read_b64 v[184:185],v153 offset:15360
EX v8,v8
EX v9,v9
EX v10,v10
EX v11,v11
M32 v[80:95],v[136:139],v[120:123],v[80:95]
R128 v[188:191],v154 offset:14080
EX v12,v12
EX v13,v13
EX v14,v14
EX v15,v15
M2B v[32:63],v[78:79],v[74:75],v[32:63]
R128 v[192:195],v154 offset:14784
CV v124,v8,v9
CV v125,v10,v11
CV v126,v12,v13
CV v127,v14,v15
EX v16,v16
EX v17,v17
EX v18,v18
EX v19,v19
EX v20,v20
EX v21,v21
M32 v[80:95],v[140:143],v[124:127],v[80:95]
R128 v[196:199],v154 offset:15488
EX v22,v22
EX v23,v23
CV v128,v16,v17
CV v129,v18,v19
CV v130,v20,v21
CV v131,v22,v23
EX v24,v24
EX v25,v25
M32 v[80:95],v[144:147],v[128:131],v[80:95]
WT lgkmcnt(3)
EX v26,v26
EX v27,v27
EX v28,v28
EX v29,v29
EX v30,v30
EX v31,v31
CV v132,v24,v25
CV v133,v26,v27
CV v134,v28,v29
CV v135,v30,v31
EX v32,v32
EX v33,v33
M32 v[80:95],v[148:151],v[132:135],v[80:95]
R128 v[200:203],v154 offset:16192
EX v34,v34
EX v35,v35
EX v36,v36
EX v37,v37
M32 v[0:15],v[176:179],v[64:67],0
EX v38,v38
EX v39,v39
CV v120,v32,v33
CV v121,v34,v35
CV v122,v36,v37
CV v123,v38,v39
M32 v[16:31],v[180:183],v[64:67],0
EX v40,v40
EX v41,v41
EX v42,v42
EX v43,v43
M32 v[96:111],v[136:139],v[120:123],v[96:111]
EX v44,v44
EX v45,v45
EX v46,v46
EX v47,v47
s_nop 0
M2B v[0:31],v[184:185],v[72:73],v[0:31]
CV v124,v40,v41
CV v125,v42,v43
CV v126,v44,v45
CV v127,v46,v47
EX v48,v48
EX v49,v49
EX v50,v50
EX v51,v51
EX v52,v52
EX v53,v53
M32 v[96:111],v[140:143],v[124:127],v[96:111]
EX v54,v54
EX v55,v55
CV v128,v48,v49
CV v129,v50,v51
CV v130,v52,v53
CV v131,v54,v55
EX v56,v56
EX v57,v57
M32 v[96:111],v[144:147],v[128:131],v[96:111]
WT lgkmcnt(0)
EX v58,v58
EX v59,v59
EX v60,v60
EX v61,v61
EX v62,v62
EX v63,v63
CV v132,v56,v57
CV v133,v58,v59
CV v134,v60,v61
CV v135,v62,v63
EX v0,v0
EX v1,v1
M32 v[96:111],v[148:151],v[132:135],v[96:111]
R128 v[112:115],v152 offset:18432
EX v2,v2
EX v3,v3
EX v4,v4
EX v5,v5
M32 v[32:47],v[176:179],v[68:71],0
R128 v[116:119],v152 offset:19968
EX v6,v6
EX v7,v7
CV v120,v0,v1
CV v121,v2,v3
CV v122,v4,v5
CV v123,v6,v7
M32 v[48:63],v[180:183],v[68:71],0
ds_read_b64 v[78:79],v153 offset:18432
EX v8,v8
EX v9,v9
EX v10,v10
EX v11,v11
M32 v[80:95],v[188:191],v[120:123],v[80:95]
R128 v[136:139],v154 offset:16896
EX v12,v12
EX v13,v13
EX v14,v14
EX v15,v15
M2B v[32:63],v[184:185],v[74:75],v[32:63]
R128 v[140:143],v154 offset:17600
CV v124,v8,v9
CV v125,v10,v11
CV v126,v12,v13
CV v127,v14,v15
EX v16,v16
EX v17,v17
EX v18,v18
EX v19,v19
EX v20,v20
EX v21,v21
M32 v[80:95],v[192:195],v[124:127],v[80:95]
R128 v[144:147],v154 offset:18304
EX v22,v22
EX v23,v23
CV v128,v16,v17
CV v129,v18,v19
CV v130,v20,v21
CV v131,v22,v23
EX v24,v24
EX v25,v25
M32 v[80:95],v[196:199],v[128:131],v[80:95]
WT lgkmcnt(3)
EX v26,v26
EX v27,v27
EX v28,v28
EX v29,v29
EX v30,v30
EX v31,v31
CV v132,v24,v25
CV v133,v26,v27
CV v134,v28,v29
CV v135,v30,v31
EX v32,v32
EX v33,v33
M32 v[80:95],v[200:203],v[132:135],v[80:95]
R128 v[148:151],v154 offset:19008
EX v34,v34
EX v35,v35
EX v36,v36
EX v37,v37
M32 v[0:15],v[112:115],v[64:67],0
EX v38,v38
EX v39,v39
CV v120,v32,v33
CV v121,v34,v35
CV v122,v36,v37
CV v123,v38,v39
M32 v[16:31],v[116:119],v[64:67],0
EX v40,v40
EX v41,v41
EX v42,v42
EX v43,v43
M32 v[96:111],v[188:191],v[120:123],v[96:111]
EX v44,v44
EX v45,v45
EX v46,v46
EX v47,v47
s_nop 0
M2B v[0:31],v[78:79],v[72:73],v[0:31]
CV v124,v40,v41
CV v125,v42,v43
CV v126,v44,v45
CV v127,v46,v47
EX v48,v48
EX v49,v49
EX v50,v50
EX v51,v51
EX v52,v52
EX v53,v53
M32 v[96:111],v[192:195],v[124:127],v[96:111]
EX v54,v54
EX v55,v55
CV v128,v48,v49
CV v129,v50,v51
CV v130,v52,v53
CV v131,v54,v55
EX v56,v56
EX v57,v57
M32 v[96:111],v[196:199],v[128:131],v[96:111]
WT lgkmcnt(0)
EX v58,v58
EX v59,v59
EX v60,v60
EX v61,v61
EX v62,v62
EX v63,v63
CV v132,v56,v57
CV v133,v58,v59
CV v134,v60,v61
CV v135,v62,v63
EX v0,v0
EX v1,v1
M32 v[96:111],v[200:203],v[132:135],v[96:111]
R128 v[176:179],v152 offset:21504
EX v2,v2
EX v3,v3
EX v4,v4
EX v5,v5
M32 v[32:47],v[112:115],v[68:71],0
R128 v[180:183],v152 offset:23040
EX v6,v6
EX v7,v7
CV v120,v0,v1
CV v121,v2,v3
CV v122,v4,v5
CV v123,v6,v7
M32 v[48:63],v[116:119],v[68:71],0
ds_read_b64 v[184:185],v153 offset:21504
EX v8,v8
EX v9,v9
EX v10,v10
EX v11,v11
M32 v[80:95],v[136:139],v[120:123],v[80:95]
R128 v[188:191],v154 offset:19712
EX v12,v12
EX v13,v13
EX v14,v14
EX v15,v15
M2B v[32:63],v[78:79],v[74:75],v[32:63]
R128 v[192:195],v154 offset:20416
CV v124,v8,v9
CV v125,v10,v11
CV v126,v12,v13
CV v127,v14,v15
EX v16,v16
EX v17,v17
EX v18,v18
EX v19,v19
EX v20,v20
EX v21,v21
M32 v[80:95],v[140:143],v[124:127],v[80:95]
R128 v[196:199],v154 offset:21120
EX v22,v22
EX v23,v23
CV v128,v16,v17
CV v129,v18,v19
CV v130,v20,v21
CV v131,v22,v23
EX v24,v24
EX v25,v25
M32 v[80:95],v[144:147],v[128:131],v[80:95]
WT lgkmcnt(3)
EX v26,v26
EX v27,v27
EX v28,v28
EX v29,v29
EX v30,v30
EX v31,v31
CV v132,v24,v25
CV v133,v26,v27
CV v134,v28,v29
CV v135,v30,v31
EX v32,v32
EX v33,v33
M32 v[80:95],v[148:151],v[132:135],v[80:95]
R128 v[200:203],v154 offset:21824
EX v34,v34
EX v35,v35
EX v36,v36
EX v37,v37
M32 v[0:15],v[176:179],v[64:67],0
EX v38,v38
EX v39,v39
CV v120,v32,v33
CV v121,v34,v35
CV v122,v36,v37
CV v123,v38,v39
M32 v[16:31],v[180:183],v[64:67],0
EX v40,v40
EX v41,v41
EX v42,v42
EX v43,v43
M32 v[96:111],v[136:139],v[120:123],v[96:111]
EX v44,v44
EX v45,v45
EX v46,v46
EX v47,v47
s_nop 0
M2B v[0:31],v[184:185],v[72:73],v[0:31]
CV v124,v40,v41
CV v125,v42,v43
CV v126,v44,v45
CV v127,v46,v47
EX v48,v48
EX v49,v49
EX v50,v50
EX v51,v51
EX v52,v52
EX v53,v53
M32 v[96:111],v[140:143],v[124:127],v[96:111]
EX v54,v54
EX v55,v55
CV v128,v48,v49
CV v129,v50,v51
CV v130,v52,v53
CV v131,v54,v55
EX v56,v56
EX v57,v57
M32 v[96:111],v[144:147],v[128:131],v[96:111]
WT lgkmcnt(0)
EX v58,v58
EX v59,v59
EX v60,v60
EX v61,v61
EX v62,v62
EX v63,v63
CV v132,v56,v57
CV v133,v58,v59
CV v134,v60,v61
CV v135,v62,v63
s_barrier
SADD s9,s32,47104
s_cmp_eq_u32 s9,141312
s_cselect_b32 s9,0,s9
s_sub_u32 s20,s9,s32
s_mov_b32 s32,s9
v_add_u32 v152,s20,v152
v_add_u32 v153,s20,v153
v_add_u32 v154,s20,v154
s_cmp_lg_u32 s17,4
s_cbranch_scc1 ATf_nodec
v_mov_b32 v161,141328
ds_read_b32 v160,v161
WT lgkmcnt(0)
v_readfirstlane_b32 s9,v160
s_nop 3
s_cmp_eq_u32 s9,0
s_cbranch_scc0 AT_slow
ATf_nodec:
EX v0,v0
EX v1,v1
M32 v[96:111],v[148:151],v[132:135],v[96:111]
R128 v[112:115],v152 offset:0
EX v2,v2
EX v3,v3
EX v4,v4
EX v5,v5
M32 v[32:47],v[176:179],v[68:71],0
R128 v[116:119],v152 offset:1536
EX v6,v6
EX v7,v7
CV v120,v0,v1
CV v121,v2,v3
CV v122,v4,v5
CV v123,v6,v7
M32 v[48:63],v[180:183],v[68:71],0
ds_read_b64 v[78:79],v153 offset:0
EX v8,v8
EX v9,v9
EX v10,v10
EX v11,v11
M32 v[80:95],v[188:191],v[120:123],v[80:95]
R128 v[136:139],v154 offset:0
EX v12,v12
EX v13,v13
EX v14,v14
EX v15,v15
M2B v[32:63],v[184:185],v[74:75],v[32:63]
R128 v[140:143],v154 offset:704
CV v124,v8,v9
CV v125,v10,v11
CV v126,v12,v13
CV v127,v14,v15
EX v16,v16
EX v17,v17
EX v18,v18
EX v19,v19
EX v20,v20
EX v21,v21
M32 v[80:95],v[192:195],v[124:127],v[80:95]
R128 v[144:147],v154 offset:1408
EX v22,v22
EX v23,v23
CV v128,v16,v17
CV v129,v18,v19
CV v130,v20,v21
CV v131,v22,v23
EX v24,v24
EX v25,v25
M32 v[80:95],v[196:199],v[128:131],v[80:95]
WT lgkmcnt(3)
EX v26,v26
EX v27,v27
EX v28,v28
EX v29,v29
EX v30,v30
EX v31,v31
CV v132,v24,v25
CV v133,v26,v27
CV v134,v28,v29
CV v135,v30,v31
EX v32,v32
EX v33,v33
M32 v[80:95],v[200:203],v[132:135],v[80:95]
R128 v[148:151],v154 offset:2112
EX v34,v34
EX v35,v35
EX v36,v36
EX v37,v37
M32 v[0:15],v[112:115],v[64:67],0
EX v38,v38
EX v39,v39
CV v120,v32,v33
CV v121,v34,v35
CV v122,v36,v37
CV v123,v38,v39
M32 v[16:31],v[116:119],v[64:67],0
EX v40,v40
EX v41,v41
EX v42,v42
EX v43,v43
M32 v[96:111],v[188:191],v[120:123],v[96:111]
EX v44,v44
EX v45,v45
EX v46,v46
EX v47,v47
s_nop 0
M2B v[0:31],v[78:79],v[72:73],v[0:31]
CV v124,v40,v41
CV v125,v42,v43
CV v126,v44,v45
CV v127,v46,v47
EX v48,v48
EX v49,v49
EX v50,v50
EX v51,v51
EX v52,v52
EX v53,v53
M32 v[96:111],v[192:195],v[124:127],v[96:111]
EX v54,v54
EX v55,v55
CV v128,v48,v49
CV v129,v50,v51
CV v130,v52,v53
CV v131,v54,v55
EX v56,v56
EX v57,v57
M32 v[96:111],v[196:199],v[128:131],v[96:111]
WT lgkmcnt(0)
EX v58,v58
EX v59,v59
EX v60,v60
EX v61,v61
EX v62,v62
EX v63,v63
CV v132,v56,v57
CV v133,v58,v59
CV v134,v60,v61
CV v135,v62,v63
s_sub_u32 s17,s17,1
s_cmp_lg_u32 s17,0
s_cbranch_scc1 ATf_loop
s_nop 1
M32 v[96:111],v[200:203],v[132:135],v[96:111]
s_nop 11
ADD v164,|v80|,|v96|
ADD v165,|v81|,|v97|
ADD v164,v164,v165
ADD v165,|v82|,|v98|
ADD v164,v164,v165
ADD v165,|v83|,|v99|
ADD v164,v164,v165
ADD v165,|v84|,|v100|
ADD v164,v164,v165
ADD v165,|v85|,|v101|
ADD v164,v164,v165
ADD v165,|v86|,|v102|
ADD v164,v164,v165
ADD v165,|v87|,|v103|
ADD v164,v164,v165
ADD v165,|v88|,|v104|
ADD v164,v164,v165
ADD v165,|v89|,|v105|
ADD v164,v164,v165
ADD v165,|v90|,|v106|
ADD v164,v164,v165
ADD v165,|v91|,|v107|
ADD v164,v164,v165
v_mov_b32 v165,0x7b800000
v_cmp_nle_f32 vcc,v164,v165
s_nop 3
s_cmp_lg_u64 vcc,0
s_cselect_b32 s19,1,0
AT_fin:
s_lshl_b32 s10,s31,2
SADD s10,s10,141344
v_mov_b32 v162,s19
v_mov_b32 v161,s10
ds_write_b32 v161,v162
s_lshl_b32 s20,s31,1
s_lshl_b32 s10,s5,3
SADD s20,s20,s10
s_mul_i32 s9,s20,40960
SADD s9,s9,15204352
SADD s9,s9,s18
AND v163,31,v205
SHL v163,4,v163
v_mov_b32 v160,v88
v_mov_b32 v161,v88
s_nop 1
v_permlane32_swap_b32 v160,v161
RCP v161,v161
s_nop 0
MUL v80,v80,v161
MUL v81,v81,v161
MUL v82,v82,v161
MUL v83,v83,v161
MUL v84,v84,v161
MUL v85,v85,v161
MUL v86,v86,v161
MUL v87,v87,v161
MUL v88,v88,v161
MUL v89,v89,v161
MUL v90,v90,v161
MUL v91,v91,v161
CV v80,v80,v81
CV v81,v82,v83
CV v82,v84,v85
CV v83,v86,v87
CV v84,v88,v89
CV v85,v90,v91
v_mov_b32 v160,v104
v_mov_b32 v161,v104
s_nop 1
v_permlane32_swap_b32 v160,v161
RCP v161,v161
s_nop 0
MUL v96,v96,v161
MUL v97,v97,v161
MUL v98,v98,v161
MUL v99,v99,v161
MUL v100,v100,v161
MUL v101,v101,v161
MUL v102,v102,v161
MUL v103,v103,v161
MUL v104,v104,v161
MUL v105,v105,v161
MUL v106,v106,v161
MUL v107,v107,v161
CV v96,v96,v97
CV v97,v98,v99
CV v98,v100,v101
CV v99,v102,v103
CV v100,v104,v105
CV v101,v106,v107
s_bitcmp1_b32 s4,0
s_cbranch_scc1 AT_odd
v_permlane32_swap_b32 v80,v82
v_permlane32_swap_b32 v81,v83
BS4 v[80:83],v204,s[24:27],s9 offen sc1
s_mov_b32 exec_hi,0
buffer_store_dwordx2 v[84:85],v163,s[24:27],s9 offen offset:1024 sc1
s_mov_b32 exec_hi,-1
SADD s9,s9,40960
v_permlane32_swap_b32 v96,v98
v_permlane32_swap_b32 v97,v99
BS4 v[96:99],v204,s[24:27],s9 offen sc1
s_mov_b32 exec_hi,0
buffer_store_dwordx2 v[100:101],v163,s[24:27],s9 offen offset:1024 sc1
s_mov_b32 exec_hi,-1
s_branch AT_stored
AT_odd:
v_cmp_gt_u32 vcc,32,v205
v_permlane32_swap_b32 v82,v84
v_permlane32_swap_b32 v83,v85
s_nop 0
v_permlane32_swap_b32 v80,v84
v_permlane32_swap_b32 v81,v85
v_cndmask_b32 v88,v80,v84,vcc
v_cndmask_b32 v89,v81,v85,vcc
v_mov_b32 v90,v82
v_mov_b32 v91,v83
BS4 v[88:91],v204,s[24:27],s9 offen offset:512 sc1
s_mov_b32 exec_hi,0
buffer_store_dwordx2 v[80:81],v163,s[24:27],s9 offen offset:8 sc1
s_mov_b32 exec_hi,-1
SADD s9,s9,40960
v_permlane32_swap_b32 v98,v100
v_permlane32_swap_b32 v99,v101
s_nop 0
v_permlane32_swap_b32 v96,v100
v_permlane32_swap_b32 v97,v101
v_cndmask_b32 v104,v96,v100,vcc
v_cndmask_b32 v105,v97,v101,vcc
v_mov_b32 v106,v98
v_mov_b32 v107,v99
BS4 v[104:107],v204,s[24:27],s9 offen offset:512 sc1
s_mov_b32 exec_hi,0
buffer_store_dwordx2 v[96:97],v163,s[24:27],s9 offen offset:8 sc1
s_mov_b32 exec_hi,-1
AT_stored:
s_lshl_b32 s46,s5,9
s_lshl_b32 s47,s31,7
SADD s46,s46,s47
s_lshl_b32 s47,s4,2
SADD s46,s46,s47
SADD s46,s46,23472640
s_cmp_eq_u32 s19,0
s_cselect_b32 s46,s46,0x7ff00000
v_mov_b32 v160,0x5ca1ab1e
v_mov_b32 v161,s46
WT vmcnt(0)
s_mov_b64 exec,1
buffer_store_dword v160,v161,s[24:27],0 offen sc1
s_mov_b64 exec,-1
WT lgkmcnt(0)
s_barrier
v_mov_b32 v161,141344
R128 v[120:123],v161
WT lgkmcnt(0)
v_or_b32 v120,v120,v121
v_or_b32 v120,v120,v122
v_or_b32 v120,v120,v123
s_nop 0
v_readfirstlane_b32 s9,v120
s_nop 3
s_cmp_eq_u32 s9,0
s_cbranch_scc0 AT_slow
s_cmp_lg_u32 s31,0
s_cbranch_scc1 K2_exit
s_mov_b64 exec,1
s_endpgm
AT_slow:
WT vmcnt(0) lgkmcnt(0)
v_mov_b32 v172,0x5ca1ab1e
v_mov_b32 v173,s91
s_mov_b64 exec,1
buffer_store_dword v172,v173,s[24:27],0 offen sc1
s_mov_b64 exec,-1
s_mov_b32 s52,0
ATs_full:
buffer_load_dword v172,v235,s[24:27],0 offen sc1
buffer_load_dword v173,v236,s[24:27],0 offen sc1
WT vmcnt(0)
s_mov_b64 s[94:95],0
v_cmp_ne_u32 vcc,0x5ca1ab1e,v172
s_nop 3
s_and_b32 vcc_lo,vcc_lo,0xffffffff
s_and_b32 vcc_hi,vcc_hi,0xffffffff
s_or_b64 s[94:95],s[94:95],vcc
v_cmp_ne_u32 vcc,0x5ca1ab1e,v173
s_nop 3
s_and_b32 vcc_lo,vcc_lo,0xffffffff
s_and_b32 vcc_hi,vcc_hi,0xffff
s_or_b64 s[94:95],s[94:95],vcc
s_cmp_eq_u64 s[94:95],0
s_cbranch_scc1 ATs_full_ok
SADD s52,s52,1
s_cmp_lt_u32 s52,200000
s_cbranch_scc0 ATs_full_ok
s_sleep 2
s_branch ATs_full
ATs_full_ok:
s_barrier
s_mov_b32 s16,1
v_add_u32 v160,0,v205
v_cmp_le_u32 vcc,96,v160
SHL v161,4,v160
v_add_u32 v162,39424,v161
v_cndmask_b32 v208,v161,v162,vcc
v_add_u32 v160,64,v205
v_cmp_le_u32 vcc,96,v160
SHL v161,4,v160
v_add_u32 v162,39424,v161
v_cndmask_b32 v209,v161,v162,vcc
v_add_u32 v160,128,v205
v_cmp_le_u32 vcc,96,v160
SHL v161,4,v160
v_add_u32 v162,39424,v161
v_cndmask_b32 v210,v161,v162,vcc
s_mul_i32 s9,s4,20
v_add_u32 v160,0,v205
v_mul_u32_u24 v161,745,v160
v_lshrrev_b32 v161,16,v161
v_mul_u32_u24 v162,88,v161
v_sub_u32 v160,v160,v162
v_mul_u32_u24 v161,41472,v161
v_mul_u32_u24 v162,2979,v160
v_lshrrev_b32 v162,16,v162
v_mul_u32_u24 v163,22,v162
v_sub_u32 v160,v160,v163
v_mul_u32_u24 v162,10368,v162
v_add_u32 v161,v161,v162
v_add_u32 v162,s9,v160
v_add_u32 v163,620,v160
v_cmp_gt_u32 vcc,20,v160
s_nop 1
v_cndmask_b32 v162,v163,v162,vcc
v_lshl_add_u32 v161,v162,4,v161
v_mov_b32 v211,v161
v_add_u32 v160,64,v205
v_mul_u32_u24 v161,745,v160
v_lshrrev_b32 v161,16,v161
v_mul_u32_u24 v162,88,v161
v_sub_u32 v160,v160,v162
v_mul_u32_u24 v161,41472,v161
v_mul_u32_u24 v162,2979,v160
v_lshrrev_b32 v162,16,v162
v_mul_u32_u24 v163,22,v162
v_sub_u32 v160,v160,v163
v_mul_u32_u24 v162,10368,v162
v_add_u32 v161,v161,v162
v_add_u32 v162,s9,v160
v_add_u32 v163,620,v160
v_cmp_gt_u32 vcc,20,v160
s_nop 1
v_cndmask_b32 v162,v163,v162,vcc
v_lshl_add_u32 v161,v162,4,v161
v_subrev_u32 v212,1024,v161
v_add_u32 v160,128,v205
v_mul_u32_u24 v161,745,v160
v_lshrrev_b32 v161,16,v161
v_mul_u32_u24 v162,88,v161
v_sub_u32 v160,v160,v162
v_mul_u32_u24 v161,41472,v161
v_mul_u32_u24 v162,2979,v160
v_lshrrev_b32 v162,16,v162
v_mul_u32_u24 v163,22,v162
v_sub_u32 v160,v160,v163
v_mul_u32_u24 v162,10368,v162
v_add_u32 v161,v161,v162
v_add_u32 v162,s9,v160
v_add_u32 v163,620,v160
v_cmp_gt_u32 vcc,20,v160
s_nop 1
v_cndmask_b32 v162,v163,v162,vcc
v_lshl_add_u32 v161,v162,4,v161
v_subrev_u32 v213,2048,v161
v_add_u32 v160,192,v205
v_mul_u32_u24 v161,745,v160
v_lshrrev_b32 v161,16,v161
v_mul_u32_u24 v162,88,v161
v_sub_u32 v160,v160,v162
v_mul_u32_u24 v161,41472,v161
v_mul_u32_u24 v162,2979,v160
v_lshrrev_b32 v162,16,v162
v_mul_u32_u24 v163,22,v162
v_sub_u32 v160,v160,v163
v_mul_u32_u24 v162,10368,v162
v_add_u32 v161,v161,v162
v_add_u32 v162,s9,v160
v_add_u32 v163,620,v160
v_cmp_gt_u32 vcc,20,v160
s_nop 1
v_cndmask_b32 v162,v163,v162,vcc
v_lshl_add_u32 v161,v162,4,v161
v_subrev_u32 v214,3072,v161
v_add_u32 v160,256,v205
v_mul_u32_u24 v161,745,v160
v_lshrrev_b32 v161,16,v161
v_mul_u32_u24 v162,88,v161
v_sub_u32 v160,v160,v162
v_mul_u32_u24 v161,41472,v161
v_mul_u32_u24 v162,2979,v160
v_lshrrev_b32 v162,16,v162
v_mul_u32_u24 v163,22,v162
v_sub_u32 v160,v160,v163
v_mul_u32_u24 v162,10368,v162
v_add_u32 v161,v161,v162
v_add_u32 v162,s9,v160
v_add_u32 v163,620,v160
v_cmp_gt_u32 vcc,20,v160
s_nop 1
v_cndmask_b32 v162,v163,v162,vcc
v_lshl_add_u32 v161,v162,4,v161
v_mov_b32 v215,v161
v_add_u32 v160,320,v205
v_mul_u32_u24 v161,745,v160
v_lshrrev_b32 v161,16,v161
v_mul_u32_u24 v162,88,v161
v_sub_u32 v160,v160,v162
v_mul_u32_u24 v161,41472,v161
v_mul_u32_u24 v162,2979,v160
v_lshrrev_b32 v162,16,v162
v_mul_u32_u24 v163,22,v162
v_sub_u32 v160,v160,v163
v_mul_u32_u24 v162,10368,v162
v_add_u32 v161,v161,v162
v_add_u32 v162,s9,v160
v_add_u32 v163,620,v160
v_cmp_gt_u32 vcc,20,v160
s_nop 1
v_cndmask_b32 v162,v163,v162,vcc
v_lshl_add_u32 v161,v162,4,v161
v_subrev_u32 v216,1024,v161
s_lshl_b32 s9,s31,1
s_lshl_b32 s10,s5,3
SADD s9,s9,s10
s_mul_i32 s7,s9,40960
SADD s7,s7,s18
s_and_b32 s10,s4,1
s_lshl_b32 s9,s10,9
SADD s8,s7,s9
s_cmp_eq_u32 s10,0
s_cselect_b32 s9,1024,8
SADD s7,s7,s9
AND v161,31,v205
SHL v162,4,v161
BL4 v[64:67],v204,s[24:27],s8 offen sc1
buffer_load_dwordx2 v[72:73],v162,s[24:27],s7 offen sc1
SADD s8,s8,40960
SADD s7,s7,40960
BL4 v[68:71],v204,s[24:27],s8 offen sc1
buffer_load_dwordx2 v[74:75],v162,s[24:27],s7 offen sc1
v_mov_b32 v166,0xff800000
v_mov_b32 v167,0xff800000
s_mov_b32 s13,0
s_mov_b32 s17,4
s_mov_b32 s15,64
SHL v160,4,v205
s_and_b32 s10,s4,1
s_lshl_b32 s20,s10,9
v_add_u32 v152,s20,v160
v_lshrrev_b32 v161,5,v205
v_mul_u32_u24 v161,1536,v161
AND v162,31,v205
v_lshl_add_u32 v161,v162,4,v161
s_cmp_eq_u32 s10,0
s_cselect_b32 s20,1024,8
v_add_u32 v153,s20,v161
AT_slow_chunk:
s_mov_b32 s14,0
s_mul_i32 s7,s13,655360
SADD s7,s7,s11
s_mul_i32 s33,s13,663552
SADD s33,s33,s12
s_cmp_eq_u32 s15,0
s_cselect_b32 s7,0x7ff00000,s7
s_cselect_b32 s33,0x7ff00000,s33
SADD s34,s7,81920
SADD s8,s14,s22
SADD s21,s14,s23
SADD s13,s13,1
s_and_b32 s13,s13,3
SADD s14,s14,47104
s_cmp_eq_u32 s14,141312
s_cselect_b32 s14,0,s14
s_cmp_lg_u32 s15,0
s_subb_u32 s15,s15,0
SADD m0,s8,0
s_nop 0
BL4 v208,s[24:27],s7 offen sc1 lds
SADD m0,s8,1024
s_nop 0
BL4 v209,s[24:27],s7 offen sc1 lds
SADD m0,s8,2048
s_nop 0
BL4 v210,s[24:27],s7 offen sc1 lds
SADD m0,s8,3072
s_nop 0
BL4 v208,s[24:27],s34 offen sc1 lds
SADD m0,s8,4096
s_nop 0
BL4 v209,s[24:27],s34 offen sc1 lds
SADD m0,s8,5120
s_nop 0
BL4 v210,s[24:27],s34 offen sc1 lds
s_mov_b32 m0,s21
s_nop 0
BL4 v211,s[24:27],s33 offen sc1 lds
s_mov_b32 m0,s21
s_nop 0
BL4 v212,s[24:27],s33 offen offset:1024 sc1 lds
s_mov_b32 m0,s21
s_nop 0
BL4 v213,s[24:27],s33 offen offset:2048 sc1 lds
s_mov_b32 m0,s21
s_nop 0
BL4 v214,s[24:27],s33 offen offset:3072 sc1 lds
SADD m0,s21,4096
s_nop 0
BL4 v215,s[24:27],s33 offen sc1 lds
SADD m0,s21,4096
s_mov_b32 exec_hi,0
BL4 v216,s[24:27],s33 offen offset:1024 sc1 lds
s_mov_b32 exec_hi,-1
WT vmcnt(0)
s_barrier
R128 v[112:115],v152 offset:0
R128 v[116:119],v152 offset:1536
ds_read_b64 v[78:79],v153 offset:0
WT lgkmcnt(0)
M32 v[0:15],v[112:115],v[64:67],0
M32 v[16:31],v[116:119],v[64:67],0
s_nop 9
M2B v[0:31],v[78:79],v[72:73],v[0:31]
s_nop 15
s_nop 3
v_max3_f32 v166,v0,v1,v166
v_max3_f32 v166,v2,v3,v166
v_max3_f32 v166,v4,v5,v166
v_max3_f32 v166,v6,v7,v166
v_max3_f32 v166,v8,v9,v166
v_max3_f32 v166,v10,v11,v166
v_max3_f32 v166,v12,v13,v166
v_max3_f32 v166,v14,v15,v166
v_max3_f32 v166,v16,v17,v166
v_max3_f32 v166,v18,v19,v166
v_max3_f32 v166,v20,v21,v166
v_max3_f32 v166,v22,v23,v166
v_max3_f32 v166,v24,v25,v166
v_max3_f32 v166,v26,v27,v166
v_max3_f32 v166,v28,v29,v166
v_max3_f32 v166,v30,v31,v166
M32 v[32:47],v[112:115],v[68:71],0
M32 v[48:63],v[116:119],v[68:71],0
s_nop 9
M2B v[32:63],v[78:79],v[74:75],v[32:63]
s_nop 15
s_nop 3
v_max3_f32 v167,v32,v33,v167
v_max3_f32 v167,v34,v35,v167
v_max3_f32 v167,v36,v37,v167
v_max3_f32 v167,v38,v39,v167
v_max3_f32 v167,v40,v41,v167
v_max3_f32 v167,v42,v43,v167
v_max3_f32 v167,v44,v45,v167
v_max3_f32 v167,v46,v47,v167
v_max3_f32 v167,v48,v49,v167
v_max3_f32 v167,v50,v51,v167
v_max3_f32 v167,v52,v53,v167
v_max3_f32 v167,v54,v55,v167
v_max3_f32 v167,v56,v57,v167
v_max3_f32 v167,v58,v59,v167
v_max3_f32 v167,v60,v61,v167
v_max3_f32 v167,v62,v63,v167
R128 v[112:115],v152 offset:3072
R128 v[116:119],v152 offset:4608
ds_read_b64 v[78:79],v153 offset:3072
WT lgkmcnt(0)
M32 v[0:15],v[112:115],v[64:67],0
M32 v[16:31],v[116:119],v[64:67],0
s_nop 9
M2B v[0:31],v[78:79],v[72:73],v[0:31]
s_nop 15
s_nop 3
v_max3_f32 v166,v0,v1,v166
v_max3_f32 v166,v2,v3,v166
v_max3_f32 v166,v4,v5,v166
v_max3_f32 v166,v6,v7,v166
v_max3_f32 v166,v8,v9,v166
v_max3_f32 v166,v10,v11,v166
v_max3_f32 v166,v12,v13,v166
v_max3_f32 v166,v14,v15,v166
v_max3_f32 v166,v16,v17,v166
v_max3_f32 v166,v18,v19,v166
v_max3_f32 v166,v20,v21,v166
v_max3_f32 v166,v22,v23,v166
v_max3_f32 v166,v24,v25,v166
v_max3_f32 v166,v26,v27,v166
v_max3_f32 v166,v28,v29,v166
v_max3_f32 v166,v30,v31,v166
M32 v[32:47],v[112:115],v[68:71],0
M32 v[48:63],v[116:119],v[68:71],0
s_nop 9
M2B v[32:63],v[78:79],v[74:75],v[32:63]
s_nop 15
s_nop 3
v_max3_f32 v167,v32,v33,v167
v_max3_f32 v167,v34,v35,v167
v_max3_f32 v167,v36,v37,v167
v_max3_f32 v167,v38,v39,v167
v_max3_f32 v167,v40,v41,v167
v_max3_f32 v167,v42,v43,v167
v_max3_f32 v167,v44,v45,v167
v_max3_f32 v167,v46,v47,v167
v_max3_f32 v167,v48,v49,v167
v_max3_f32 v167,v50,v51,v167
v_max3_f32 v167,v52,v53,v167
v_max3_f32 v167,v54,v55,v167
v_max3_f32 v167,v56,v57,v167
v_max3_f32 v167,v58,v59,v167
v_max3_f32 v167,v60,v61,v167
v_max3_f32 v167,v62,v63,v167
R128 v[112:115],v152 offset:6144
R128 v[116:119],v152 offset:7680
ds_read_b64 v[78:79],v153 offset:6144
WT lgkmcnt(0)
M32 v[0:15],v[112:115],v[64:67],0
M32 v[16:31],v[116:119],v[64:67],0
s_nop 9
M2B v[0:31],v[78:79],v[72:73],v[0:31]
s_nop 15
s_nop 3
v_max3_f32 v166,v0,v1,v166
v_max3_f32 v166,v2,v3,v166
v_max3_f32 v166,v4,v5,v166
v_max3_f32 v166,v6,v7,v166
v_max3_f32 v166,v8,v9,v166
v_max3_f32 v166,v10,v11,v166
v_max3_f32 v166,v12,v13,v166
v_max3_f32 v166,v14,v15,v166
v_max3_f32 v166,v16,v17,v166
v_max3_f32 v166,v18,v19,v166
v_max3_f32 v166,v20,v21,v166
v_max3_f32 v166,v22,v23,v166
v_max3_f32 v166,v24,v25,v166
v_max3_f32 v166,v26,v27,v166
v_max3_f32 v166,v28,v29,v166
v_max3_f32 v166,v30,v31,v166
M32 v[32:47],v[112:115],v[68:71],0
M32 v[48:63],v[116:119],v[68:71],0
s_nop 9
M2B v[32:63],v[78:79],v[74:75],v[32:63]
s_nop 15
s_nop 3
v_max3_f32 v167,v32,v33,v167
v_max3_f32 v167,v34,v35,v167
v_max3_f32 v167,v36,v37,v167
v_max3_f32 v167,v38,v39,v167
v_max3_f32 v167,v40,v41,v167
v_max3_f32 v167,v42,v43,v167
v_max3_f32 v167,v44,v45,v167
v_max3_f32 v167,v46,v47,v167
v_max3_f32 v167,v48,v49,v167
v_max3_f32 v167,v50,v51,v167
v_max3_f32 v167,v52,v53,v167
v_max3_f32 v167,v54,v55,v167
v_max3_f32 v167,v56,v57,v167
v_max3_f32 v167,v58,v59,v167
v_max3_f32 v167,v60,v61,v167
v_max3_f32 v167,v62,v63,v167
R128 v[112:115],v152 offset:9216
R128 v[116:119],v152 offset:10752
ds_read_b64 v[78:79],v153 offset:9216
WT lgkmcnt(0)
M32 v[0:15],v[112:115],v[64:67],0
M32 v[16:31],v[116:119],v[64:67],0
s_nop 9
M2B v[0:31],v[78:79],v[72:73],v[0:31]
s_nop 15
s_nop 3
v_max3_f32 v166,v0,v1,v166
v_max3_f32 v166,v2,v3,v166
v_max3_f32 v166,v4,v5,v166
v_max3_f32 v166,v6,v7,v166
v_max3_f32 v166,v8,v9,v166
v_max3_f32 v166,v10,v11,v166
v_max3_f32 v166,v12,v13,v166
v_max3_f32 v166,v14,v15,v166
v_max3_f32 v166,v16,v17,v166
v_max3_f32 v166,v18,v19,v166
v_max3_f32 v166,v20,v21,v166
v_max3_f32 v166,v22,v23,v166
v_max3_f32 v166,v24,v25,v166
v_max3_f32 v166,v26,v27,v166
v_max3_f32 v166,v28,v29,v166
v_max3_f32 v166,v30,v31,v166
M32 v[32:47],v[112:115],v[68:71],0
M32 v[48:63],v[116:119],v[68:71],0
s_nop 9
M2B v[32:63],v[78:79],v[74:75],v[32:63]
s_nop 15
s_nop 3
v_max3_f32 v167,v32,v33,v167
v_max3_f32 v167,v34,v35,v167
v_max3_f32 v167,v36,v37,v167
v_max3_f32 v167,v38,v39,v167
v_max3_f32 v167,v40,v41,v167
v_max3_f32 v167,v42,v43,v167
v_max3_f32 v167,v44,v45,v167
v_max3_f32 v167,v46,v47,v167
v_max3_f32 v167,v48,v49,v167
v_max3_f32 v167,v50,v51,v167
v_max3_f32 v167,v52,v53,v167
v_max3_f32 v167,v54,v55,v167
v_max3_f32 v167,v56,v57,v167
v_max3_f32 v167,v58,v59,v167
v_max3_f32 v167,v60,v61,v167
v_max3_f32 v167,v62,v63,v167
R128 v[112:115],v152 offset:12288
R128 v[116:119],v152 offset:13824
ds_read_b64 v[78:79],v153 offset:12288
WT lgkmcnt(0)
M32 v[0:15],v[112:115],v[64:67],0
M32 v[16:31],v[116:119],v[64:67],0
s_nop 9
M2B v[0:31],v[78:79],v[72:73],v[0:31]
s_nop 15
s_nop 3
v_max3_f32 v166,v0,v1,v166
v_max3_f32 v166,v2,v3,v166
v_max3_f32 v166,v4,v5,v166
v_max3_f32 v166,v6,v7,v166
v_max3_f32 v166,v8,v9,v166
v_max3_f32 v166,v10,v11,v166
v_max3_f32 v166,v12,v13,v166
v_max3_f32 v166,v14,v15,v166
v_max3_f32 v166,v16,v17,v166
v_max3_f32 v166,v18,v19,v166
v_max3_f32 v166,v20,v21,v166
v_max3_f32 v166,v22,v23,v166
v_max3_f32 v166,v24,v25,v166
v_max3_f32 v166,v26,v27,v166
v_max3_f32 v166,v28,v29,v166
v_max3_f32 v166,v30,v31,v166
M32 v[32:47],v[112:115],v[68:71],0
M32 v[48:63],v[116:119],v[68:71],0
s_nop 9
M2B v[32:63],v[78:79],v[74:75],v[32:63]
s_nop 15
s_nop 3
v_max3_f32 v167,v32,v33,v167
v_max3_f32 v167,v34,v35,v167
v_max3_f32 v167,v36,v37,v167
v_max3_f32 v167,v38,v39,v167
v_max3_f32 v167,v40,v41,v167
v_max3_f32 v167,v42,v43,v167
v_max3_f32 v167,v44,v45,v167
v_max3_f32 v167,v46,v47,v167
v_max3_f32 v167,v48,v49,v167
v_max3_f32 v167,v50,v51,v167
v_max3_f32 v167,v52,v53,v167
v_max3_f32 v167,v54,v55,v167
v_max3_f32 v167,v56,v57,v167
v_max3_f32 v167,v58,v59,v167
v_max3_f32 v167,v60,v61,v167
v_max3_f32 v167,v62,v63,v167
R128 v[112:115],v152 offset:15360
R128 v[116:119],v152 offset:16896
ds_read_b64 v[78:79],v153 offset:15360
WT lgkmcnt(0)
M32 v[0:15],v[112:115],v[64:67],0
M32 v[16:31],v[116:119],v[64:67],0
s_nop 9
M2B v[0:31],v[78:79],v[72:73],v[0:31]
s_nop 15
s_nop 3
v_max3_f32 v166,v0,v1,v166
v_max3_f32 v166,v2,v3,v166
v_max3_f32 v166,v4,v5,v166
v_max3_f32 v166,v6,v7,v166
v_max3_f32 v166,v8,v9,v166
v_max3_f32 v166,v10,v11,v166
v_max3_f32 v166,v12,v13,v166
v_max3_f32 v166,v14,v15,v166
v_max3_f32 v166,v16,v17,v166
v_max3_f32 v166,v18,v19,v166
v_max3_f32 v166,v20,v21,v166
v_max3_f32 v166,v22,v23,v166
v_max3_f32 v166,v24,v25,v166
v_max3_f32 v166,v26,v27,v166
v_max3_f32 v166,v28,v29,v166
v_max3_f32 v166,v30,v31,v166
M32 v[32:47],v[112:115],v[68:71],0
M32 v[48:63],v[116:119],v[68:71],0
s_nop 9
M2B v[32:63],v[78:79],v[74:75],v[32:63]
s_nop 15
s_nop 3
v_max3_f32 v167,v32,v33,v167
v_max3_f32 v167,v34,v35,v167
v_max3_f32 v167,v36,v37,v167
v_max3_f32 v167,v38,v39,v167
v_max3_f32 v167,v40,v41,v167
v_max3_f32 v167,v42,v43,v167
v_max3_f32 v167,v44,v45,v167
v_max3_f32 v167,v46,v47,v167
v_max3_f32 v167,v48,v49,v167
v_max3_f32 v167,v50,v51,v167
v_max3_f32 v167,v52,v53,v167
v_max3_f32 v167,v54,v55,v167
v_max3_f32 v167,v56,v57,v167
v_max3_f32 v167,v58,v59,v167
v_max3_f32 v167,v60,v61,v167
v_max3_f32 v167,v62,v63,v167
R128 v[112:115],v152 offset:18432
R128 v[116:119],v152 offset:19968
ds_read_b64 v[78:79],v153 offset:18432
WT lgkmcnt(0)
M32 v[0:15],v[112:115],v[64:67],0
M32 v[16:31],v[116:119],v[64:67],0
s_nop 9
M2B v[0:31],v[78:79],v[72:73],v[0:31]
s_nop 15
s_nop 3
v_max3_f32 v166,v0,v1,v166
v_max3_f32 v166,v2,v3,v166
v_max3_f32 v166,v4,v5,v166
v_max3_f32 v166,v6,v7,v166
v_max3_f32 v166,v8,v9,v166
v_max3_f32 v166,v10,v11,v166
v_max3_f32 v166,v12,v13,v166
v_max3_f32 v166,v14,v15,v166
v_max3_f32 v166,v16,v17,v166
v_max3_f32 v166,v18,v19,v166
v_max3_f32 v166,v20,v21,v166
v_max3_f32 v166,v22,v23,v166
v_max3_f32 v166,v24,v25,v166
v_max3_f32 v166,v26,v27,v166
v_max3_f32 v166,v28,v29,v166
v_max3_f32 v166,v30,v31,v166
M32 v[32:47],v[112:115],v[68:71],0
M32 v[48:63],v[116:119],v[68:71],0
s_nop 9
M2B v[32:63],v[78:79],v[74:75],v[32:63]
s_nop 15
s_nop 3
v_max3_f32 v167,v32,v33,v167
v_max3_f32 v167,v34,v35,v167
v_max3_f32 v167,v36,v37,v167
v_max3_f32 v167,v38,v39,v167
v_max3_f32 v167,v40,v41,v167
v_max3_f32 v167,v42,v43,v167
v_max3_f32 v167,v44,v45,v167
v_max3_f32 v167,v46,v47,v167
v_max3_f32 v167,v48,v49,v167
v_max3_f32 v167,v50,v51,v167
v_max3_f32 v167,v52,v53,v167
v_max3_f32 v167,v54,v55,v167
v_max3_f32 v167,v56,v57,v167
v_max3_f32 v167,v58,v59,v167
v_max3_f32 v167,v60,v61,v167
v_max3_f32 v167,v62,v63,v167
R128 v[112:115],v152 offset:21504
R128 v[116:119],v152 offset:23040
ds_read_b64 v[78:79],v153 offset:21504
WT lgkmcnt(0)
M32 v[0:15],v[112:115],v[64:67],0
M32 v[16:31],v[116:119],v[64:67],0
s_nop 9
M2B v[0:31],v[78:79],v[72:73],v[0:31]
s_nop 15
s_nop 3
v_max3_f32 v166,v0,v1,v166
v_max3_f32 v166,v2,v3,v166
v_max3_f32 v166,v4,v5,v166
v_max3_f32 v166,v6,v7,v166
v_max3_f32 v166,v8,v9,v166
v_max3_f32 v166,v10,v11,v166
v_max3_f32 v166,v12,v13,v166
v_max3_f32 v166,v14,v15,v166
v_max3_f32 v166,v16,v17,v166
v_max3_f32 v166,v18,v19,v166
v_max3_f32 v166,v20,v21,v166
v_max3_f32 v166,v22,v23,v166
v_max3_f32 v166,v24,v25,v166
v_max3_f32 v166,v26,v27,v166
v_max3_f32 v166,v28,v29,v166
v_max3_f32 v166,v30,v31,v166
M32 v[32:47],v[112:115],v[68:71],0
M32 v[48:63],v[116:119],v[68:71],0
s_nop 9
M2B v[32:63],v[78:79],v[74:75],v[32:63]
s_nop 15
s_nop 3
v_max3_f32 v167,v32,v33,v167
v_max3_f32 v167,v34,v35,v167
v_max3_f32 v167,v36,v37,v167
v_max3_f32 v167,v38,v39,v167
v_max3_f32 v167,v40,v41,v167
v_max3_f32 v167,v42,v43,v167
v_max3_f32 v167,v44,v45,v167
v_max3_f32 v167,v46,v47,v167
v_max3_f32 v167,v48,v49,v167
v_max3_f32 v167,v50,v51,v167
v_max3_f32 v167,v52,v53,v167
v_max3_f32 v167,v54,v55,v167
v_max3_f32 v167,v56,v57,v167
v_max3_f32 v167,v58,v59,v167
v_max3_f32 v167,v60,v61,v167
v_max3_f32 v167,v62,v63,v167
s_barrier
s_sub_u32 s17,s17,1
s_cmp_lg_u32 s17,0
s_cbranch_scc1 AT_slow_chunk
v_mov_b32 v160,v166
s_nop 1
v_permlane32_swap_b32 v160,v166
v_max_f32 v166,v166,v160
v_mov_b32 v160,v167
s_nop 1
v_permlane32_swap_b32 v160,v167
v_max_f32 v167,v167,v160
s_mov_b32 s13,0
s_mov_b32 s14,0
s_mov_b32 s15,4
s_mul_i32 s7,s13,655360
SADD s7,s7,s11
s_mul_i32 s33,s13,663552
SADD s33,s33,s12
s_cmp_eq_u32 s15,0
s_cselect_b32 s7,0x7ff00000,s7
s_cselect_b32 s33,0x7ff00000,s33
SADD s34,s7,81920
SADD s8,s14,s22
SADD s21,s14,s23
SADD s13,s13,1
s_and_b32 s13,s13,3
SADD s14,s14,47104
s_cmp_eq_u32 s14,141312
s_cselect_b32 s14,0,s14
s_cmp_lg_u32 s15,0
s_subb_u32 s15,s15,0
SADD m0,s8,0
s_nop 0
BL4 v208,s[24:27],s7 offen sc1 lds
SADD m0,s8,1024
s_nop 0
BL4 v209,s[24:27],s7 offen sc1 lds
SADD m0,s8,2048
s_nop 0
BL4 v210,s[24:27],s7 offen sc1 lds
SADD m0,s8,3072
s_nop 0
BL4 v208,s[24:27],s34 offen sc1 lds
SADD m0,s8,4096
s_nop 0
BL4 v209,s[24:27],s34 offen sc1 lds
SADD m0,s8,5120
s_nop 0
BL4 v210,s[24:27],s34 offen sc1 lds
s_mov_b32 m0,s21
s_nop 0
BL4 v211,s[24:27],s33 offen sc1 lds
s_mov_b32 m0,s21
s_nop 0
BL4 v212,s[24:27],s33 offen offset:1024 sc1 lds
s_mov_b32 m0,s21
s_nop 0
BL4 v213,s[24:27],s33 offen offset:2048 sc1 lds
s_mov_b32 m0,s21
s_nop 0
BL4 v214,s[24:27],s33 offen offset:3072 sc1 lds
SADD m0,s21,4096
s_nop 0
BL4 v215,s[24:27],s33 offen sc1 lds
SADD m0,s21,4096
s_mov_b32 exec_hi,0
BL4 v216,s[24:27],s33 offen offset:1024 sc1 lds
s_mov_b32 exec_hi,-1
s_mul_i32 s7,s13,655360
SADD s7,s7,s11
s_mul_i32 s33,s13,663552
SADD s33,s33,s12
s_cmp_eq_u32 s15,0
s_cselect_b32 s7,0x7ff00000,s7
s_cselect_b32 s33,0x7ff00000,s33
SADD s34,s7,81920
SADD s8,s14,s22
SADD s21,s14,s23
SADD s13,s13,1
s_and_b32 s13,s13,3
SADD s14,s14,47104
s_cmp_eq_u32 s14,141312
s_cselect_b32 s14,0,s14
s_cmp_lg_u32 s15,0
s_subb_u32 s15,s15,0
SADD m0,s8,0
s_nop 0
BL4 v208,s[24:27],s7 offen sc1 lds
SADD m0,s8,1024
s_nop 0
BL4 v209,s[24:27],s7 offen sc1 lds
SADD m0,s8,2048
s_nop 0
BL4 v210,s[24:27],s7 offen sc1 lds
SADD m0,s8,3072
s_nop 0
BL4 v208,s[24:27],s34 offen sc1 lds
SADD m0,s8,4096
s_nop 0
BL4 v209,s[24:27],s34 offen sc1 lds
SADD m0,s8,5120
s_nop 0
BL4 v210,s[24:27],s34 offen sc1 lds
s_mov_b32 m0,s21
s_nop 0
BL4 v211,s[24:27],s33 offen sc1 lds
s_mov_b32 m0,s21
s_nop 0
BL4 v212,s[24:27],s33 offen offset:1024 sc1 lds
s_mov_b32 m0,s21
s_nop 0
BL4 v213,s[24:27],s33 offen offset:2048 sc1 lds
s_mov_b32 m0,s21
s_nop 0
BL4 v214,s[24:27],s33 offen offset:3072 sc1 lds
SADD m0,s21,4096
s_nop 0
BL4 v215,s[24:27],s33 offen sc1 lds
SADD m0,s21,4096
s_mov_b32 exec_hi,0
BL4 v216,s[24:27],s33 offen offset:1024 sc1 lds
s_mov_b32 exec_hi,-1
SHL v160,4,v205
s_and_b32 s10,s4,1
s_lshl_b32 s20,s10,9
v_add_u32 v152,s20,v160
v_lshrrev_b32 v161,5,v205
v_mul_u32_u24 v161,1536,v161
AND v162,31,v205
v_lshl_add_u32 v161,v162,4,v161
s_cmp_eq_u32 s10,0
s_cselect_b32 s20,1024,8
v_add_u32 v153,s20,v161
v_min_u32 v162,21,v162
SHL v162,4,v162
v_lshrrev_b32 v161,5,v205
v_mul_u32_u24 v161,352,v161
v_add_u32 v162,v162,v161
v_add_u32 v154,24576,v162
v_mov_b32 v80,0
v_mov_b32 v81,0
v_mov_b32 v82,0
v_mov_b32 v83,0
v_mov_b32 v84,0
v_mov_b32 v85,0
v_mov_b32 v86,0
v_mov_b32 v87,0
v_mov_b32 v88,0
v_mov_b32 v89,0
v_mov_b32 v90,0
v_mov_b32 v91,0
v_mov_b32 v92,0
v_mov_b32 v93,0
v_mov_b32 v94,0
v_mov_b32 v95,0
v_mov_b32 v96,0
v_mov_b32 v97,0
v_mov_b32 v98,0
v_mov_b32 v99,0
v_mov_b32 v100,0
v_mov_b32 v101,0
v_mov_b32 v102,0
v_mov_b32 v103,0
v_mov_b32 v104,0
v_mov_b32 v105,0
v_mov_b32 v106,0
v_mov_b32 v107,0
v_mov_b32 v108,0
v_mov_b32 v109,0
v_mov_b32 v110,0
v_mov_b32 v111,0
v_mov_b32 v132,0
v_mov_b32 v133,0
v_mov_b32 v134,0
v_mov_b32 v135,0
v_mov_b32 v200,0
v_mov_b32 v201,0
v_mov_b32 v202,0
v_mov_b32 v203,0
s_mov_b32 s32,0
s_mov_b32 s17,4
WT vmcnt(12)
s_barrier
R128 v[112:115],v152 offset:0
R128 v[116:119],v152 offset:1536
ds_read_b64 v[78:79],v153 offset:0
R128 v[136:139],v154 offset:0
R128 v[140:143],v154 offset:704
R128 v[144:147],v154 offset:1408
R128 v[148:151],v154 offset:2112
WT lgkmcnt(4)
M32 v[0:15],v[112:115],v[64:67],0
M32 v[16:31],v[116:119],v[64:67],0
s_nop 9
M2B v[0:31],v[78:79],v[72:73],v[0:31]
s_nop 15
s_nop 1
WT lgkmcnt(0)
.p2align 6
ATs_loop:
SADD m0,s8,2048
s_nop 0
BL4 v210,s[24:27],s7 offen sc1 lds
SADD m0,s8,3072
s_nop 0
BL4 v208,s[24:27],s34 offen sc1 lds
v_sub_f32 v0,v0,v166
EX v0,v0
v_sub_f32 v1,v1,v166
EX v1,v1
M32 v[96:111],v[200:203],v[132:135],v[96:111]
R128 v[176:179],v152 offset:3072
v_sub_f32 v2,v2,v166
EX v2,v2
v_sub_f32 v3,v3,v166
EX v3,v3
v_sub_f32 v4,v4,v166
EX v4,v4
v_sub_f32 v5,v5,v166
EX v5,v5
M32 v[32:47],v[112:115],v[68:71],0
R128 v[180:183],v152 offset:4608
v_sub_f32 v6,v6,v166
EX v6,v6
v_sub_f32 v7,v7,v166
EX v7,v7
CV v120,v0,v1
CV v121,v2,v3
CV v122,v4,v5
CV v123,v6,v7
M32 v[48:63],v[116:119],v[68:71],0
ds_read_b64 v[184:185],v153 offset:3072
v_sub_f32 v8,v8,v166
EX v8,v8
v_sub_f32 v9,v9,v166
EX v9,v9
v_sub_f32 v10,v10,v166
EX v10,v10
v_sub_f32 v11,v11,v166
EX v11,v11
M32 v[80:95],v[136:139],v[120:123],v[80:95]
R128 v[188:191],v154 offset:2816
v_sub_f32 v12,v12,v166
EX v12,v12
v_sub_f32 v13,v13,v166
EX v13,v13
v_sub_f32 v14,v14,v166
EX v14,v14
v_sub_f32 v15,v15,v166
EX v15,v15
M2B v[32:63],v[78:79],v[74:75],v[32:63]
R128 v[192:195],v154 offset:3520
CV v124,v8,v9
CV v125,v10,v11
CV v126,v12,v13
CV v127,v14,v15
v_sub_f32 v16,v16,v166
EX v16,v16
v_sub_f32 v17,v17,v166
EX v17,v17
v_sub_f32 v18,v18,v166
EX v18,v18
v_sub_f32 v19,v19,v166
EX v19,v19
v_sub_f32 v20,v20,v166
EX v20,v20
v_sub_f32 v21,v21,v166
EX v21,v21
M32 v[80:95],v[140:143],v[124:127],v[80:95]
R128 v[196:199],v154 offset:4224
v_sub_f32 v22,v22,v166
EX v22,v22
v_sub_f32 v23,v23,v166
EX v23,v23
CV v128,v16,v17
CV v129,v18,v19
CV v130,v20,v21
CV v131,v22,v23
v_sub_f32 v24,v24,v166
EX v24,v24
v_sub_f32 v25,v25,v166
EX v25,v25
M32 v[80:95],v[144:147],v[128:131],v[80:95]
WT lgkmcnt(3)
v_sub_f32 v26,v26,v166
EX v26,v26
v_sub_f32 v27,v27,v166
EX v27,v27
v_sub_f32 v28,v28,v166
EX v28,v28
v_sub_f32 v29,v29,v166
EX v29,v29
v_sub_f32 v30,v30,v166
EX v30,v30
v_sub_f32 v31,v31,v166
EX v31,v31
CV v132,v24,v25
CV v133,v26,v27
CV v134,v28,v29
CV v135,v30,v31
v_sub_f32 v32,v32,v167
EX v32,v32
v_sub_f32 v33,v33,v167
EX v33,v33
M32 v[80:95],v[148:151],v[132:135],v[80:95]
R128 v[200:203],v154 offset:4928
v_sub_f32 v34,v34,v167
EX v34,v34
v_sub_f32 v35,v35,v167
EX v35,v35
v_sub_f32 v36,v36,v167
EX v36,v36
v_sub_f32 v37,v37,v167
EX v37,v37
M32 v[0:15],v[176:179],v[64:67],0
v_sub_f32 v38,v38,v167
EX v38,v38
v_sub_f32 v39,v39,v167
EX v39,v39
CV v120,v32,v33
CV v121,v34,v35
CV v122,v36,v37
CV v123,v38,v39
M32 v[16:31],v[180:183],v[64:67],0
v_sub_f32 v40,v40,v167
EX v40,v40
v_sub_f32 v41,v41,v167
EX v41,v41
v_sub_f32 v42,v42,v167
EX v42,v42
v_sub_f32 v43,v43,v167
EX v43,v43
M32 v[96:111],v[136:139],v[120:123],v[96:111]
v_sub_f32 v44,v44,v167
EX v44,v44
v_sub_f32 v45,v45,v167
EX v45,v45
v_sub_f32 v46,v46,v167
EX v46,v46
v_sub_f32 v47,v47,v167
EX v47,v47
M2B v[0:31],v[184:185],v[72:73],v[0:31]
CV v124,v40,v41
CV v125,v42,v43
CV v126,v44,v45
CV v127,v46,v47
v_sub_f32 v48,v48,v167
EX v48,v48
v_sub_f32 v49,v49,v167
EX v49,v49
v_sub_f32 v50,v50,v167
EX v50,v50
v_sub_f32 v51,v51,v167
EX v51,v51
v_sub_f32 v52,v52,v167
EX v52,v52
v_sub_f32 v53,v53,v167
EX v53,v53
M32 v[96:111],v[140:143],v[124:127],v[96:111]
v_sub_f32 v54,v54,v167
EX v54,v54
v_sub_f32 v55,v55,v167
EX v55,v55
CV v128,v48,v49
CV v129,v50,v51
CV v130,v52,v53
CV v131,v54,v55
v_sub_f32 v56,v56,v167
EX v56,v56
v_sub_f32 v57,v57,v167
EX v57,v57
M32 v[96:111],v[144:147],v[128:131],v[96:111]
WT lgkmcnt(0)
v_sub_f32 v58,v58,v167
EX v58,v58
v_sub_f32 v59,v59,v167
EX v59,v59
v_sub_f32 v60,v60,v167
EX v60,v60
v_sub_f32 v61,v61,v167
EX v61,v61
v_sub_f32 v62,v62,v167
EX v62,v62
v_sub_f32 v63,v63,v167
EX v63,v63
CV v132,v56,v57
CV v133,v58,v59
CV v134,v60,v61
CV v135,v62,v63
SADD m0,s8,4096
s_nop 0
BL4 v209,s[24:27],s34 offen sc1 lds
SADD m0,s8,5120
s_nop 0
BL4 v210,s[24:27],s34 offen sc1 lds
v_sub_f32 v0,v0,v166
EX v0,v0
v_sub_f32 v1,v1,v166
EX v1,v1
M32 v[96:111],v[148:151],v[132:135],v[96:111]
R128 v[112:115],v152 offset:6144
v_sub_f32 v2,v2,v166
EX v2,v2
v_sub_f32 v3,v3,v166
EX v3,v3
v_sub_f32 v4,v4,v166
EX v4,v4
v_sub_f32 v5,v5,v166
EX v5,v5
M32 v[32:47],v[176:179],v[68:71],0
R128 v[116:119],v152 offset:7680
v_sub_f32 v6,v6,v166
EX v6,v6
v_sub_f32 v7,v7,v166
EX v7,v7
CV v120,v0,v1
CV v121,v2,v3
CV v122,v4,v5
CV v123,v6,v7
M32 v[48:63],v[180:183],v[68:71],0
ds_read_b64 v[78:79],v153 offset:6144
v_sub_f32 v8,v8,v166
EX v8,v8
v_sub_f32 v9,v9,v166
EX v9,v9
v_sub_f32 v10,v10,v166
EX v10,v10
v_sub_f32 v11,v11,v166
EX v11,v11
M32 v[80:95],v[188:191],v[120:123],v[80:95]
R128 v[136:139],v154 offset:5632
v_sub_f32 v12,v12,v166
EX v12,v12
v_sub_f32 v13,v13,v166
EX v13,v13
v_sub_f32 v14,v14,v166
EX v14,v14
v_sub_f32 v15,v15,v166
EX v15,v15
M2B v[32:63],v[184:185],v[74:75],v[32:63]
R128 v[140:143],v154 offset:6336
CV v124,v8,v9
CV v125,v10,v11
CV v126,v12,v13
CV v127,v14,v15
v_sub_f32 v16,v16,v166
EX v16,v16
v_sub_f32 v17,v17,v166
EX v17,v17
v_sub_f32 v18,v18,v166
EX v18,v18
v_sub_f32 v19,v19,v166
EX v19,v19
v_sub_f32 v20,v20,v166
EX v20,v20
v_sub_f32 v21,v21,v166
EX v21,v21
M32 v[80:95],v[192:195],v[124:127],v[80:95]
R128 v[144:147],v154 offset:7040
v_sub_f32 v22,v22,v166
EX v22,v22
v_sub_f32 v23,v23,v166
EX v23,v23
CV v128,v16,v17
CV v129,v18,v19
CV v130,v20,v21
CV v131,v22,v23
v_sub_f32 v24,v24,v166
EX v24,v24
v_sub_f32 v25,v25,v166
EX v25,v25
M32 v[80:95],v[196:199],v[128:131],v[80:95]
WT lgkmcnt(3)
v_sub_f32 v26,v26,v166
EX v26,v26
v_sub_f32 v27,v27,v166
EX v27,v27
v_sub_f32 v28,v28,v166
EX v28,v28
v_sub_f32 v29,v29,v166
EX v29,v29
v_sub_f32 v30,v30,v166
EX v30,v30
v_sub_f32 v31,v31,v166
EX v31,v31
CV v132,v24,v25
CV v133,v26,v27
CV v134,v28,v29
CV v135,v30,v31
v_sub_f32 v32,v32,v167
EX v32,v32
v_sub_f32 v33,v33,v167
EX v33,v33
M32 v[80:95],v[200:203],v[132:135],v[80:95]
R128 v[148:151],v154 offset:7744
v_sub_f32 v34,v34,v167
EX v34,v34
v_sub_f32 v35,v35,v167
EX v35,v35
v_sub_f32 v36,v36,v167
EX v36,v36
v_sub_f32 v37,v37,v167
EX v37,v37
M32 v[0:15],v[112:115],v[64:67],0
v_sub_f32 v38,v38,v167
EX v38,v38
v_sub_f32 v39,v39,v167
EX v39,v39
CV v120,v32,v33
CV v121,v34,v35
CV v122,v36,v37
CV v123,v38,v39
M32 v[16:31],v[116:119],v[64:67],0
v_sub_f32 v40,v40,v167
EX v40,v40
v_sub_f32 v41,v41,v167
EX v41,v41
v_sub_f32 v42,v42,v167
EX v42,v42
v_sub_f32 v43,v43,v167
EX v43,v43
M32 v[96:111],v[188:191],v[120:123],v[96:111]
v_sub_f32 v44,v44,v167
EX v44,v44
v_sub_f32 v45,v45,v167
EX v45,v45
v_sub_f32 v46,v46,v167
EX v46,v46
v_sub_f32 v47,v47,v167
EX v47,v47
M2B v[0:31],v[78:79],v[72:73],v[0:31]
CV v124,v40,v41
CV v125,v42,v43
CV v126,v44,v45
CV v127,v46,v47
v_sub_f32 v48,v48,v167
EX v48,v48
v_sub_f32 v49,v49,v167
EX v49,v49
v_sub_f32 v50,v50,v167
EX v50,v50
v_sub_f32 v51,v51,v167
EX v51,v51
v_sub_f32 v52,v52,v167
EX v52,v52
v_sub_f32 v53,v53,v167
EX v53,v53
M32 v[96:111],v[192:195],v[124:127],v[96:111]
v_sub_f32 v54,v54,v167
EX v54,v54
v_sub_f32 v55,v55,v167
EX v55,v55
CV v128,v48,v49
CV v129,v50,v51
CV v130,v52,v53
CV v131,v54,v55
v_sub_f32 v56,v56,v167
EX v56,v56
v_sub_f32 v57,v57,v167
EX v57,v57
M32 v[96:111],v[196:199],v[128:131],v[96:111]
WT lgkmcnt(0)
v_sub_f32 v58,v58,v167
EX v58,v58
v_sub_f32 v59,v59,v167
EX v59,v59
v_sub_f32 v60,v60,v167
EX v60,v60
v_sub_f32 v61,v61,v167
EX v61,v61
v_sub_f32 v62,v62,v167
EX v62,v62
v_sub_f32 v63,v63,v167
EX v63,v63
CV v132,v56,v57
CV v133,v58,v59
CV v134,v60,v61
CV v135,v62,v63
s_mov_b32 m0,s21
s_nop 0
BL4 v211,s[24:27],s33 offen sc1 lds
s_mov_b32 m0,s21
s_nop 0
BL4 v212,s[24:27],s33 offen offset:1024 sc1 lds
v_sub_f32 v0,v0,v166
EX v0,v0
v_sub_f32 v1,v1,v166
EX v1,v1
M32 v[96:111],v[200:203],v[132:135],v[96:111]
R128 v[176:179],v152 offset:9216
v_sub_f32 v2,v2,v166
EX v2,v2
v_sub_f32 v3,v3,v166
EX v3,v3
v_sub_f32 v4,v4,v166
EX v4,v4
v_sub_f32 v5,v5,v166
EX v5,v5
M32 v[32:47],v[112:115],v[68:71],0
R128 v[180:183],v152 offset:10752
v_sub_f32 v6,v6,v166
EX v6,v6
v_sub_f32 v7,v7,v166
EX v7,v7
CV v120,v0,v1
CV v121,v2,v3
CV v122,v4,v5
CV v123,v6,v7
M32 v[48:63],v[116:119],v[68:71],0
ds_read_b64 v[184:185],v153 offset:9216
v_sub_f32 v8,v8,v166
EX v8,v8
v_sub_f32 v9,v9,v166
EX v9,v9
v_sub_f32 v10,v10,v166
EX v10,v10
v_sub_f32 v11,v11,v166
EX v11,v11
M32 v[80:95],v[136:139],v[120:123],v[80:95]
R128 v[188:191],v154 offset:8448
v_sub_f32 v12,v12,v166
EX v12,v12
v_sub_f32 v13,v13,v166
EX v13,v13
v_sub_f32 v14,v14,v166
EX v14,v14
v_sub_f32 v15,v15,v166
EX v15,v15
M2B v[32:63],v[78:79],v[74:75],v[32:63]
R128 v[192:195],v154 offset:9152
CV v124,v8,v9
CV v125,v10,v11
CV v126,v12,v13
CV v127,v14,v15
v_sub_f32 v16,v16,v166
EX v16,v16
v_sub_f32 v17,v17,v166
EX v17,v17
v_sub_f32 v18,v18,v166
EX v18,v18
v_sub_f32 v19,v19,v166
EX v19,v19
v_sub_f32 v20,v20,v166
EX v20,v20
v_sub_f32 v21,v21,v166
EX v21,v21
M32 v[80:95],v[140:143],v[124:127],v[80:95]
R128 v[196:199],v154 offset:9856
v_sub_f32 v22,v22,v166
EX v22,v22
v_sub_f32 v23,v23,v166
EX v23,v23
CV v128,v16,v17
CV v129,v18,v19
CV v130,v20,v21
CV v131,v22,v23
v_sub_f32 v24,v24,v166
EX v24,v24
v_sub_f32 v25,v25,v166
EX v25,v25
M32 v[80:95],v[144:147],v[128:131],v[80:95]
WT lgkmcnt(3)
v_sub_f32 v26,v26,v166
EX v26,v26
v_sub_f32 v27,v27,v166
EX v27,v27
v_sub_f32 v28,v28,v166
EX v28,v28
v_sub_f32 v29,v29,v166
EX v29,v29
v_sub_f32 v30,v30,v166
EX v30,v30
v_sub_f32 v31,v31,v166
EX v31,v31
CV v132,v24,v25
CV v133,v26,v27
CV v134,v28,v29
CV v135,v30,v31
v_sub_f32 v32,v32,v167
EX v32,v32
v_sub_f32 v33,v33,v167
EX v33,v33
M32 v[80:95],v[148:151],v[132:135],v[80:95]
R128 v[200:203],v154 offset:10560
v_sub_f32 v34,v34,v167
EX v34,v34
v_sub_f32 v35,v35,v167
EX v35,v35
v_sub_f32 v36,v36,v167
EX v36,v36
v_sub_f32 v37,v37,v167
EX v37,v37
M32 v[0:15],v[176:179],v[64:67],0
v_sub_f32 v38,v38,v167
EX v38,v38
v_sub_f32 v39,v39,v167
EX v39,v39
CV v120,v32,v33
CV v121,v34,v35
CV v122,v36,v37
CV v123,v38,v39
M32 v[16:31],v[180:183],v[64:67],0
v_sub_f32 v40,v40,v167
EX v40,v40
v_sub_f32 v41,v41,v167
EX v41,v41
v_sub_f32 v42,v42,v167
EX v42,v42
v_sub_f32 v43,v43,v167
EX v43,v43
M32 v[96:111],v[136:139],v[120:123],v[96:111]
v_sub_f32 v44,v44,v167
EX v44,v44
v_sub_f32 v45,v45,v167
EX v45,v45
v_sub_f32 v46,v46,v167
EX v46,v46
v_sub_f32 v47,v47,v167
EX v47,v47
M2B v[0:31],v[184:185],v[72:73],v[0:31]
CV v124,v40,v41
CV v125,v42,v43
CV v126,v44,v45
CV v127,v46,v47
v_sub_f32 v48,v48,v167
EX v48,v48
v_sub_f32 v49,v49,v167
EX v49,v49
v_sub_f32 v50,v50,v167
EX v50,v50
v_sub_f32 v51,v51,v167
EX v51,v51
v_sub_f32 v52,v52,v167
EX v52,v52
v_sub_f32 v53,v53,v167
EX v53,v53
M32 v[96:111],v[140:143],v[124:127],v[96:111]
v_sub_f32 v54,v54,v167
EX v54,v54
v_sub_f32 v55,v55,v167
EX v55,v55
CV v128,v48,v49
CV v129,v50,v51
CV v130,v52,v53
CV v131,v54,v55
v_sub_f32 v56,v56,v167
EX v56,v56
v_sub_f32 v57,v57,v167
EX v57,v57
M32 v[96:111],v[144:147],v[128:131],v[96:111]
WT lgkmcnt(0)
v_sub_f32 v58,v58,v167
EX v58,v58
v_sub_f32 v59,v59,v167
EX v59,v59
v_sub_f32 v60,v60,v167
EX v60,v60
v_sub_f32 v61,v61,v167
EX v61,v61
v_sub_f32 v62,v62,v167
EX v62,v62
v_sub_f32 v63,v63,v167
EX v63,v63
CV v132,v56,v57
CV v133,v58,v59
CV v134,v60,v61
CV v135,v62,v63
s_mov_b32 m0,s21
s_nop 0
BL4 v213,s[24:27],s33 offen offset:2048 sc1 lds
s_mov_b32 m0,s21
s_nop 0
BL4 v214,s[24:27],s33 offen offset:3072 sc1 lds
v_sub_f32 v0,v0,v166
EX v0,v0
v_sub_f32 v1,v1,v166
EX v1,v1
M32 v[96:111],v[148:151],v[132:135],v[96:111]
R128 v[112:115],v152 offset:12288
v_sub_f32 v2,v2,v166
EX v2,v2
v_sub_f32 v3,v3,v166
EX v3,v3
v_sub_f32 v4,v4,v166
EX v4,v4
v_sub_f32 v5,v5,v166
EX v5,v5
M32 v[32:47],v[176:179],v[68:71],0
R128 v[116:119],v152 offset:13824
v_sub_f32 v6,v6,v166
EX v6,v6
v_sub_f32 v7,v7,v166
EX v7,v7
CV v120,v0,v1
CV v121,v2,v3
CV v122,v4,v5
CV v123,v6,v7
M32 v[48:63],v[180:183],v[68:71],0
ds_read_b64 v[78:79],v153 offset:12288
v_sub_f32 v8,v8,v166
EX v8,v8
v_sub_f32 v9,v9,v166
EX v9,v9
v_sub_f32 v10,v10,v166
EX v10,v10
v_sub_f32 v11,v11,v166
EX v11,v11
M32 v[80:95],v[188:191],v[120:123],v[80:95]
R128 v[136:139],v154 offset:11264
v_sub_f32 v12,v12,v166
EX v12,v12
v_sub_f32 v13,v13,v166
EX v13,v13
v_sub_f32 v14,v14,v166
EX v14,v14
v_sub_f32 v15,v15,v166
EX v15,v15
M2B v[32:63],v[184:185],v[74:75],v[32:63]
R128 v[140:143],v154 offset:11968
CV v124,v8,v9
CV v125,v10,v11
CV v126,v12,v13
CV v127,v14,v15
v_sub_f32 v16,v16,v166
EX v16,v16
v_sub_f32 v17,v17,v166
EX v17,v17
v_sub_f32 v18,v18,v166
EX v18,v18
v_sub_f32 v19,v19,v166
EX v19,v19
v_sub_f32 v20,v20,v166
EX v20,v20
v_sub_f32 v21,v21,v166
EX v21,v21
M32 v[80:95],v[192:195],v[124:127],v[80:95]
R128 v[144:147],v154 offset:12672
v_sub_f32 v22,v22,v166
EX v22,v22
v_sub_f32 v23,v23,v166
EX v23,v23
CV v128,v16,v17
CV v129,v18,v19
CV v130,v20,v21
CV v131,v22,v23
v_sub_f32 v24,v24,v166
EX v24,v24
v_sub_f32 v25,v25,v166
EX v25,v25
M32 v[80:95],v[196:199],v[128:131],v[80:95]
WT lgkmcnt(3)
v_sub_f32 v26,v26,v166
EX v26,v26
v_sub_f32 v27,v27,v166
EX v27,v27
v_sub_f32 v28,v28,v166
EX v28,v28
v_sub_f32 v29,v29,v166
EX v29,v29
v_sub_f32 v30,v30,v166
EX v30,v30
v_sub_f32 v31,v31,v166
EX v31,v31
CV v132,v24,v25
CV v133,v26,v27
CV v134,v28,v29
CV v135,v30,v31
v_sub_f32 v32,v32,v167
EX v32,v32
v_sub_f32 v33,v33,v167
EX v33,v33
M32 v[80:95],v[200:203],v[132:135],v[80:95]
R128 v[148:151],v154 offset:13376
v_sub_f32 v34,v34,v167
EX v34,v34
v_sub_f32 v35,v35,v167
EX v35,v35
v_sub_f32 v36,v36,v167
EX v36,v36
v_sub_f32 v37,v37,v167
EX v37,v37
M32 v[0:15],v[112:115],v[64:67],0
v_sub_f32 v38,v38,v167
EX v38,v38
v_sub_f32 v39,v39,v167
EX v39,v39
CV v120,v32,v33
CV v121,v34,v35
CV v122,v36,v37
CV v123,v38,v39
M32 v[16:31],v[116:119],v[64:67],0
v_sub_f32 v40,v40,v167
EX v40,v40
v_sub_f32 v41,v41,v167
EX v41,v41
v_sub_f32 v42,v42,v167
EX v42,v42
v_sub_f32 v43,v43,v167
EX v43,v43
M32 v[96:111],v[188:191],v[120:123],v[96:111]
v_sub_f32 v44,v44,v167
EX v44,v44
v_sub_f32 v45,v45,v167
EX v45,v45
v_sub_f32 v46,v46,v167
EX v46,v46
v_sub_f32 v47,v47,v167
EX v47,v47
M2B v[0:31],v[78:79],v[72:73],v[0:31]
CV v124,v40,v41
CV v125,v42,v43
CV v126,v44,v45
CV v127,v46,v47
v_sub_f32 v48,v48,v167
EX v48,v48
v_sub_f32 v49,v49,v167
EX v49,v49
v_sub_f32 v50,v50,v167
EX v50,v50
v_sub_f32 v51,v51,v167
EX v51,v51
v_sub_f32 v52,v52,v167
EX v52,v52
v_sub_f32 v53,v53,v167
EX v53,v53
M32 v[96:111],v[192:195],v[124:127],v[96:111]
v_sub_f32 v54,v54,v167
EX v54,v54
v_sub_f32 v55,v55,v167
EX v55,v55
CV v128,v48,v49
CV v129,v50,v51
CV v130,v52,v53
CV v131,v54,v55
v_sub_f32 v56,v56,v167
EX v56,v56
v_sub_f32 v57,v57,v167
EX v57,v57
M32 v[96:111],v[196:199],v[128:131],v[96:111]
WT lgkmcnt(0)
v_sub_f32 v58,v58,v167
EX v58,v58
v_sub_f32 v59,v59,v167
EX v59,v59
v_sub_f32 v60,v60,v167
EX v60,v60
v_sub_f32 v61,v61,v167
EX v61,v61
v_sub_f32 v62,v62,v167
EX v62,v62
v_sub_f32 v63,v63,v167
EX v63,v63
CV v132,v56,v57
CV v133,v58,v59
CV v134,v60,v61
CV v135,v62,v63
SADD m0,s21,4096
s_nop 0
BL4 v215,s[24:27],s33 offen sc1 lds
SADD m0,s21,4096
s_mov_b32 exec_hi,0
BL4 v216,s[24:27],s33 offen offset:1024 sc1 lds
s_mov_b32 exec_hi,-1
v_sub_f32 v0,v0,v166
EX v0,v0
v_sub_f32 v1,v1,v166
EX v1,v1
M32 v[96:111],v[200:203],v[132:135],v[96:111]
R128 v[176:179],v152 offset:15360
v_sub_f32 v2,v2,v166
EX v2,v2
v_sub_f32 v3,v3,v166
EX v3,v3
v_sub_f32 v4,v4,v166
EX v4,v4
v_sub_f32 v5,v5,v166
EX v5,v5
M32 v[32:47],v[112:115],v[68:71],0
R128 v[180:183],v152 offset:16896
v_sub_f32 v6,v6,v166
EX v6,v6
v_sub_f32 v7,v7,v166
EX v7,v7
CV v120,v0,v1
CV v121,v2,v3
CV v122,v4,v5
CV v123,v6,v7
M32 v[48:63],v[116:119],v[68:71],0
ds_read_b64 v[184:185],v153 offset:15360
v_sub_f32 v8,v8,v166
EX v8,v8
v_sub_f32 v9,v9,v166
EX v9,v9
v_sub_f32 v10,v10,v166
EX v10,v10
v_sub_f32 v11,v11,v166
EX v11,v11
M32 v[80:95],v[136:139],v[120:123],v[80:95]
R128 v[188:191],v154 offset:14080
v_sub_f32 v12,v12,v166
EX v12,v12
v_sub_f32 v13,v13,v166
EX v13,v13
v_sub_f32 v14,v14,v166
EX v14,v14
v_sub_f32 v15,v15,v166
EX v15,v15
M2B v[32:63],v[78:79],v[74:75],v[32:63]
R128 v[192:195],v154 offset:14784
CV v124,v8,v9
CV v125,v10,v11
CV v126,v12,v13
CV v127,v14,v15
v_sub_f32 v16,v16,v166
EX v16,v16
v_sub_f32 v17,v17,v166
EX v17,v17
v_sub_f32 v18,v18,v166
EX v18,v18
v_sub_f32 v19,v19,v166
EX v19,v19
v_sub_f32 v20,v20,v166
EX v20,v20
v_sub_f32 v21,v21,v166
EX v21,v21
M32 v[80:95],v[140:143],v[124:127],v[80:95]
R128 v[196:199],v154 offset:15488
v_sub_f32 v22,v22,v166
EX v22,v22
v_sub_f32 v23,v23,v166
EX v23,v23
CV v128,v16,v17
CV v129,v18,v19
CV v130,v20,v21
CV v131,v22,v23
v_sub_f32 v24,v24,v166
EX v24,v24
v_sub_f32 v25,v25,v166
EX v25,v25
M32 v[80:95],v[144:147],v[128:131],v[80:95]
WT lgkmcnt(3)
v_sub_f32 v26,v26,v166
EX v26,v26
v_sub_f32 v27,v27,v166
EX v27,v27
v_sub_f32 v28,v28,v166
EX v28,v28
v_sub_f32 v29,v29,v166
EX v29,v29
v_sub_f32 v30,v30,v166
EX v30,v30
v_sub_f32 v31,v31,v166
EX v31,v31
CV v132,v24,v25
CV v133,v26,v27
CV v134,v28,v29
CV v135,v30,v31
v_sub_f32 v32,v32,v167
EX v32,v32
v_sub_f32 v33,v33,v167
EX v33,v33
M32 v[80:95],v[148:151],v[132:135],v[80:95]
R128 v[200:203],v154 offset:16192
v_sub_f32 v34,v34,v167
EX v34,v34
v_sub_f32 v35,v35,v167
EX v35,v35
v_sub_f32 v36,v36,v167
EX v36,v36
v_sub_f32 v37,v37,v167
EX v37,v37
M32 v[0:15],v[176:179],v[64:67],0
v_sub_f32 v38,v38,v167
EX v38,v38
v_sub_f32 v39,v39,v167
EX v39,v39
CV v120,v32,v33
CV v121,v34,v35
CV v122,v36,v37
CV v123,v38,v39
M32 v[16:31],v[180:183],v[64:67],0
v_sub_f32 v40,v40,v167
EX v40,v40
v_sub_f32 v41,v41,v167
EX v41,v41
v_sub_f32 v42,v42,v167
EX v42,v42
v_sub_f32 v43,v43,v167
EX v43,v43
M32 v[96:111],v[136:139],v[120:123],v[96:111]
v_sub_f32 v44,v44,v167
EX v44,v44
v_sub_f32 v45,v45,v167
EX v45,v45
v_sub_f32 v46,v46,v167
EX v46,v46
v_sub_f32 v47,v47,v167
EX v47,v47
M2B v[0:31],v[184:185],v[72:73],v[0:31]
CV v124,v40,v41
CV v125,v42,v43
CV v126,v44,v45
CV v127,v46,v47
v_sub_f32 v48,v48,v167
EX v48,v48
v_sub_f32 v49,v49,v167
EX v49,v49
v_sub_f32 v50,v50,v167
EX v50,v50
v_sub_f32 v51,v51,v167
EX v51,v51
v_sub_f32 v52,v52,v167
EX v52,v52
v_sub_f32 v53,v53,v167
EX v53,v53
M32 v[96:111],v[140:143],v[124:127],v[96:111]
v_sub_f32 v54,v54,v167
EX v54,v54
v_sub_f32 v55,v55,v167
EX v55,v55
CV v128,v48,v49
CV v129,v50,v51
CV v130,v52,v53
CV v131,v54,v55
v_sub_f32 v56,v56,v167
EX v56,v56
v_sub_f32 v57,v57,v167
EX v57,v57
M32 v[96:111],v[144:147],v[128:131],v[96:111]
WT lgkmcnt(0)
v_sub_f32 v58,v58,v167
EX v58,v58
v_sub_f32 v59,v59,v167
EX v59,v59
v_sub_f32 v60,v60,v167
EX v60,v60
v_sub_f32 v61,v61,v167
EX v61,v61
v_sub_f32 v62,v62,v167
EX v62,v62
v_sub_f32 v63,v63,v167
EX v63,v63
CV v132,v56,v57
CV v133,v58,v59
CV v134,v60,v61
CV v135,v62,v63
v_sub_f32 v0,v0,v166
EX v0,v0
v_sub_f32 v1,v1,v166
EX v1,v1
M32 v[96:111],v[148:151],v[132:135],v[96:111]
R128 v[112:115],v152 offset:18432
v_sub_f32 v2,v2,v166
EX v2,v2
v_sub_f32 v3,v3,v166
EX v3,v3
v_sub_f32 v4,v4,v166
EX v4,v4
v_sub_f32 v5,v5,v166
EX v5,v5
M32 v[32:47],v[176:179],v[68:71],0
R128 v[116:119],v152 offset:19968
v_sub_f32 v6,v6,v166
EX v6,v6
v_sub_f32 v7,v7,v166
EX v7,v7
CV v120,v0,v1
CV v121,v2,v3
CV v122,v4,v5
CV v123,v6,v7
M32 v[48:63],v[180:183],v[68:71],0
ds_read_b64 v[78:79],v153 offset:18432
v_sub_f32 v8,v8,v166
EX v8,v8
v_sub_f32 v9,v9,v166
EX v9,v9
v_sub_f32 v10,v10,v166
EX v10,v10
v_sub_f32 v11,v11,v166
EX v11,v11
M32 v[80:95],v[188:191],v[120:123],v[80:95]
R128 v[136:139],v154 offset:16896
v_sub_f32 v12,v12,v166
EX v12,v12
v_sub_f32 v13,v13,v166
EX v13,v13
v_sub_f32 v14,v14,v166
EX v14,v14
v_sub_f32 v15,v15,v166
EX v15,v15
M2B v[32:63],v[184:185],v[74:75],v[32:63]
R128 v[140:143],v154 offset:17600
CV v124,v8,v9
CV v125,v10,v11
CV v126,v12,v13
CV v127,v14,v15
v_sub_f32 v16,v16,v166
EX v16,v16
v_sub_f32 v17,v17,v166
EX v17,v17
v_sub_f32 v18,v18,v166
EX v18,v18
v_sub_f32 v19,v19,v166
EX v19,v19
v_sub_f32 v20,v20,v166
EX v20,v20
v_sub_f32 v21,v21,v166
EX v21,v21
M32 v[80:95],v[192:195],v[124:127],v[80:95]
R128 v[144:147],v154 offset:18304
v_sub_f32 v22,v22,v166
EX v22,v22
v_sub_f32 v23,v23,v166
EX v23,v23
CV v128,v16,v17
CV v129,v18,v19
CV v130,v20,v21
CV v131,v22,v23
v_sub_f32 v24,v24,v166
EX v24,v24
v_sub_f32 v25,v25,v166
EX v25,v25
M32 v[80:95],v[196:199],v[128:131],v[80:95]
WT lgkmcnt(3)
v_sub_f32 v26,v26,v166
EX v26,v26
v_sub_f32 v27,v27,v166
EX v27,v27
v_sub_f32 v28,v28,v166
EX v28,v28
v_sub_f32 v29,v29,v166
EX v29,v29
v_sub_f32 v30,v30,v166
EX v30,v30
v_sub_f32 v31,v31,v166
EX v31,v31
CV v132,v24,v25
CV v133,v26,v27
CV v134,v28,v29
CV v135,v30,v31
v_sub_f32 v32,v32,v167
EX v32,v32
v_sub_f32 v33,v33,v167
EX v33,v33
M32 v[80:95],v[200:203],v[132:135],v[80:95]
R128 v[148:151],v154 offset:19008
v_sub_f32 v34,v34,v167
EX v34,v34
v_sub_f32 v35,v35,v167
EX v35,v35
v_sub_f32 v36,v36,v167
EX v36,v36
v_sub_f32 v37,v37,v167
EX v37,v37
M32 v[0:15],v[112:115],v[64:67],0
v_sub_f32 v38,v38,v167
EX v38,v38
v_sub_f32 v39,v39,v167
EX v39,v39
CV v120,v32,v33
CV v121,v34,v35
CV v122,v36,v37
CV v123,v38,v39
M32 v[16:31],v[116:119],v[64:67],0
v_sub_f32 v40,v40,v167
EX v40,v40
v_sub_f32 v41,v41,v167
EX v41,v41
v_sub_f32 v42,v42,v167
EX v42,v42
v_sub_f32 v43,v43,v167
EX v43,v43
M32 v[96:111],v[188:191],v[120:123],v[96:111]
v_sub_f32 v44,v44,v167
EX v44,v44
v_sub_f32 v45,v45,v167
EX v45,v45
v_sub_f32 v46,v46,v167
EX v46,v46
v_sub_f32 v47,v47,v167
EX v47,v47
M2B v[0:31],v[78:79],v[72:73],v[0:31]
CV v124,v40,v41
CV v125,v42,v43
CV v126,v44,v45
CV v127,v46,v47
v_sub_f32 v48,v48,v167
EX v48,v48
v_sub_f32 v49,v49,v167
EX v49,v49
v_sub_f32 v50,v50,v167
EX v50,v50
v_sub_f32 v51,v51,v167
EX v51,v51
v_sub_f32 v52,v52,v167
EX v52,v52
v_sub_f32 v53,v53,v167
EX v53,v53
M32 v[96:111],v[192:195],v[124:127],v[96:111]
v_sub_f32 v54,v54,v167
EX v54,v54
v_sub_f32 v55,v55,v167
EX v55,v55
CV v128,v48,v49
CV v129,v50,v51
CV v130,v52,v53
CV v131,v54,v55
v_sub_f32 v56,v56,v167
EX v56,v56
v_sub_f32 v57,v57,v167
EX v57,v57
M32 v[96:111],v[196:199],v[128:131],v[96:111]
WT lgkmcnt(0)
v_sub_f32 v58,v58,v167
EX v58,v58
v_sub_f32 v59,v59,v167
EX v59,v59
v_sub_f32 v60,v60,v167
EX v60,v60
v_sub_f32 v61,v61,v167
EX v61,v61
v_sub_f32 v62,v62,v167
EX v62,v62
v_sub_f32 v63,v63,v167
EX v63,v63
CV v132,v56,v57
CV v133,v58,v59
CV v134,v60,v61
CV v135,v62,v63
v_sub_f32 v0,v0,v166
EX v0,v0
v_sub_f32 v1,v1,v166
EX v1,v1
M32 v[96:111],v[200:203],v[132:135],v[96:111]
R128 v[176:179],v152 offset:21504
v_sub_f32 v2,v2,v166
EX v2,v2
v_sub_f32 v3,v3,v166
EX v3,v3
v_sub_f32 v4,v4,v166
EX v4,v4
v_sub_f32 v5,v5,v166
EX v5,v5
M32 v[32:47],v[112:115],v[68:71],0
R128 v[180:183],v152 offset:23040
v_sub_f32 v6,v6,v166
EX v6,v6
v_sub_f32 v7,v7,v166
EX v7,v7
CV v120,v0,v1
CV v121,v2,v3
CV v122,v4,v5
CV v123,v6,v7
M32 v[48:63],v[116:119],v[68:71],0
ds_read_b64 v[184:185],v153 offset:21504
v_sub_f32 v8,v8,v166
EX v8,v8
v_sub_f32 v9,v9,v166
EX v9,v9
v_sub_f32 v10,v10,v166
EX v10,v10
v_sub_f32 v11,v11,v166
EX v11,v11
M32 v[80:95],v[136:139],v[120:123],v[80:95]
R128 v[188:191],v154 offset:19712
v_sub_f32 v12,v12,v166
EX v12,v12
v_sub_f32 v13,v13,v166
EX v13,v13
v_sub_f32 v14,v14,v166
EX v14,v14
v_sub_f32 v15,v15,v166
EX v15,v15
M2B v[32:63],v[78:79],v[74:75],v[32:63]
R128 v[192:195],v154 offset:20416
CV v124,v8,v9
CV v125,v10,v11
CV v126,v12,v13
CV v127,v14,v15
v_sub_f32 v16,v16,v166
EX v16,v16
v_sub_f32 v17,v17,v166
EX v17,v17
v_sub_f32 v18,v18,v166
EX v18,v18
v_sub_f32 v19,v19,v166
EX v19,v19
v_sub_f32 v20,v20,v166
EX v20,v20
v_sub_f32 v21,v21,v166
EX v21,v21
M32 v[80:95],v[140:143],v[124:127],v[80:95]
R128 v[196:199],v154 offset:21120
v_sub_f32 v22,v22,v166
EX v22,v22
v_sub_f32 v23,v23,v166
EX v23,v23
CV v128,v16,v17
CV v129,v18,v19
CV v130,v20,v21
CV v131,v22,v23
v_sub_f32 v24,v24,v166
EX v24,v24
v_sub_f32 v25,v25,v166
EX v25,v25
M32 v[80:95],v[144:147],v[128:131],v[80:95]
WT lgkmcnt(3)
v_sub_f32 v26,v26,v166
EX v26,v26
v_sub_f32 v27,v27,v166
EX v27,v27
v_sub_f32 v28,v28,v166
EX v28,v28
v_sub_f32 v29,v29,v166
EX v29,v29
v_sub_f32 v30,v30,v166
EX v30,v30
v_sub_f32 v31,v31,v166
EX v31,v31
CV v132,v24,v25
CV v133,v26,v27
CV v134,v28,v29
CV v135,v30,v31
v_sub_f32 v32,v32,v167
EX v32,v32
v_sub_f32 v33,v33,v167
EX v33,v33
M32 v[80:95],v[148:151],v[132:135],v[80:95]
R128 v[200:203],v154 offset:21824
v_sub_f32 v34,v34,v167
EX v34,v34
v_sub_f32 v35,v35,v167
EX v35,v35
v_sub_f32 v36,v36,v167
EX v36,v36
v_sub_f32 v37,v37,v167
EX v37,v37
M32 v[0:15],v[176:179],v[64:67],0
v_sub_f32 v38,v38,v167
EX v38,v38
v_sub_f32 v39,v39,v167
EX v39,v39
CV v120,v32,v33
CV v121,v34,v35
CV v122,v36,v37
CV v123,v38,v39
M32 v[16:31],v[180:183],v[64:67],0
v_sub_f32 v40,v40,v167
EX v40,v40
v_sub_f32 v41,v41,v167
EX v41,v41
v_sub_f32 v42,v42,v167
EX v42,v42
v_sub_f32 v43,v43,v167
EX v43,v43
M32 v[96:111],v[136:139],v[120:123],v[96:111]
v_sub_f32 v44,v44,v167
EX v44,v44
v_sub_f32 v45,v45,v167
EX v45,v45
v_sub_f32 v46,v46,v167
EX v46,v46
v_sub_f32 v47,v47,v167
EX v47,v47
M2B v[0:31],v[184:185],v[72:73],v[0:31]
CV v124,v40,v41
CV v125,v42,v43
CV v126,v44,v45
CV v127,v46,v47
v_sub_f32 v48,v48,v167
EX v48,v48
v_sub_f32 v49,v49,v167
EX v49,v49
v_sub_f32 v50,v50,v167
EX v50,v50
v_sub_f32 v51,v51,v167
EX v51,v51
v_sub_f32 v52,v52,v167
EX v52,v52
v_sub_f32 v53,v53,v167
EX v53,v53
M32 v[96:111],v[140:143],v[124:127],v[96:111]
v_sub_f32 v54,v54,v167
EX v54,v54
v_sub_f32 v55,v55,v167
EX v55,v55
CV v128,v48,v49
CV v129,v50,v51
CV v130,v52,v53
CV v131,v54,v55
v_sub_f32 v56,v56,v167
EX v56,v56
v_sub_f32 v57,v57,v167
EX v57,v57
M32 v[96:111],v[144:147],v[128:131],v[96:111]
WT lgkmcnt(0)
v_sub_f32 v58,v58,v167
EX v58,v58
v_sub_f32 v59,v59,v167
EX v59,v59
v_sub_f32 v60,v60,v167
EX v60,v60
v_sub_f32 v61,v61,v167
EX v61,v61
v_sub_f32 v62,v62,v167
EX v62,v62
v_sub_f32 v63,v63,v167
EX v63,v63
CV v132,v56,v57
CV v133,v58,v59
CV v134,v60,v61
CV v135,v62,v63
WT vmcnt(0)
s_barrier
SADD s9,s32,47104
s_cmp_eq_u32 s9,141312
s_cselect_b32 s9,0,s9
s_sub_u32 s20,s9,s32
s_mov_b32 s32,s9
v_add_u32 v152,s20,v152
v_add_u32 v153,s20,v153
v_add_u32 v154,s20,v154
s_mul_i32 s7,s13,655360
SADD s7,s7,s11
s_mul_i32 s33,s13,663552
SADD s33,s33,s12
s_cmp_eq_u32 s15,0
s_cselect_b32 s7,0x7ff00000,s7
s_cselect_b32 s33,0x7ff00000,s33
SADD s34,s7,81920
SADD s8,s14,s22
SADD s21,s14,s23
SADD s13,s13,1
s_and_b32 s13,s13,3
SADD s14,s14,47104
s_cmp_eq_u32 s14,141312
s_cselect_b32 s14,0,s14
s_cmp_lg_u32 s15,0
s_subb_u32 s15,s15,0
SADD m0,s8,0
s_nop 0
BL4 v208,s[24:27],s7 offen sc1 lds
SADD m0,s8,1024
s_nop 0
BL4 v209,s[24:27],s7 offen sc1 lds
v_sub_f32 v0,v0,v166
EX v0,v0
v_sub_f32 v1,v1,v166
EX v1,v1
M32 v[96:111],v[148:151],v[132:135],v[96:111]
R128 v[112:115],v152 offset:0
v_sub_f32 v2,v2,v166
EX v2,v2
v_sub_f32 v3,v3,v166
EX v3,v3
v_sub_f32 v4,v4,v166
EX v4,v4
v_sub_f32 v5,v5,v166
EX v5,v5
M32 v[32:47],v[176:179],v[68:71],0
R128 v[116:119],v152 offset:1536
v_sub_f32 v6,v6,v166
EX v6,v6
v_sub_f32 v7,v7,v166
EX v7,v7
CV v120,v0,v1
CV v121,v2,v3
CV v122,v4,v5
CV v123,v6,v7
M32 v[48:63],v[180:183],v[68:71],0
ds_read_b64 v[78:79],v153 offset:0
v_sub_f32 v8,v8,v166
EX v8,v8
v_sub_f32 v9,v9,v166
EX v9,v9
v_sub_f32 v10,v10,v166
EX v10,v10
v_sub_f32 v11,v11,v166
EX v11,v11
M32 v[80:95],v[188:191],v[120:123],v[80:95]
R128 v[136:139],v154 offset:0
v_sub_f32 v12,v12,v166
EX v12,v12
v_sub_f32 v13,v13,v166
EX v13,v13
v_sub_f32 v14,v14,v166
EX v14,v14
v_sub_f32 v15,v15,v166
EX v15,v15
M2B v[32:63],v[184:185],v[74:75],v[32:63]
R128 v[140:143],v154 offset:704
CV v124,v8,v9
CV v125,v10,v11
CV v126,v12,v13
CV v127,v14,v15
v_sub_f32 v16,v16,v166
EX v16,v16
v_sub_f32 v17,v17,v166
EX v17,v17
v_sub_f32 v18,v18,v166
EX v18,v18
v_sub_f32 v19,v19,v166
EX v19,v19
v_sub_f32 v20,v20,v166
EX v20,v20
v_sub_f32 v21,v21,v166
EX v21,v21
M32 v[80:95],v[192:195],v[124:127],v[80:95]
R128 v[144:147],v154 offset:1408
v_sub_f32 v22,v22,v166
EX v22,v22
v_sub_f32 v23,v23,v166
EX v23,v23
CV v128,v16,v17
CV v129,v18,v19
CV v130,v20,v21
CV v131,v22,v23
v_sub_f32 v24,v24,v166
EX v24,v24
v_sub_f32 v25,v25,v166
EX v25,v25
M32 v[80:95],v[196:199],v[128:131],v[80:95]
WT lgkmcnt(3)
v_sub_f32 v26,v26,v166
EX v26,v26
v_sub_f32 v27,v27,v166
EX v27,v27
v_sub_f32 v28,v28,v166
EX v28,v28
v_sub_f32 v29,v29,v166
EX v29,v29
v_sub_f32 v30,v30,v166
EX v30,v30
v_sub_f32 v31,v31,v166
EX v31,v31
CV v132,v24,v25
CV v133,v26,v27
CV v134,v28,v29
CV v135,v30,v31
v_sub_f32 v32,v32,v167
EX v32,v32
v_sub_f32 v33,v33,v167
EX v33,v33
M32 v[80:95],v[200:203],v[132:135],v[80:95]
R128 v[148:151],v154 offset:2112
v_sub_f32 v34,v34,v167
EX v34,v34
v_sub_f32 v35,v35,v167
EX v35,v35
v_sub_f32 v36,v36,v167
EX v36,v36
v_sub_f32 v37,v37,v167
EX v37,v37
M32 v[0:15],v[112:115],v[64:67],0
v_sub_f32 v38,v38,v167
EX v38,v38
v_sub_f32 v39,v39,v167
EX v39,v39
CV v120,v32,v33
CV v121,v34,v35
CV v122,v36,v37
CV v123,v38,v39
M32 v[16:31],v[116:119],v[64:67],0
v_sub_f32 v40,v40,v167
EX v40,v40
v_sub_f32 v41,v41,v167
EX v41,v41
v_sub_f32 v42,v42,v167
EX v42,v42
v_sub_f32 v43,v43,v167
EX v43,v43
M32 v[96:111],v[188:191],v[120:123],v[96:111]
v_sub_f32 v44,v44,v167
EX v44,v44
v_sub_f32 v45,v45,v167
EX v45,v45
v_sub_f32 v46,v46,v167
EX v46,v46
v_sub_f32 v47,v47,v167
EX v47,v47
M2B v[0:31],v[78:79],v[72:73],v[0:31]
CV v124,v40,v41
CV v125,v42,v43
CV v126,v44,v45
CV v127,v46,v47
v_sub_f32 v48,v48,v167
EX v48,v48
v_sub_f32 v49,v49,v167
EX v49,v49
v_sub_f32 v50,v50,v167
EX v50,v50
v_sub_f32 v51,v51,v167
EX v51,v51
v_sub_f32 v52,v52,v167
EX v52,v52
v_sub_f32 v53,v53,v167
EX v53,v53
M32 v[96:111],v[192:195],v[124:127],v[96:111]
v_sub_f32 v54,v54,v167
EX v54,v54
v_sub_f32 v55,v55,v167
EX v55,v55
CV v128,v48,v49
CV v129,v50,v51
CV v130,v52,v53
CV v131,v54,v55
v_sub_f32 v56,v56,v167
EX v56,v56
v_sub_f32 v57,v57,v167
EX v57,v57
M32 v[96:111],v[196:199],v[128:131],v[96:111]
WT lgkmcnt(0)
v_sub_f32 v58,v58,v167
EX v58,v58
v_sub_f32 v59,v59,v167
EX v59,v59
v_sub_f32 v60,v60,v167
EX v60,v60
v_sub_f32 v61,v61,v167
EX v61,v61
v_sub_f32 v62,v62,v167
EX v62,v62
v_sub_f32 v63,v63,v167
EX v63,v63
CV v132,v56,v57
CV v133,v58,v59
CV v134,v60,v61
CV v135,v62,v63
s_sub_u32 s17,s17,1
s_cmp_lg_u32 s17,0
s_cbranch_scc1 ATs_loop
s_nop 1
M32 v[96:111],v[200:203],v[132:135],v[96:111]
s_nop 11
s_mov_b32 s19,0
WT vmcnt(0)
s_barrier
s_branch AT_fin
HELP:
v_add_u32 v206,4096,v204
s_mul_i32 s35,s41,110592
s_mul_i32 s9,s31,27648
SADD s35,s35,s9
SADD s35,s35,8126464
s_mul_i32 s36,s42,552960
s_mul_i32 s9,s31,138240
SADD s36,s36,s9
SADD s36,s36,17825792
s_mov_b32 s54,0
WT vmcnt(2)
s_barrier
s_mov_b32 s52,0
HP_full:
buffer_load_dword v244,v235,s[24:27],0 offen sc1
buffer_load_dword v245,v236,s[24:27],0 offen sc1
WT vmcnt(0)
s_mov_b64 s[94:95],0
v_cmp_ne_u32 vcc,0x5ca1ab1e,v244
s_nop 3
s_and_b32 vcc_lo,vcc_lo,0xffffffff
s_and_b32 vcc_hi,vcc_hi,0xffffffff
s_or_b64 s[94:95],s[94:95],vcc
v_cmp_ne_u32 vcc,0x5ca1ab1e,v245
s_nop 3
s_and_b32 vcc_lo,vcc_lo,0xffffffff
s_and_b32 vcc_hi,vcc_hi,0xffff
s_or_b64 s[94:95],s[94:95],vcc
s_cmp_eq_u64 s[94:95],0
s_cbranch_scc1 HP_full_ok
SADD s52,s52,1
s_cmp_lt_u32 s52,200000
s_cbranch_scc0 HP_full_ok
s_sleep 2
s_branch HP_full
HP_full_ok:
v_mov_b32 v240,0x5ca1ab1e
v_mov_b32 v241,s91
s_mov_b64 exec,1
buffer_store_dword v240,v241,s[24:27],0 offen sc1
s_mov_b64 exec,-1
s_mul_i32 s9,s4,20
SADD s10,s9,19
s_lshr_b32 s9,s9,5
s_lshr_b32 s10,s10,5
s_lshl_b32 s9,s9,8
s_lshl_b32 s10,s10,8
SADD s9,s9,20856832
SADD s10,s10,20856832
SHL v240,2,v205
buffer_load_dword v244,v240,s[24:27],s9 offen sc1
buffer_load_dword v245,v240,s[24:27],s10 offen sc1
s_mul_i32 s7,s13,655360
SADD s7,s7,s11
s_mul_i32 s33,s13,663552
SADD s33,s33,s12
s_cmp_eq_u32 s15,0
s_cselect_b32 s7,0x7ff00000,s7
s_cselect_b32 s33,0x7ff00000,s33
SADD s34,s7,81920
SADD s8,s14,s22
SADD s21,s14,s23
SADD s13,s13,1
s_and_b32 s13,s13,3
SADD s14,s14,47104
s_cmp_eq_u32 s14,141312
s_cselect_b32 s14,0,s14
s_cmp_lg_u32 s15,0
s_subb_u32 s15,s15,0
SADD m0,s8,0
s_nop 0
BL4 v192,s[24:27],s7 offen sc1 lds
SADD m0,s8,1024
s_nop 0
BL4 v193,s[24:27],s7 offen sc1 lds
SADD m0,s8,2048
s_nop 0
BL4 v194,s[24:27],s7 offen sc1 lds
SADD m0,s8,3072
s_nop 0
BL4 v192,s[24:27],s34 offen sc1 lds
SADD m0,s8,4096
s_nop 0
BL4 v193,s[24:27],s34 offen sc1 lds
SADD m0,s8,5120
s_nop 0
BL4 v194,s[24:27],s34 offen sc1 lds
s_mov_b32 m0,s21
s_nop 0
BL4 v195,s[24:27],s33 offen sc1 lds
s_mov_b32 m0,s21
s_nop 0
BL4 v196,s[24:27],s33 offen offset:1024 sc1 lds
s_mov_b32 m0,s21
s_nop 0
BL4 v197,s[24:27],s33 offen offset:2048 sc1 lds
s_mov_b32 m0,s21
s_nop 0
BL4 v198,s[24:27],s33 offen offset:3072 sc1 lds
SADD m0,s21,4096
s_nop 0
BL4 v199,s[24:27],s33 offen sc1 lds
SADD m0,s21,4096
s_mov_b32 exec_hi,0
BL4 v200,s[24:27],s33 offen offset:1024 sc1 lds
s_mov_b32 exec_hi,-1
v_mov_b32 v241,141312
R128 v[248:251],v241
WT vmcnt(12)
v_max_f32 v244,v244,v245
s_nop 1
v_max_f32_dpp v244,v244,v244 row_shr:1 row_mask:0xf bank_mask:0xf bound_ctrl:0
s_nop 1
v_max_f32_dpp v244,v244,v244 row_shr:2 row_mask:0xf bank_mask:0xf bound_ctrl:0
s_nop 1
v_max_f32_dpp v244,v244,v244 row_shr:4 row_mask:0xf bank_mask:0xf bound_ctrl:0
s_nop 1
v_max_f32_dpp v244,v244,v244 row_shr:8 row_mask:0xf bank_mask:0xf bound_ctrl:0
s_nop 1
v_max_f32_dpp v244,v244,v244 row_bcast:15 row_mask:0xa bank_mask:0xf
s_nop 1
v_max_f32_dpp v244,v244,v244 row_bcast:31 row_mask:0xc bank_mask:0xf
s_nop 0
v_readlane_b32 s9,v244,63
WT lgkmcnt(0)
v_max3_f32 v248,v248,v249,v250
v_max_f32 v248,v248,v251
MUL v248,s9,v248
v_mov_b32 v249,0x442ec1dd
v_cmp_nle_f32 vcc,v248,v249
v_mov_b32 v250,0
v_mov_b32 v251,1
v_cndmask_b32 v250,v250,v251,vcc
v_mov_b32 v241,141328
ds_write_b32 v241,v250
WT lgkmcnt(0)
WT vmcnt(0)
s_barrier
v_mov_b32 v241,141328
ds_read_b32 v240,v241
WT lgkmcnt(0)
v_readfirstlane_b32 s9,v240
s_nop 3
s_cmp_eq_u32 s9,0
s_cbranch_scc0 HP_slow0
s_mul_i32 s7,s13,655360
SADD s7,s7,s11
s_mul_i32 s33,s13,663552
SADD s33,s33,s12
s_cmp_eq_u32 s15,0
s_cselect_b32 s7,0x7ff00000,s7
s_cselect_b32 s33,0x7ff00000,s33
SADD s34,s7,81920
SADD s8,s14,s22
SADD s21,s14,s23
SADD s13,s13,1
s_and_b32 s13,s13,3
SADD s14,s14,47104
s_cmp_eq_u32 s14,141312
s_cselect_b32 s14,0,s14
s_cmp_lg_u32 s15,0
s_subb_u32 s15,s15,0
SADD m0,s8,0
s_nop 0
BL4 v192,s[24:27],s7 offen sc1 lds
SADD m0,s8,1024
s_nop 0
BL4 v193,s[24:27],s7 offen sc1 lds
SADD m0,s8,2048
s_nop 0
BL4 v194,s[24:27],s7 offen sc1 lds
SADD m0,s8,3072
s_nop 0
BL4 v192,s[24:27],s34 offen sc1 lds
SADD m0,s8,4096
s_nop 0
BL4 v193,s[24:27],s34 offen sc1 lds
SADD m0,s8,5120
s_nop 0
BL4 v194,s[24:27],s34 offen sc1 lds
s_mov_b32 m0,s21
s_nop 0
BL4 v195,s[24:27],s33 offen sc1 lds
s_mov_b32 m0,s21
s_nop 0
BL4 v196,s[24:27],s33 offen offset:1024 sc1 lds
s_mov_b32 m0,s21
s_nop 0
BL4 v197,s[24:27],s33 offen offset:2048 sc1 lds
s_mov_b32 m0,s21
s_nop 0
BL4 v198,s[24:27],s33 offen offset:3072 sc1 lds
SADD m0,s21,4096
s_nop 0
BL4 v199,s[24:27],s33 offen sc1 lds
SADD m0,s21,4096
s_mov_b32 exec_hi,0
BL4 v200,s[24:27],s33 offen offset:1024 sc1 lds
s_mov_b32 exec_hi,-1
s_lshr_b32 s9,s41,2
s_lshl_b32 s9,s9,9
SADD s9,s9,23463936
SHL v242,2,v205
v_add_u32 v242,s9,v242
v_add_u32 v243,256,v242
s_mov_b32 s52,0
HPa_fh:
buffer_load_dword v244,v242,s[24:27],0 offen sc1
buffer_load_dword v245,v243,s[24:27],0 offen sc1
WT vmcnt(0)
s_mov_b64 s[94:95],0
v_cmp_ne_u32 vcc,0x5ca1ab1e,v244
s_nop 3
s_and_b32 vcc_lo,vcc_lo,0xffffffff
s_and_b32 vcc_hi,vcc_hi,0xffffffff
s_or_b64 s[94:95],s[94:95],vcc
v_cmp_ne_u32 vcc,0x5ca1ab1e,v245
s_nop 3
s_and_b32 vcc_lo,vcc_lo,0xffffffff
s_and_b32 vcc_hi,vcc_hi,0xffffff
s_or_b64 s[94:95],s[94:95],vcc
s_cmp_eq_u64 s[94:95],0
s_cbranch_scc1 HPa_fh_ok
SADD s52,s52,1
s_cmp_lt_u32 s52,200000
s_cbranch_scc0 HPa_fh_ok
s_sleep 2
s_branch HPa_fh
HPa_fh_ok:
BL4 v[140:143],v204,s[24:27],s35 offen sc1
BL4 v[80:83],v204,s[24:27],s36 offen sc1
BL4 v[84:87],v204,s[24:27],s36 offen offset:1024 sc1
BL4 v[88:91],v204,s[24:27],s36 offen offset:2048 sc1
BL4 v[92:95],v204,s[24:27],s36 offen offset:3072 sc1
BL4 v[96:99],v206,s[24:27],s36 offen sc1
SADD s35,s35,1024
SADD s36,s36,5120
BL4 v[144:147],v204,s[24:27],s35 offen sc1
BL4 v[100:103],v204,s[24:27],s36 offen sc1
BL4 v[104:107],v204,s[24:27],s36 offen offset:1024 sc1
BL4 v[108:111],v204,s[24:27],s36 offen offset:2048 sc1
BL4 v[112:115],v204,s[24:27],s36 offen offset:3072 sc1
BL4 v[116:119],v206,s[24:27],s36 offen sc1
SADD s35,s35,1024
SADD s36,s36,5120
BL4 v[148:151],v204,s[24:27],s35 offen sc1
BL4 v[120:123],v204,s[24:27],s36 offen sc1
BL4 v[124:127],v204,s[24:27],s36 offen offset:1024 sc1
BL4 v[128:131],v204,s[24:27],s36 offen offset:2048 sc1
BL4 v[132:135],v204,s[24:27],s36 offen offset:3072 sc1
BL4 v[136:139],v206,s[24:27],s36 offen sc1
SADD s35,s35,1024
SADD s36,s36,5120
WT vmcnt(12)
M32 v[0:15],v[80:83],v[140:143],0
M32 v[16:31],v[84:87],v[140:143],0
M32 v[32:47],v[88:91],v[140:143],0
M32 v[48:63],v[92:95],v[140:143],0
M32 v[64:79],v[96:99],v[140:143],0
BL4 v[152:155],v204,s[24:27],s35 offen sc1
BL4 v[160:163],v204,s[24:27],s36 offen sc1
BL4 v[164:167],v204,s[24:27],s36 offen offset:1024 sc1
BL4 v[168:171],v204,s[24:27],s36 offen offset:2048 sc1
BL4 v[172:175],v204,s[24:27],s36 offen offset:3072 sc1
BL4 v[176:179],v206,s[24:27],s36 offen sc1
SADD s35,s35,1024
SADD s36,s36,5120
WT vmcnt(12)
M32 v[0:15],v[100:103],v[144:147],v[0:15]
M32 v[16:31],v[104:107],v[144:147],v[16:31]
M32 v[32:47],v[108:111],v[144:147],v[32:47]
M32 v[48:63],v[112:115],v[144:147],v[48:63]
M32 v[64:79],v[116:119],v[144:147],v[64:79]
BL4 v[140:143],v204,s[24:27],s35 offen sc1
BL4 v[80:83],v204,s[24:27],s36 offen sc1
BL4 v[84:87],v204,s[24:27],s36 offen offset:1024 sc1
BL4 v[88:91],v204,s[24:27],s36 offen offset:2048 sc1
BL4 v[92:95],v204,s[24:27],s36 offen offset:3072 sc1
BL4 v[96:99],v206,s[24:27],s36 offen sc1
SADD s35,s35,1024
SADD s36,s36,5120
WT vmcnt(12)
M32 v[0:15],v[120:123],v[148:151],v[0:15]
M32 v[16:31],v[124:127],v[148:151],v[16:31]
M32 v[32:47],v[128:131],v[148:151],v[32:47]
M32 v[48:63],v[132:135],v[148:151],v[48:63]
M32 v[64:79],v[136:139],v[148:151],v[64:79]
BL4 v[144:147],v204,s[24:27],s35 offen sc1
BL4 v[100:103],v204,s[24:27],s36 offen sc1
BL4 v[104:107],v204,s[24:27],s36 offen offset:1024 sc1
BL4 v[108:111],v204,s[24:27],s36 offen offset:2048 sc1
BL4 v[112:115],v204,s[24:27],s36 offen offset:3072 sc1
BL4 v[116:119],v206,s[24:27],s36 offen sc1
SADD s35,s35,1024
SADD s36,s36,5120
WT vmcnt(12)
M32 v[0:15],v[160:163],v[152:155],v[0:15]
M32 v[16:31],v[164:167],v[152:155],v[16:31]
M32 v[32:47],v[168:171],v[152:155],v[32:47]
M32 v[48:63],v[172:175],v[152:155],v[48:63]
M32 v[64:79],v[176:179],v[152:155],v[64:79]
BL4 v[148:151],v204,s[24:27],s35 offen sc1
BL4 v[120:123],v204,s[24:27],s36 offen sc1
BL4 v[124:127],v204,s[24:27],s36 offen offset:1024 sc1
BL4 v[128:131],v204,s[24:27],s36 offen offset:2048 sc1
BL4 v[132:135],v204,s[24:27],s36 offen offset:3072 sc1
BL4 v[136:139],v206,s[24:27],s36 offen sc1
SADD s35,s35,1024
SADD s36,s36,5120
WT vmcnt(12)
M32 v[0:15],v[80:83],v[140:143],v[0:15]
M32 v[16:31],v[84:87],v[140:143],v[16:31]
M32 v[32:47],v[88:91],v[140:143],v[32:47]
M32 v[48:63],v[92:95],v[140:143],v[48:63]
M32 v[64:79],v[96:99],v[140:143],v[64:79]
BL4 v[152:155],v204,s[24:27],s35 offen sc1
BL4 v[160:163],v204,s[24:27],s36 offen sc1
BL4 v[164:167],v204,s[24:27],s36 offen offset:1024 sc1
BL4 v[168:171],v204,s[24:27],s36 offen offset:2048 sc1
BL4 v[172:175],v204,s[24:27],s36 offen offset:3072 sc1
BL4 v[176:179],v206,s[24:27],s36 offen sc1
SADD s35,s35,1024
SADD s36,s36,5120
WT vmcnt(12)
M32 v[0:15],v[100:103],v[144:147],v[0:15]
M32 v[16:31],v[104:107],v[144:147],v[16:31]
M32 v[32:47],v[108:111],v[144:147],v[32:47]
M32 v[48:63],v[112:115],v[144:147],v[48:63]
M32 v[64:79],v[116:119],v[144:147],v[64:79]
BL4 v[140:143],v204,s[24:27],s35 offen sc1
BL4 v[80:83],v204,s[24:27],s36 offen sc1
BL4 v[84:87],v204,s[24:27],s36 offen offset:1024 sc1
BL4 v[88:91],v204,s[24:27],s36 offen offset:2048 sc1
BL4 v[92:95],v204,s[24:27],s36 offen offset:3072 sc1
BL4 v[96:99],v206,s[24:27],s36 offen sc1
SADD s35,s35,1024
SADD s36,s36,5120
WT vmcnt(12)
M32 v[0:15],v[120:123],v[148:151],v[0:15]
M32 v[16:31],v[124:127],v[148:151],v[16:31]
M32 v[32:47],v[128:131],v[148:151],v[32:47]
M32 v[48:63],v[132:135],v[148:151],v[48:63]
M32 v[64:79],v[136:139],v[148:151],v[64:79]
BL4 v[144:147],v204,s[24:27],s35 offen sc1
BL4 v[100:103],v204,s[24:27],s36 offen sc1
BL4 v[104:107],v204,s[24:27],s36 offen offset:1024 sc1
BL4 v[108:111],v204,s[24:27],s36 offen offset:2048 sc1
BL4 v[112:115],v204,s[24:27],s36 offen offset:3072 sc1
BL4 v[116:119],v206,s[24:27],s36 offen sc1
SADD s35,s35,1024
SADD s36,s36,5120
WT vmcnt(12)
M32 v[0:15],v[160:163],v[152:155],v[0:15]
M32 v[16:31],v[164:167],v[152:155],v[16:31]
M32 v[32:47],v[168:171],v[152:155],v[32:47]
M32 v[48:63],v[172:175],v[152:155],v[48:63]
M32 v[64:79],v[176:179],v[152:155],v[64:79]
BL4 v[148:151],v204,s[24:27],s35 offen sc1
BL4 v[120:123],v204,s[24:27],s36 offen sc1
BL4 v[124:127],v204,s[24:27],s36 offen offset:1024 sc1
BL4 v[128:131],v204,s[24:27],s36 offen offset:2048 sc1
BL4 v[132:135],v204,s[24:27],s36 offen offset:3072 sc1
BL4 v[136:139],v206,s[24:27],s36 offen sc1
SADD s35,s35,1024
SADD s36,s36,5120
WT vmcnt(12)
M32 v[0:15],v[80:83],v[140:143],v[0:15]
M32 v[16:31],v[84:87],v[140:143],v[16:31]
M32 v[32:47],v[88:91],v[140:143],v[32:47]
M32 v[48:63],v[92:95],v[140:143],v[48:63]
M32 v[64:79],v[96:99],v[140:143],v[64:79]
BL4 v[152:155],v204,s[24:27],s35 offen sc1
BL4 v[160:163],v204,s[24:27],s36 offen sc1
BL4 v[164:167],v204,s[24:27],s36 offen offset:1024 sc1
BL4 v[168:171],v204,s[24:27],s36 offen offset:2048 sc1
BL4 v[172:175],v204,s[24:27],s36 offen offset:3072 sc1
BL4 v[176:179],v206,s[24:27],s36 offen sc1
SADD s35,s35,1024
SADD s36,s36,5120
WT vmcnt(12)
M32 v[0:15],v[100:103],v[144:147],v[0:15]
M32 v[16:31],v[104:107],v[144:147],v[16:31]
M32 v[32:47],v[108:111],v[144:147],v[32:47]
M32 v[48:63],v[112:115],v[144:147],v[48:63]
M32 v[64:79],v[116:119],v[144:147],v[64:79]
BL4 v[140:143],v204,s[24:27],s35 offen sc1
BL4 v[80:83],v204,s[24:27],s36 offen sc1
BL4 v[84:87],v204,s[24:27],s36 offen offset:1024 sc1
BL4 v[88:91],v204,s[24:27],s36 offen offset:2048 sc1
BL4 v[92:95],v204,s[24:27],s36 offen offset:3072 sc1
BL4 v[96:99],v206,s[24:27],s36 offen sc1
SADD s35,s35,1024
SADD s36,s36,5120
WT vmcnt(63)
s_barrier
s_mul_i32 s7,s13,655360
SADD s7,s7,s11
s_mul_i32 s33,s13,663552
SADD s33,s33,s12
s_cmp_eq_u32 s15,0
s_cselect_b32 s7,0x7ff00000,s7
s_cselect_b32 s33,0x7ff00000,s33
SADD s34,s7,81920
SADD s8,s14,s22
SADD s21,s14,s23
SADD s13,s13,1
s_and_b32 s13,s13,3
SADD s14,s14,47104
s_cmp_eq_u32 s14,141312
s_cselect_b32 s14,0,s14
s_cmp_lg_u32 s15,0
s_subb_u32 s15,s15,0
SADD m0,s8,0
s_nop 0
BL4 v192,s[24:27],s7 offen sc1 lds
SADD m0,s8,1024
s_nop 0
BL4 v193,s[24:27],s7 offen sc1 lds
SADD m0,s8,2048
s_nop 0
BL4 v194,s[24:27],s7 offen sc1 lds
SADD m0,s8,3072
s_nop 0
BL4 v192,s[24:27],s34 offen sc1 lds
SADD m0,s8,4096
s_nop 0
BL4 v193,s[24:27],s34 offen sc1 lds
SADD m0,s8,5120
s_nop 0
BL4 v194,s[24:27],s34 offen sc1 lds
s_mov_b32 m0,s21
s_nop 0
BL4 v195,s[24:27],s33 offen sc1 lds
s_mov_b32 m0,s21
s_nop 0
BL4 v196,s[24:27],s33 offen offset:1024 sc1 lds
s_mov_b32 m0,s21
s_nop 0
BL4 v197,s[24:27],s33 offen offset:2048 sc1 lds
s_mov_b32 m0,s21
s_nop 0
BL4 v198,s[24:27],s33 offen offset:3072 sc1 lds
SADD m0,s21,4096
s_nop 0
BL4 v199,s[24:27],s33 offen sc1 lds
SADD m0,s21,4096
s_mov_b32 exec_hi,0
BL4 v200,s[24:27],s33 offen offset:1024 sc1 lds
s_mov_b32 exec_hi,-1
WT vmcnt(24)
s_nop 2
M32 v[0:15],v[120:123],v[148:151],v[0:15]
M32 v[16:31],v[124:127],v[148:151],v[16:31]
M32 v[32:47],v[128:131],v[148:151],v[32:47]
M32 v[48:63],v[132:135],v[148:151],v[48:63]
M32 v[64:79],v[136:139],v[148:151],v[64:79]
BL4 v[144:147],v204,s[24:27],s35 offen sc1
BL4 v[100:103],v204,s[24:27],s36 offen sc1
BL4 v[104:107],v204,s[24:27],s36 offen offset:1024 sc1
BL4 v[108:111],v204,s[24:27],s36 offen offset:2048 sc1
BL4 v[112:115],v204,s[24:27],s36 offen offset:3072 sc1
BL4 v[116:119],v206,s[24:27],s36 offen sc1
SADD s35,s35,1024
SADD s36,s36,5120
WT vmcnt(24)
M32 v[0:15],v[160:163],v[152:155],v[0:15]
M32 v[16:31],v[164:167],v[152:155],v[16:31]
M32 v[32:47],v[168:171],v[152:155],v[32:47]
M32 v[48:63],v[172:175],v[152:155],v[48:63]
M32 v[64:79],v[176:179],v[152:155],v[64:79]
BL4 v[148:151],v204,s[24:27],s35 offen sc1
BL4 v[120:123],v204,s[24:27],s36 offen sc1
BL4 v[124:127],v204,s[24:27],s36 offen offset:1024 sc1
BL4 v[128:131],v204,s[24:27],s36 offen offset:2048 sc1
BL4 v[132:135],v204,s[24:27],s36 offen offset:3072 sc1
BL4 v[136:139],v206,s[24:27],s36 offen sc1
SADD s35,s35,1024
SADD s36,s36,5120
WT vmcnt(24)
M32 v[0:15],v[80:83],v[140:143],v[0:15]
M32 v[16:31],v[84:87],v[140:143],v[16:31]
M32 v[32:47],v[88:91],v[140:143],v[32:47]
M32 v[48:63],v[92:95],v[140:143],v[48:63]
M32 v[64:79],v[96:99],v[140:143],v[64:79]
BL4 v[152:155],v204,s[24:27],s35 offen sc1
BL4 v[160:163],v204,s[24:27],s36 offen sc1
BL4 v[164:167],v204,s[24:27],s36 offen offset:1024 sc1
BL4 v[168:171],v204,s[24:27],s36 offen offset:2048 sc1
BL4 v[172:175],v204,s[24:27],s36 offen offset:3072 sc1
BL4 v[176:179],v206,s[24:27],s36 offen sc1
SADD s35,s35,1024
SADD s36,s36,5120
WT vmcnt(12)
M32 v[0:15],v[100:103],v[144:147],v[0:15]
M32 v[16:31],v[104:107],v[144:147],v[16:31]
M32 v[32:47],v[108:111],v[144:147],v[32:47]
M32 v[48:63],v[112:115],v[144:147],v[48:63]
M32 v[64:79],v[116:119],v[144:147],v[64:79]
BL4 v[140:143],v204,s[24:27],s35 offen sc1
BL4 v[80:83],v204,s[24:27],s36 offen sc1
BL4 v[84:87],v204,s[24:27],s36 offen offset:1024 sc1
BL4 v[88:91],v204,s[24:27],s36 offen offset:2048 sc1
BL4 v[92:95],v204,s[24:27],s36 offen offset:3072 sc1
BL4 v[96:99],v206,s[24:27],s36 offen sc1
SADD s35,s35,1024
SADD s36,s36,5120
WT vmcnt(12)
M32 v[0:15],v[120:123],v[148:151],v[0:15]
M32 v[16:31],v[124:127],v[148:151],v[16:31]
M32 v[32:47],v[128:131],v[148:151],v[32:47]
M32 v[48:63],v[132:135],v[148:151],v[48:63]
M32 v[64:79],v[136:139],v[148:151],v[64:79]
BL4 v[144:147],v204,s[24:27],s35 offen sc1
BL4 v[100:103],v204,s[24:27],s36 offen sc1
BL4 v[104:107],v204,s[24:27],s36 offen offset:1024 sc1
BL4 v[108:111],v204,s[24:27],s36 offen offset:2048 sc1
BL4 v[112:115],v204,s[24:27],s36 offen offset:3072 sc1
BL4 v[116:119],v206,s[24:27],s36 offen sc1
SADD s35,s35,1024
SADD s36,s36,5120
WT vmcnt(12)
M32 v[0:15],v[160:163],v[152:155],v[0:15]
M32 v[16:31],v[164:167],v[152:155],v[16:31]
M32 v[32:47],v[168:171],v[152:155],v[32:47]
M32 v[48:63],v[172:175],v[152:155],v[48:63]
M32 v[64:79],v[176:179],v[152:155],v[64:79]
BL4 v[148:151],v204,s[24:27],s35 offen sc1
BL4 v[120:123],v204,s[24:27],s36 offen sc1
BL4 v[124:127],v204,s[24:27],s36 offen offset:1024 sc1
BL4 v[128:131],v204,s[24:27],s36 offen offset:2048 sc1
BL4 v[132:135],v204,s[24:27],s36 offen offset:3072 sc1
BL4 v[136:139],v206,s[24:27],s36 offen sc1
SADD s35,s35,1024
SADD s36,s36,5120
WT vmcnt(12)
M32 v[0:15],v[80:83],v[140:143],v[0:15]
M32 v[16:31],v[84:87],v[140:143],v[16:31]
M32 v[32:47],v[88:91],v[140:143],v[32:47]
M32 v[48:63],v[92:95],v[140:143],v[48:63]
M32 v[64:79],v[96:99],v[140:143],v[64:79]
BL4 v[152:155],v204,s[24:27],s35 offen sc1
BL4 v[160:163],v204,s[24:27],s36 offen sc1
BL4 v[164:167],v204,s[24:27],s36 offen offset:1024 sc1
BL4 v[168:171],v204,s[24:27],s36 offen offset:2048 sc1
BL4 v[172:175],v204,s[24:27],s36 offen offset:3072 sc1
BL4 v[176:179],v206,s[24:27],s36 offen sc1
SADD s35,s35,1024
SADD s36,s36,5120
WT vmcnt(12)
M32 v[0:15],v[100:103],v[144:147],v[0:15]
M32 v[16:31],v[104:107],v[144:147],v[16:31]
M32 v[32:47],v[108:111],v[144:147],v[32:47]
M32 v[48:63],v[112:115],v[144:147],v[48:63]
M32 v[64:79],v[116:119],v[144:147],v[64:79]
BL4 v[140:143],v204,s[24:27],s35 offen sc1
BL4 v[80:83],v204,s[24:27],s36 offen sc1
BL4 v[84:87],v204,s[24:27],s36 offen offset:1024 sc1
BL4 v[88:91],v204,s[24:27],s36 offen offset:2048 sc1
BL4 v[92:95],v204,s[24:27],s36 offen offset:3072 sc1
BL4 v[96:99],v206,s[24:27],s36 offen sc1
SADD s35,s35,1024
SADD s36,s36,5120
WT vmcnt(12)
M32 v[0:15],v[120:123],v[148:151],v[0:15]
M32 v[16:31],v[124:127],v[148:151],v[16:31]
M32 v[32:47],v[128:131],v[148:151],v[32:47]
M32 v[48:63],v[132:135],v[148:151],v[48:63]
M32 v[64:79],v[136:139],v[148:151],v[64:79]
BL4 v[144:147],v204,s[24:27],s35 offen sc1
BL4 v[100:103],v204,s[24:27],s36 offen sc1
BL4 v[104:107],v204,s[24:27],s36 offen offset:1024 sc1
BL4 v[108:111],v204,s[24:27],s36 offen offset:2048 sc1
BL4 v[112:115],v204,s[24:27],s36 offen offset:3072 sc1
BL4 v[116:119],v206,s[24:27],s36 offen sc1
SADD s35,s35,1024
SADD s36,s36,5120
WT vmcnt(12)
M32 v[0:15],v[160:163],v[152:155],v[0:15]
M32 v[16:31],v[164:167],v[152:155],v[16:31]
M32 v[32:47],v[168:171],v[152:155],v[32:47]
M32 v[48:63],v[172:175],v[152:155],v[48:63]
M32 v[64:79],v[176:179],v[152:155],v[64:79]
BL4 v[148:151],v204,s[24:27],s35 offen sc1
BL4 v[120:123],v204,s[24:27],s36 offen sc1
BL4 v[124:127],v204,s[24:27],s36 offen offset:1024 sc1
BL4 v[128:131],v204,s[24:27],s36 offen offset:2048 sc1
BL4 v[132:135],v204,s[24:27],s36 offen offset:3072 sc1
BL4 v[136:139],v206,s[24:27],s36 offen sc1
SADD s35,s35,1024
SADD s36,s36,5120
WT vmcnt(60)
s_barrier
WT vmcnt(12)
M32 v[0:15],v[80:83],v[140:143],v[0:15]
M32 v[16:31],v[84:87],v[140:143],v[16:31]
M32 v[32:47],v[88:91],v[140:143],v[32:47]
M32 v[48:63],v[92:95],v[140:143],v[48:63]
M32 v[64:79],v[96:99],v[140:143],v[64:79]
BL4 v[152:155],v204,s[24:27],s35 offen sc1
BL4 v[160:163],v204,s[24:27],s36 offen sc1
BL4 v[164:167],v204,s[24:27],s36 offen offset:1024 sc1
BL4 v[168:171],v204,s[24:27],s36 offen offset:2048 sc1
BL4 v[172:175],v204,s[24:27],s36 offen offset:3072 sc1
BL4 v[176:179],v206,s[24:27],s36 offen sc1
SADD s35,s35,1024
SADD s36,s36,5120
WT vmcnt(12)
M32 v[0:15],v[100:103],v[144:147],v[0:15]
M32 v[16:31],v[104:107],v[144:147],v[16:31]
M32 v[32:47],v[108:111],v[144:147],v[32:47]
M32 v[48:63],v[112:115],v[144:147],v[48:63]
M32 v[64:79],v[116:119],v[144:147],v[64:79]
BL4 v[140:143],v204,s[24:27],s35 offen sc1
BL4 v[80:83],v204,s[24:27],s36 offen sc1
BL4 v[84:87],v204,s[24:27],s36 offen offset:1024 sc1
BL4 v[88:91],v204,s[24:27],s36 offen offset:2048 sc1
BL4 v[92:95],v204,s[24:27],s36 offen offset:3072 sc1
BL4 v[96:99],v206,s[24:27],s36 offen sc1
SADD s35,s35,1024
SADD s36,s36,5120
WT vmcnt(12)
M32 v[0:15],v[120:123],v[148:151],v[0:15]
M32 v[16:31],v[124:127],v[148:151],v[16:31]
M32 v[32:47],v[128:131],v[148:151],v[32:47]
M32 v[48:63],v[132:135],v[148:151],v[48:63]
M32 v[64:79],v[136:139],v[148:151],v[64:79]
BL4 v[144:147],v204,s[24:27],s35 offen sc1
BL4 v[100:103],v204,s[24:27],s36 offen sc1
BL4 v[104:107],v204,s[24:27],s36 offen offset:1024 sc1
BL4 v[108:111],v204,s[24:27],s36 offen offset:2048 sc1
BL4 v[112:115],v204,s[24:27],s36 offen offset:3072 sc1
BL4 v[116:119],v206,s[24:27],s36 offen sc1
SADD s35,s35,1024
SADD s36,s36,5120
WT vmcnt(12)
M32 v[0:15],v[160:163],v[152:155],v[0:15]
M32 v[16:31],v[164:167],v[152:155],v[16:31]
M32 v[32:47],v[168:171],v[152:155],v[32:47]
M32 v[48:63],v[172:175],v[152:155],v[48:63]
M32 v[64:79],v[176:179],v[152:155],v[64:79]
BL4 v[148:151],v204,s[24:27],s35 offen sc1
BL4 v[120:123],v204,s[24:27],s36 offen sc1
BL4 v[124:127],v204,s[24:27],s36 offen offset:1024 sc1
BL4 v[128:131],v204,s[24:27],s36 offen offset:2048 sc1
BL4 v[132:135],v204,s[24:27],s36 offen offset:3072 sc1
BL4 v[136:139],v206,s[24:27],s36 offen sc1
SADD s35,s35,1024
SADD s36,s36,5120
WT vmcnt(12)
M32 v[0:15],v[80:83],v[140:143],v[0:15]
M32 v[16:31],v[84:87],v[140:143],v[16:31]
M32 v[32:47],v[88:91],v[140:143],v[32:47]
M32 v[48:63],v[92:95],v[140:143],v[48:63]
M32 v[64:79],v[96:99],v[140:143],v[64:79]
WT vmcnt(6)
M32 v[0:15],v[100:103],v[144:147],v[0:15]
M32 v[16:31],v[104:107],v[144:147],v[16:31]
M32 v[32:47],v[108:111],v[144:147],v[32:47]
M32 v[48:63],v[112:115],v[144:147],v[48:63]
M32 v[64:79],v[116:119],v[144:147],v[64:79]
WT vmcnt(0)
M32 v[0:15],v[120:123],v[148:151],v[0:15]
M32 v[16:31],v[124:127],v[148:151],v[16:31]
M32 v[32:47],v[128:131],v[148:151],v[32:47]
M32 v[48:63],v[132:135],v[148:151],v[48:63]
M32 v[64:79],v[136:139],v[148:151],v[64:79]
s_mov_b32 s54,1
HP_ffndone:
s_mul_i32 s44,s42,204800
SADD s44,s44,20037632
s_mul_i32 s9,s31,51200
SADD s47,s44,s9
SADD s47,s47,4096
s_lshl_b32 s9,s31,10
SADD s44,s44,s9
BL4 v[80:83],v204,s[24:27],s44 offen sc1
SADD s44,s44,5120
BL4 v[84:87],v204,s[24:27],s44 offen sc1
SADD s44,s44,5120
BL4 v[88:91],v204,s[24:27],s44 offen sc1
SADD s44,s44,5120
BL4 v[92:95],v204,s[24:27],s44 offen sc1
SADD s44,s44,5120
BL4 v[96:99],v204,s[24:27],s44 offen sc1
SADD s44,s44,5120
BL4 v[100:103],v204,s[24:27],s44 offen sc1
SADD s44,s44,5120
BL4 v[104:107],v204,s[24:27],s44 offen sc1
SADD s44,s44,5120
BL4 v[108:111],v204,s[24:27],s44 offen sc1
SADD s44,s44,5120
BL4 v[112:115],v204,s[24:27],s44 offen sc1
SADD s44,s44,5120
BL4 v[116:119],v204,s[24:27],s44 offen sc1
SADD s44,s44,5120
BL4 v[120:123],v204,s[24:27],s44 offen sc1
SADD s44,s44,5120
BL4 v[124:127],v204,s[24:27],s44 offen sc1
SADD s44,s44,5120
BL4 v[128:131],v204,s[24:27],s44 offen sc1
SADD s44,s44,5120
BL4 v[132:135],v204,s[24:27],s44 offen sc1
SADD s44,s44,5120
BL4 v[136:139],v204,s[24:27],s44 offen sc1
SADD s44,s44,5120
BL4 v[140:143],v204,s[24:27],s44 offen sc1
SADD s44,s44,5120
BL4 v[144:147],v204,s[24:27],s44 offen sc1
SADD s44,s44,5120
BL4 v[148:151],v204,s[24:27],s44 offen sc1
SADD s44,s44,5120
BL4 v[152:155],v204,s[24:27],s44 offen sc1
SADD s44,s44,5120
BL4 v[156:159],v204,s[24:27],s44 offen sc1
SADD s44,s44,5120
BL4 v[160:163],v204,s[24:27],s44 offen sc1
SADD s44,s44,5120
BL4 v[164:167],v204,s[24:27],s44 offen sc1
SADD s44,s44,5120
BL4 v[168:171],v204,s[24:27],s44 offen sc1
SADD s44,s44,5120
BL4 v[172:175],v204,s[24:27],s44 offen sc1
SADD s44,s44,5120
BL4 v[176:179],v204,s[24:27],s44 offen sc1
SADD s44,s44,5120
BL4 v[180:183],v204,s[24:27],s44 offen sc1
SADD s44,s44,5120
BL4 v[184:187],v204,s[24:27],s44 offen sc1
SADD s44,s44,5120
BL4 v[188:191],v204,s[24:27],s44 offen sc1
SADD s44,s44,5120
BL4 v[192:195],v204,s[24:27],s44 offen sc1
SADD s44,s44,5120
BL4 v[196:199],v204,s[24:27],s44 offen sc1
SADD s44,s44,5120
BL4 v[200:203],v204,s[24:27],s44 offen sc1
SADD s44,s44,5120
BL4 v[208:211],v204,s[24:27],s44 offen sc1
SADD s44,s44,5120
BL4 v[212:215],v204,s[24:27],s44 offen sc1
SADD s44,s44,5120
BL4 v[216:219],v204,s[24:27],s44 offen sc1
SADD s44,s44,5120
BL4 v[220:223],v204,s[24:27],s44 offen sc1
SADD s44,s44,5120
BL4 v[224:227],v204,s[24:27],s44 offen sc1
SADD s44,s44,5120
BL4 v[228:231],v204,s[24:27],s44 offen sc1
SADD s44,s44,5120
BL4 v[232:235],v204,s[24:27],s44 offen sc1
SADD s44,s44,5120
BL4 v[236:239],v204,s[24:27],s44 offen sc1
SADD s44,s44,5120
s_cmp_eq_u32 s16,0
s_cbranch_scc0 HP_nob4
s_barrier
HP_nob4:
s_nop 11
s_mul_i32 s9,s31,20480
SADD s9,s9,47104
v_add_u32 v240,s9,v204
ds_write_b128 v240,v[0:3] offset:0
ds_write_b128 v240,v[4:7] offset:1024
ds_write_b128 v240,v[8:11] offset:2048
ds_write_b128 v240,v[12:15] offset:3072
ds_write_b128 v240,v[16:19] offset:4096
ds_write_b128 v240,v[20:23] offset:5120
ds_write_b128 v240,v[24:27] offset:6144
ds_write_b128 v240,v[28:31] offset:7168
ds_write_b128 v240,v[32:35] offset:8192
ds_write_b128 v240,v[36:39] offset:9216
ds_write_b128 v240,v[40:43] offset:10240
ds_write_b128 v240,v[44:47] offset:11264
ds_write_b128 v240,v[48:51] offset:12288
ds_write_b128 v240,v[52:55] offset:13312
ds_write_b128 v240,v[56:59] offset:14336
ds_write_b128 v240,v[60:63] offset:15360
ds_write_b128 v240,v[64:67] offset:16384
ds_write_b128 v240,v[68:71] offset:17408
ds_write_b128 v240,v[72:75] offset:18432
ds_write_b128 v240,v[76:79] offset:19456
WT lgkmcnt(0)
s_barrier
v_mov_b32 v244,141344
R128 v[248:251],v244
WT lgkmcnt(0)
v_or_b32 v248,v248,v249
v_or_b32 v248,v248,v250
v_or_b32 v248,v248,v251
s_nop 0
v_readfirstlane_b32 s9,v248
s_nop 3
s_cmp_eq_u32 s9,0
s_cbranch_scc0 HP_slow1
s_lshl_b32 s9,s31,12
SADD s9,s9,47104
v_add_u32 v240,s9,v204
v_add_u32 v241,40960,v240
s_lshl_b32 s9,s31,10
SADD s9,s9,63488
v_add_u32 v242,s9,v204
v_add_u32 v243,40960,v242
R128 v[0:3],v240 offset:0
R128 v[4:7],v240 offset:20480
R128 v[8:11],v241 offset:0
R128 v[12:15],v241 offset:20480
R128 v[16:19],v240 offset:1024
R128 v[20:23],v240 offset:21504
R128 v[24:27],v241 offset:1024
R128 v[28:31],v241 offset:21504
R128 v[32:35],v240 offset:2048
R128 v[36:39],v240 offset:22528
R128 v[40:43],v241 offset:2048
R128 v[44:47],v241 offset:22528
WT lgkmcnt(0)
R128 v[48:51],v240 offset:3072
R128 v[52:55],v240 offset:23552
R128 v[56:59],v241 offset:3072
R128 v[60:63],v241 offset:23552
R128 v[64:67],v242 offset:0
R128 v[68:71],v242 offset:20480
R128 v[72:75],v243 offset:0
R128 v[76:79],v243 offset:20480
WT lgkmcnt(0)
ADD v0,v0,v4
ADD v8,v8,v12
ADD v1,v1,v5
ADD v9,v9,v13
ADD v2,v2,v6
ADD v10,v10,v14
ADD v3,v3,v7
ADD v11,v11,v15
ADD v0,v0,v8
ADD v1,v1,v9
ADD v2,v2,v10
ADD v3,v3,v11
MUL v244,0xbfb8aa3b,v0
MUL v245,0xbfb8aa3b,v1
MUL v246,0xbfb8aa3b,v2
MUL v247,0xbfb8aa3b,v3
EX v244,v244
EX v245,v245
EX v246,v246
EX v247,v247
ADD v244,1.0,v244
ADD v245,1.0,v245
ADD v246,1.0,v246
ADD v247,1.0,v247
RCP v244,v244
RCP v245,v245
RCP v246,v246
RCP v247,v247
MUL v0,v244,v0
MUL v1,v245,v1
MUL v2,v246,v2
MUL v3,v247,v3
ADD v16,v16,v20
ADD v24,v24,v28
ADD v17,v17,v21
ADD v25,v25,v29
ADD v18,v18,v22
ADD v26,v26,v30
ADD v19,v19,v23
ADD v27,v27,v31
ADD v16,v16,v24
ADD v17,v17,v25
ADD v18,v18,v26
ADD v19,v19,v27
MUL v244,0xbfb8aa3b,v16
MUL v245,0xbfb8aa3b,v17
MUL v246,0xbfb8aa3b,v18
MUL v247,0xbfb8aa3b,v19
EX v244,v244
EX v245,v245
EX v246,v246
EX v247,v247
ADD v244,1.0,v244
ADD v245,1.0,v245
ADD v246,1.0,v246
ADD v247,1.0,v247
RCP v244,v244
RCP v245,v245
RCP v246,v246
RCP v247,v247
MUL v16,v244,v16
MUL v17,v245,v17
MUL v18,v246,v18
MUL v19,v247,v19
ADD v32,v32,v36
ADD v40,v40,v44
ADD v33,v33,v37
ADD v41,v41,v45
ADD v34,v34,v38
ADD v42,v42,v46
ADD v35,v35,v39
ADD v43,v43,v47
ADD v32,v32,v40
ADD v33,v33,v41
ADD v34,v34,v42
ADD v35,v35,v43
MUL v244,0xbfb8aa3b,v32
MUL v245,0xbfb8aa3b,v33
MUL v246,0xbfb8aa3b,v34
MUL v247,0xbfb8aa3b,v35
EX v244,v244
EX v245,v245
EX v246,v246
EX v247,v247
ADD v244,1.0,v244
ADD v245,1.0,v245
ADD v246,1.0,v246
ADD v247,1.0,v247
RCP v244,v244
RCP v245,v245
RCP v246,v246
RCP v247,v247
MUL v32,v244,v32
MUL v33,v245,v33
MUL v34,v246,v34
MUL v35,v247,v35
ADD v48,v48,v52
ADD v56,v56,v60
ADD v49,v49,v53
ADD v57,v57,v61
ADD v50,v50,v54
ADD v58,v58,v62
ADD v51,v51,v55
ADD v59,v59,v63
ADD v48,v48,v56
ADD v49,v49,v57
ADD v50,v50,v58
ADD v51,v51,v59
MUL v244,0xbfb8aa3b,v48
MUL v245,0xbfb8aa3b,v49
MUL v246,0xbfb8aa3b,v50
MUL v247,0xbfb8aa3b,v51
EX v244,v244
EX v245,v245
EX v246,v246
EX v247,v247
ADD v244,1.0,v244
ADD v245,1.0,v245
ADD v246,1.0,v246
ADD v247,1.0,v247
RCP v244,v244
RCP v245,v245
RCP v246,v246
RCP v247,v247
MUL v48,v244,v48
MUL v49,v245,v49
MUL v50,v246,v50
MUL v51,v247,v51
ADD v64,v64,v68
ADD v72,v72,v76
ADD v65,v65,v69
ADD v73,v73,v77
ADD v66,v66,v70
ADD v74,v74,v78
ADD v67,v67,v71
ADD v75,v75,v79
ADD v64,v64,v72
ADD v65,v65,v73
ADD v66,v66,v74
ADD v67,v67,v75
MUL v244,0xbfb8aa3b,v64
MUL v245,0xbfb8aa3b,v65
MUL v246,0xbfb8aa3b,v66
MUL v247,0xbfb8aa3b,v67
EX v244,v244
EX v245,v245
EX v246,v246
EX v247,v247
ADD v244,1.0,v244
ADD v245,1.0,v245
ADD v246,1.0,v246
ADD v247,1.0,v247
RCP v244,v244
RCP v245,v245
RCP v246,v246
RCP v247,v247
MUL v64,v244,v64
MUL v65,v245,v65
MUL v66,v246,v66
MUL v67,v247,v67
s_mul_i32 s9,s31,5120
SADD s9,s9,141568
v_add_u32 v243,s9,v204
ds_write_b128 v243,v[0:3] offset:0
ds_write_b128 v243,v[16:19] offset:1024
ds_write_b128 v243,v[32:35] offset:2048
ds_write_b128 v243,v[48:51] offset:3072
ds_write_b128 v243,v[64:67] offset:4096
WT lgkmcnt(0)
BL4 v[32:35],v204,s[24:27],s44 offen sc1
SADD s44,s44,5120
BL4 v[36:39],v204,s[24:27],s47 offen sc1
SADD s47,s47,5120
BL4 v[40:43],v204,s[24:27],s47 offen sc1
SADD s47,s47,5120
BL4 v[44:47],v204,s[24:27],s47 offen sc1
SADD s47,s47,5120
BL4 v[48:51],v204,s[24:27],s47 offen sc1
SADD s47,s47,5120
BL4 v[52:55],v204,s[24:27],s47 offen sc1
SADD s47,s47,5120
BL4 v[56:59],v204,s[24:27],s47 offen sc1
SADD s47,s47,5120
BL4 v[60:63],v204,s[24:27],s47 offen sc1
SADD s47,s47,5120
BL4 v[64:67],v204,s[24:27],s47 offen sc1
SADD s47,s47,5120
BL4 v[68:71],v204,s[24:27],s47 offen sc1
SADD s47,s47,5120
BL4 v[72:75],v204,s[24:27],s47 offen sc1
SADD s47,s47,5120
s_load_dwordx2 s[68:69],s[0:1],0
s_load_dwordx2 s[72:73],s[0:1],56
s_mul_i32 s9,s41,40960
s_mul_i32 s10,s42,320
SADD s9,s9,s10
s_lshl_b32 s10,s31,6
v_add_u32 v244,s10,v205
v_add_u32 v245,0,v244
v_mul_u32_u24 v246,3277,v245
v_lshrrev_b32 v246,16,v246
v_mul_u32_u24 v247,20,v246
v_sub_u32 v247,v245,v247
v_mul_u32_u24 v248,1280,v246
v_lshl_add_u32 v248,v247,4,v248
v_add_u32 v240,s9,v248
v_add_u32 v245,256,v244
v_mul_u32_u24 v246,3277,v245
v_lshrrev_b32 v246,16,v246
v_mul_u32_u24 v247,20,v246
v_sub_u32 v247,v245,v247
v_mul_u32_u24 v248,1280,v246
v_lshl_add_u32 v248,v247,4,v248
v_add_u32 v241,s9,v248
v_add_u32 v245,512,v244
v_mul_u32_u24 v246,3277,v245
v_lshrrev_b32 v246,16,v246
v_mul_u32_u24 v247,20,v246
v_sub_u32 v247,v245,v247
v_mul_u32_u24 v248,1280,v246
v_lshl_add_u32 v248,v247,4,v248
v_add_u32 v242,s9,v248
v_cmp_gt_u32 vcc,640,v245
v_mov_b32 v249,0x80000000
s_nop 0
v_cndmask_b32 v242,v249,v242,vcc
WT lgkmcnt(0)
s_mov_b32 s70,2621440
s_mov_b32 s71,131072
s_mov_b32 s74,2621440
s_mov_b32 s75,131072
s_lshr_b32 s9,s41,1
s_lshl_b32 s9,s9,7
SADD s9,s9,23472640
AND v244,31,v205
SHL v244,2,v244
v_add_u32 v244,s9,v244
s_mov_b32 s52,0
HP_poll:
buffer_load_dword v245,v244,s[24:27],0 offen sc1
WT vmcnt(0)
v_cmp_ne_u32 vcc,0x5ca1ab1e,v245
s_nop 3
s_and_b32 vcc_lo,vcc_lo,0xffffffff
s_cmp_eq_u32 vcc_lo,0
s_cbranch_scc1 HP_poll_ok
SADD s52,s52,1
s_cmp_lt_u32 s52,200000
s_cbranch_scc0 HP_poll_ok
s_sleep 1
s_branch HP_poll
HP_poll_ok:
s_mul_i32 s45,s41,40960
s_mul_i32 s9,s31,10240
SADD s45,s45,s9
SADD s45,s45,15204352
SADD m0,s9,0
s_nop 0
BL4 v204,s[24:27],s45 offen sc1 lds
BL4 v204,s[24:27],s45 offen offset:1024 sc1 lds
BL4 v204,s[24:27],s45 offen offset:2048 sc1 lds
BL4 v204,s[24:27],s45 offen offset:3072 sc1 lds
SADD m0,s9,4096
SADD s45,s45,4096
BL4 v204,s[24:27],s45 offen sc1 lds
BL4 v204,s[24:27],s45 offen offset:1024 sc1 lds
BL4 v204,s[24:27],s45 offen offset:2048 sc1 lds
BL4 v204,s[24:27],s45 offen offset:3072 sc1 lds
SADD m0,s9,8192
SADD s45,s45,4096
BL4 v204,s[24:27],s45 offen sc1 lds
BL4 v204,s[24:27],s45 offen offset:1024 sc1 lds
v_add_u32 v244,s9,v204
WT vmcnt(0)
s_barrier
R128 v[248:251],v204 offset:0
R128 v[252:255],v204 offset:1024
R128 v[76:79],v204 offset:2048
WT lgkmcnt(2)
M32 v[0:15],v[80:83],v[248:251],0
R128 v[248:251],v204 offset:3072
WT lgkmcnt(2)
M32 v[0:15],v[84:87],v[252:255],v[0:15]
R128 v[252:255],v244 offset:0
WT lgkmcnt(2)
M32 v[0:15],v[88:91],v[76:79],v[0:15]
R128 v[76:79],v204 offset:4096
WT lgkmcnt(2)
M32 v[0:15],v[92:95],v[248:251],v[0:15]
R128 v[248:251],v204 offset:5120
WT lgkmcnt(2)
M32 v[16:31],v[36:39],v[252:255],0
R128 v[252:255],v204 offset:6144
WT lgkmcnt(2)
M32 v[0:15],v[96:99],v[76:79],v[0:15]
R128 v[76:79],v204 offset:7168
WT lgkmcnt(2)
M32 v[0:15],v[100:103],v[248:251],v[0:15]
R128 v[248:251],v244 offset:1024
WT lgkmcnt(2)
M32 v[0:15],v[104:107],v[252:255],v[0:15]
R128 v[252:255],v204 offset:8192
WT lgkmcnt(2)
M32 v[0:15],v[108:111],v[76:79],v[0:15]
R128 v[76:79],v204 offset:9216
WT lgkmcnt(2)
M32 v[16:31],v[40:43],v[248:251],v[16:31]
R128 v[248:251],v204 offset:10240
WT lgkmcnt(2)
M32 v[0:15],v[112:115],v[252:255],v[0:15]
R128 v[252:255],v204 offset:11264
WT lgkmcnt(2)
M32 v[0:15],v[116:119],v[76:79],v[0:15]
R128 v[76:79],v244 offset:2048
WT lgkmcnt(2)
M32 v[0:15],v[120:123],v[248:251],v[0:15]
R128 v[248:251],v204 offset:12288
WT lgkmcnt(2)
M32 v[0:15],v[124:127],v[252:255],v[0:15]
R128 v[252:255],v204 offset:13312
WT lgkmcnt(2)
M32 v[16:31],v[44:47],v[76:79],v[16:31]
R128 v[76:79],v204 offset:14336
WT lgkmcnt(2)
M32 v[0:15],v[128:131],v[248:251],v[0:15]
R128 v[248:251],v204 offset:15360
WT lgkmcnt(2)
M32 v[0:15],v[132:135],v[252:255],v[0:15]
R128 v[252:255],v244 offset:3072
WT lgkmcnt(2)
M32 v[0:15],v[136:139],v[76:79],v[0:15]
R128 v[76:79],v204 offset:16384
WT lgkmcnt(2)
M32 v[0:15],v[140:143],v[248:251],v[0:15]
R128 v[248:251],v204 offset:17408
WT lgkmcnt(2)
M32 v[16:31],v[48:51],v[252:255],v[16:31]
R128 v[252:255],v204 offset:18432
WT lgkmcnt(2)
M32 v[0:15],v[144:147],v[76:79],v[0:15]
R128 v[76:79],v204 offset:19456
WT lgkmcnt(2)
M32 v[0:15],v[148:151],v[248:251],v[0:15]
R128 v[248:251],v244 offset:4096
WT lgkmcnt(2)
M32 v[0:15],v[152:155],v[252:255],v[0:15]
R128 v[252:255],v204 offset:20480
WT lgkmcnt(2)
M32 v[0:15],v[156:159],v[76:79],v[0:15]
R128 v[76:79],v204 offset:21504
WT lgkmcnt(2)
M32 v[16:31],v[52:55],v[248:251],v[16:31]
R128 v[248:251],v204 offset:22528
WT lgkmcnt(2)
M32 v[0:15],v[160:163],v[252:255],v[0:15]
R128 v[252:255],v204 offset:23552
WT lgkmcnt(2)
M32 v[0:15],v[164:167],v[76:79],v[0:15]
R128 v[76:79],v244 offset:5120
WT lgkmcnt(2)
M32 v[0:15],v[168:171],v[248:251],v[0:15]
R128 v[248:251],v204 offset:24576
WT lgkmcnt(2)
M32 v[0:15],v[172:175],v[252:255],v[0:15]
R128 v[252:255],v204 offset:25600
WT lgkmcnt(2)
M32 v[16:31],v[56:59],v[76:79],v[16:31]
R128 v[76:79],v204 offset:26624
WT lgkmcnt(2)
M32 v[0:15],v[176:179],v[248:251],v[0:15]
R128 v[248:251],v204 offset:27648
WT lgkmcnt(2)
M32 v[0:15],v[180:183],v[252:255],v[0:15]
R128 v[252:255],v244 offset:6144
WT lgkmcnt(2)
M32 v[0:15],v[184:187],v[76:79],v[0:15]
R128 v[76:79],v204 offset:28672
WT lgkmcnt(2)
M32 v[0:15],v[188:191],v[248:251],v[0:15]
R128 v[248:251],v204 offset:29696
WT lgkmcnt(2)
M32 v[16:31],v[60:63],v[252:255],v[16:31]
R128 v[252:255],v204 offset:30720
WT lgkmcnt(2)
M32 v[0:15],v[192:195],v[76:79],v[0:15]
R128 v[76:79],v204 offset:31744
WT lgkmcnt(2)
M32 v[0:15],v[196:199],v[248:251],v[0:15]
R128 v[248:251],v244 offset:7168
WT lgkmcnt(2)
M32 v[0:15],v[200:203],v[252:255],v[0:15]
R128 v[252:255],v204 offset:32768
WT lgkmcnt(2)
M32 v[0:15],v[208:211],v[76:79],v[0:15]
R128 v[76:79],v204 offset:33792
WT lgkmcnt(2)
M32 v[16:31],v[64:67],v[248:251],v[16:31]
R128 v[248:251],v204 offset:34816
WT lgkmcnt(2)
M32 v[0:15],v[212:215],v[252:255],v[0:15]
R128 v[252:255],v204 offset:35840
WT lgkmcnt(2)
M32 v[0:15],v[216:219],v[76:79],v[0:15]
R128 v[76:79],v244 offset:8192
WT lgkmcnt(2)
M32 v[0:15],v[220:223],v[248:251],v[0:15]
R128 v[248:251],v204 offset:36864
WT lgkmcnt(2)
M32 v[0:15],v[224:227],v[252:255],v[0:15]
R128 v[252:255],v204 offset:37888
WT lgkmcnt(2)
M32 v[16:31],v[68:71],v[76:79],v[16:31]
R128 v[76:79],v204 offset:38912
WT lgkmcnt(2)
M32 v[0:15],v[228:231],v[248:251],v[0:15]
R128 v[248:251],v204 offset:39936
WT lgkmcnt(2)
M32 v[0:15],v[232:235],v[252:255],v[0:15]
R128 v[252:255],v244 offset:9216
WT lgkmcnt(2)
M32 v[0:15],v[236:239],v[76:79],v[0:15]
WT lgkmcnt(1)
M32 v[0:15],v[32:35],v[248:251],v[0:15]
WT lgkmcnt(0)
M32 v[16:31],v[72:75],v[252:255],v[16:31]
BL4 v[80:83],v240,s[68:71],0 offen
BL4 v[84:87],v241,s[68:71],0 offen
BL4 v[88:91],v242,s[68:71],0 offen
R128 v[100:103],v243 offset:0
R128 v[104:107],v243 offset:1024
R128 v[108:111],v243 offset:2048
R128 v[112:115],v243 offset:3072
R128 v[116:119],v243 offset:4096
s_lshl_b32 s9,s31,12
SADD s9,s9,40960
v_add_u32 v244,s9,v204
s_nop 7
ds_write_b128 v244,v[16:19] offset:0
ds_write_b128 v244,v[20:23] offset:1024
ds_write_b128 v244,v[24:27] offset:2048
ds_write_b128 v244,v[28:31] offset:3072
WT lgkmcnt(4)
MUL v0,v0,v100
MUL v1,v1,v101
MUL v2,v2,v102
MUL v3,v3,v103
MUL v4,v4,v104
MUL v5,v5,v105
MUL v6,v6,v106
MUL v7,v7,v107
MUL v8,v8,v108
MUL v9,v9,v109
MUL v10,v10,v110
MUL v11,v11,v111
MUL v12,v12,v112
MUL v13,v13,v113
MUL v14,v14,v114
MUL v15,v15,v115
CV v120,v0,v1
CV v121,v2,v3
CV v122,v4,v5
CV v123,v6,v7
CV v124,v8,v9
CV v125,v10,v11
CV v126,v12,v13
CV v127,v14,v15
AND v245,31,v205
v_mul_u32_u24 v245,336,v245
v_lshrrev_b32 v246,5,v205
v_lshl_add_u32 v245,v246,3,v245
s_lshl_b32 s9,s31,6
SADD s9,s9,81920
v_add_u32 v246,s9,v245
ds_write_b64 v246,v[120:121] offset:0
ds_write_b64 v246,v[122:123] offset:16
ds_write_b64 v246,v[124:125] offset:32
ds_write_b64 v246,v[126:127] offset:48
WT lgkmcnt(0)
s_barrier
s_lshl_b32 s9,s31,10
SADD s9,s9,40960
v_add_u32 v244,s9,v204
R128 v[32:35],v244 offset:0
R128 v[36:39],v244 offset:4096
R128 v[40:43],v244 offset:8192
R128 v[44:47],v244 offset:12288
WT lgkmcnt(0)
ADD v32,v32,v36
ADD v40,v40,v44
ADD v33,v33,v37
ADD v41,v41,v45
ADD v34,v34,v38
ADD v42,v42,v46
ADD v35,v35,v39
ADD v43,v43,v47
ADD v32,v32,v40
ADD v33,v33,v41
ADD v34,v34,v42
ADD v35,v35,v43
MUL v32,v32,v116
MUL v33,v33,v117
MUL v34,v34,v118
MUL v35,v35,v119
CV v36,v32,v33
CV v37,v34,v35
s_lshl_b32 s9,s31,4
SADD s9,s9,82176
v_add_u32 v246,s9,v245
ds_write_b64 v246,v[36:37]
s_lshl_b32 s10,s31,6
v_add_u32 v244,s10,v205
v_add_u32 v244,0,v244
v_min_u32 v244,639,v244
v_mul_u32_u24 v245,3277,v244
v_lshrrev_b32 v245,16,v245
v_mul_u32_u24 v246,20,v245
v_sub_u32 v246,v244,v246
v_mul_u32_u24 v245,336,v245
v_lshl_add_u32 v245,v246,4,v245
v_add_u32 v248,81920,v245
v_add_u32 v244,s10,v205
v_add_u32 v244,256,v244
v_min_u32 v244,639,v244
v_mul_u32_u24 v245,3277,v244
v_lshrrev_b32 v245,16,v245
v_mul_u32_u24 v246,20,v245
v_sub_u32 v246,v244,v246
v_mul_u32_u24 v245,336,v245
v_lshl_add_u32 v245,v246,4,v245
v_add_u32 v249,81920,v245
v_add_u32 v244,s10,v205
v_add_u32 v244,512,v244
v_min_u32 v244,639,v244
v_mul_u32_u24 v245,3277,v244
v_lshrrev_b32 v245,16,v245
v_mul_u32_u24 v246,20,v245
v_sub_u32 v246,v244,v246
v_mul_u32_u24 v245,336,v245
v_lshl_add_u32 v245,v246,4,v245
v_add_u32 v250,81920,v245
WT lgkmcnt(0)
s_barrier
R128 v[0:3],v248
R128 v[4:7],v249
R128 v[8:11],v250
WT vmcnt(0)
WT lgkmcnt(0)
SHL v16,16,v0
AND v17,0xffff0000,v0
SHL v18,16,v80
AND v19,0xffff0000,v80
ADD v16,v16,v18
ADD v17,v17,v19
CV v80,v16,v17
SHL v16,16,v1
AND v17,0xffff0000,v1
SHL v18,16,v81
AND v19,0xffff0000,v81
ADD v16,v16,v18
ADD v17,v17,v19
CV v81,v16,v17
SHL v16,16,v2
AND v17,0xffff0000,v2
SHL v18,16,v82
AND v19,0xffff0000,v82
ADD v16,v16,v18
ADD v17,v17,v19
CV v82,v16,v17
SHL v16,16,v3
AND v17,0xffff0000,v3
SHL v18,16,v83
AND v19,0xffff0000,v83
ADD v16,v16,v18
ADD v17,v17,v19
CV v83,v16,v17
BS4 v[80:83],v240,s[72:75],0 offen
SHL v16,16,v4
AND v17,0xffff0000,v4
SHL v18,16,v84
AND v19,0xffff0000,v84
ADD v16,v16,v18
ADD v17,v17,v19
CV v84,v16,v17
SHL v16,16,v5
AND v17,0xffff0000,v5
SHL v18,16,v85
AND v19,0xffff0000,v85
ADD v16,v16,v18
ADD v17,v17,v19
CV v85,v16,v17
SHL v16,16,v6
AND v17,0xffff0000,v6
SHL v18,16,v86
AND v19,0xffff0000,v86
ADD v16,v16,v18
ADD v17,v17,v19
CV v86,v16,v17
SHL v16,16,v7
AND v17,0xffff0000,v7
SHL v18,16,v87
AND v19,0xffff0000,v87
ADD v16,v16,v18
ADD v17,v17,v19
CV v87,v16,v17
BS4 v[84:87],v241,s[72:75],0 offen
SHL v16,16,v8
AND v17,0xffff0000,v8
SHL v18,16,v88
AND v19,0xffff0000,v88
ADD v16,v16,v18
ADD v17,v17,v19
CV v88,v16,v17
SHL v16,16,v9
AND v17,0xffff0000,v9
SHL v18,16,v89
AND v19,0xffff0000,v89
ADD v16,v16,v18
ADD v17,v17,v19
CV v89,v16,v17
SHL v16,16,v10
AND v17,0xffff0000,v10
SHL v18,16,v90
AND v19,0xffff0000,v90
ADD v16,v16,v18
ADD v17,v17,v19
CV v90,v16,v17
SHL v16,16,v11
AND v17,0xffff0000,v11
SHL v18,16,v91
AND v19,0xffff0000,v91
ADD v16,v16,v18
ADD v17,v17,v19
CV v91,v16,v17
BS4 v[88:91],v242,s[72:75],0 offen
s_endpgm
HP_slow0:
WT vmcnt(0)
v_mov_b32 v240,0x5ca1ab1e
v_mov_b32 v241,s91
s_mov_b64 exec,1
buffer_store_dword v240,v241,s[24:27],0 offen sc1
s_mov_b64 exec,-1
s_mov_b32 s52,0
HPs_full:
buffer_load_dword v244,v235,s[24:27],0 offen sc1
buffer_load_dword v245,v236,s[24:27],0 offen sc1
WT vmcnt(0)
s_mov_b64 s[94:95],0
v_cmp_ne_u32 vcc,0x5ca1ab1e,v244
s_nop 3
s_and_b32 vcc_lo,vcc_lo,0xffffffff
s_and_b32 vcc_hi,vcc_hi,0xffffffff
s_or_b64 s[94:95],s[94:95],vcc
v_cmp_ne_u32 vcc,0x5ca1ab1e,v245
s_nop 3
s_and_b32 vcc_lo,vcc_lo,0xffffffff
s_and_b32 vcc_hi,vcc_hi,0xffff
s_or_b64 s[94:95],s[94:95],vcc
s_cmp_eq_u64 s[94:95],0
s_cbranch_scc1 HPs_full_ok
SADD s52,s52,1
s_cmp_lt_u32 s52,200000
s_cbranch_scc0 HPs_full_ok
s_sleep 2
s_branch HPs_full
HPs_full_ok:
s_lshr_b32 s9,s41,2
s_lshl_b32 s9,s9,9
SADD s9,s9,23463936
SHL v242,2,v205
v_add_u32 v242,s9,v242
v_add_u32 v243,256,v242
s_mov_b32 s52,0
HPs_fh:
buffer_load_dword v244,v242,s[24:27],0 offen sc1
buffer_load_dword v245,v243,s[24:27],0 offen sc1
WT vmcnt(0)
s_mov_b64 s[94:95],0
v_cmp_ne_u32 vcc,0x5ca1ab1e,v244
s_nop 3
s_and_b32 vcc_lo,vcc_lo,0xffffffff
s_and_b32 vcc_hi,vcc_hi,0xffffffff
s_or_b64 s[94:95],s[94:95],vcc
v_cmp_ne_u32 vcc,0x5ca1ab1e,v245
s_nop 3
s_and_b32 vcc_lo,vcc_lo,0xffffffff
s_and_b32 vcc_hi,vcc_hi,0xffffff
s_or_b64 s[94:95],s[94:95],vcc
s_cmp_eq_u64 s[94:95],0
s_cbranch_scc1 HPs_fh_ok
SADD s52,s52,1
s_cmp_lt_u32 s52,200000
s_cbranch_scc0 HPs_fh_ok
s_sleep 2
s_branch HPs_fh
HPs_fh_ok:
HP_slow0b:
s_mov_b32 s16,1
s_mul_i32 s35,s41,110592
s_mul_i32 s9,s31,27648
SADD s35,s35,s9
SADD s35,s35,8126464
s_mul_i32 s36,s42,552960
s_mul_i32 s9,s31,138240
SADD s36,s36,s9
SADD s36,s36,17825792
v_mov_b32 v0,0
v_mov_b32 v1,0
v_mov_b32 v2,0
v_mov_b32 v3,0
v_mov_b32 v4,0
v_mov_b32 v5,0
v_mov_b32 v6,0
v_mov_b32 v7,0
v_mov_b32 v8,0
v_mov_b32 v9,0
v_mov_b32 v10,0
v_mov_b32 v11,0
v_mov_b32 v12,0
v_mov_b32 v13,0
v_mov_b32 v14,0
v_mov_b32 v15,0
v_mov_b32 v16,0
v_mov_b32 v17,0
v_mov_b32 v18,0
v_mov_b32 v19,0
v_mov_b32 v20,0
v_mov_b32 v21,0
v_mov_b32 v22,0
v_mov_b32 v23,0
v_mov_b32 v24,0
v_mov_b32 v25,0
v_mov_b32 v26,0
v_mov_b32 v27,0
v_mov_b32 v28,0
v_mov_b32 v29,0
v_mov_b32 v30,0
v_mov_b32 v31,0
v_mov_b32 v32,0
v_mov_b32 v33,0
v_mov_b32 v34,0
v_mov_b32 v35,0
v_mov_b32 v36,0
v_mov_b32 v37,0
v_mov_b32 v38,0
v_mov_b32 v39,0
v_mov_b32 v40,0
v_mov_b32 v41,0
v_mov_b32 v42,0
v_mov_b32 v43,0
v_mov_b32 v44,0
v_mov_b32 v45,0
v_mov_b32 v46,0
v_mov_b32 v47,0
v_mov_b32 v48,0
v_mov_b32 v49,0
v_mov_b32 v50,0
v_mov_b32 v51,0
v_mov_b32 v52,0
v_mov_b32 v53,0
v_mov_b32 v54,0
v_mov_b32 v55,0
v_mov_b32 v56,0
v_mov_b32 v57,0
v_mov_b32 v58,0
v_mov_b32 v59,0
v_mov_b32 v60,0
v_mov_b32 v61,0
v_mov_b32 v62,0
v_mov_b32 v63,0
v_mov_b32 v64,0
v_mov_b32 v65,0
v_mov_b32 v66,0
v_mov_b32 v67,0
v_mov_b32 v68,0
v_mov_b32 v69,0
v_mov_b32 v70,0
v_mov_b32 v71,0
v_mov_b32 v72,0
v_mov_b32 v73,0
v_mov_b32 v74,0
v_mov_b32 v75,0
v_mov_b32 v76,0
v_mov_b32 v77,0
v_mov_b32 v78,0
v_mov_b32 v79,0
s_mov_b32 s17,27
HP_slow_ffn:
BL4 v[140:143],v204,s[24:27],s35 offen sc1
BL4 v[80:83],v204,s[24:27],s36 offen sc1
BL4 v[84:87],v204,s[24:27],s36 offen offset:1024 sc1
BL4 v[88:91],v204,s[24:27],s36 offen offset:2048 sc1
BL4 v[92:95],v204,s[24:27],s36 offen offset:3072 sc1
BL4 v[96:99],v206,s[24:27],s36 offen sc1
WT vmcnt(0)
M32 v[0:15],v[80:83],v[140:143],v[0:15]
M32 v[16:31],v[84:87],v[140:143],v[16:31]
M32 v[32:47],v[88:91],v[140:143],v[32:47]
M32 v[48:63],v[92:95],v[140:143],v[48:63]
M32 v[64:79],v[96:99],v[140:143],v[64:79]
SADD s35,s35,1024
SADD s36,s36,5120
s_nop 7
s_sub_u32 s17,s17,1
s_cmp_lg_u32 s17,0
s_cbranch_scc1 HP_slow_ffn
s_barrier
s_barrier
s_barrier
s_barrier
s_barrier
s_barrier
s_barrier
s_barrier
s_barrier
s_barrier
s_barrier
s_barrier
s_barrier
s_barrier
s_barrier
s_branch HP_ffndone
HP_slow1:
WT vmcnt(0)
s_branch HP_slow0b
K2_exit:
s_endpgm
K1_exit:
s_endpgm
.section .rodata,"a"

.p2align 6
.amdhsa_kernel recurrent_scan__softmax_full_mha__glu_gated_glu__prompt_kernel
  .amdhsa_next_free_vgpr 256
  .amdhsa_next_free_sgpr 96
  .amdhsa_accum_offset 256
  .amdhsa_group_segment_fixed_size 0
  .amdhsa_kernarg_size 80
  .amdhsa_user_sgpr_count 2
  .amdhsa_user_sgpr_kernarg_segment_ptr 1
  .amdhsa_system_sgpr_workgroup_id_x 1
  .amdhsa_float_denorm_mode_32 3
.end_amdhsa_kernel
```
